```python
import torch

def _softmax(x, axis=-1):
    return torch.softmax(x, dim=axis)
def _gelu(x):
    return torch.nn.functional.gelu(x, approximate="tanh")
def _silu(x):
    return torch.nn.functional.silu(x)
def _sigmoid(x):
    return torch.sigmoid(x)
def _layernorm(x, axis=-1, eps=1e-5):
    m = x.mean(dim=axis, keepdim=True)
    v = x.var(dim=axis, keepdim=True, unbiased=False)
    return (x - m) / torch.sqrt(v + eps)
def _scatter_add(tgt, idx, src, axis=0):
    return tgt.clone().index_add_(axis, idx, src)
def _segment_sum(src, seg, n):
    out = torch.zeros((n,) + src.shape[1:], dtype=src.dtype)
    return out.index_add_(0, seg, src)
def _pad(x, pw):
    flat = tuple(v for pair in reversed(pw) for v in pair)
    return torch.nn.functional.pad(x, flat)

kernel_name = 'interleave_layers__sliding_block__geglu_ffn__prompt'

def setup_inputs():

    _w = (lambda a: (lambda t: t.to(torch.bfloat16) if t.is_floating_point() else t)(torch.as_tensor(a)))
    def _A_setup():
        B, S, D = 1, 2048, 448
        return {
            "x": _w((lambda *s: torch.randn(*s, dtype=torch.bfloat16) * 0.05)(B, S, D)),
            "wqkv": _w((lambda *s: torch.randn(*s, dtype=torch.bfloat16) * 0.05)(D, 3 * D)),
            "wo": _w((lambda *s: torch.randn(*s, dtype=torch.bfloat16) * 0.05)(D, D)),
        }
    _A_in = _A_setup()

    def _B_setup():
        B, S, D, F = 1, 2048, 448, 1792
        return {
            "x": _w((lambda *s: torch.randn(*s, dtype=torch.bfloat16) * 0.05)(B, S, D)),
            "w_gate": _w((lambda *s: torch.randn(*s, dtype=torch.bfloat16) * 0.05)(D, F)),
            "w_up": _w((lambda *s: torch.randn(*s, dtype=torch.bfloat16) * 0.05)(D, F)),
            "w_down": _w((lambda *s: torch.randn(*s, dtype=torch.bfloat16) * 0.05)(F, D)),
        }
    _B_in = _B_setup()

    return {
        "A_x": _A_in["x"],
        "A_wqkv": _A_in["wqkv"],
        "A_wo": _A_in["wo"],
        "B_x": _B_in["x"],
        "B_w_gate": _B_in["w_gate"],
        "B_w_up": _B_in["w_up"],
        "B_w_down": _B_in["w_down"],
    }

def reference(A_x, A_wqkv, A_wo, B_x, B_w_gate, B_w_up, B_w_down):
    def _A_ref(x, wqkv, wo):
        B, S, D = x.shape
        H = 16; Dh = D // H; W = 256
        qkv = (lambda x, *d: x.permute(*d))((x @ wqkv).reshape(B, S, 3, H, Dh), 2, 0, 3, 1, 4)
        q, k, v = qkv[0], qkv[1], qkv[2]
        scores = torch.einsum("bhqd,bhkd->bhqk", q, k) * (Dh ** -0.5)
        idx = torch.arange(S)
        mask = (idx[:, None] - idx[None, :] >= 0) & (idx[:, None] - idx[None, :] < W)
        scores = torch.where(mask[None, None], scores, -1e9)
        p = _softmax(scores, axis=-1)
        o = torch.einsum("bhqk,bhkd->bhqd", p, v)
        return (lambda x, *d: x.permute(*d))(o, 0, 2, 1, 3).reshape(B, S, D) @ wo

    def _B_ref(x, w_gate, w_up, w_down):
        return (_gelu(x @ w_gate) * (x @ w_up)) @ w_down

    x = A_x
    x = x + _A_ref(_layernorm(x, axis=-1), A_wqkv, A_wo)
    x = x + _B_ref(_layernorm(x, axis=-1), B_w_gate, B_w_up, B_w_down)
    x = x + _A_ref(_layernorm(x, axis=-1), A_wqkv, A_wo)
    x = x + _B_ref(_layernorm(x, axis=-1), B_w_gate, B_w_up, B_w_down)
    return x
```

```asm
; @launch kernel=prep_kernel grid=(360,1,1) block=(256,1,1) lds=33792
; @launch kernel=main_kernel grid=(256,1,1) block=(512,1,1) lds=163840
.amdgcn_target "amdgcn-amd-amdhsa--gfx950"
.text
.globl prep_kernel
.p2align 8
.type prep_kernel,@function
prep_kernel:
    s_cmp_ge_u32 s2, 360
    s_cbranch_scc1 Lprep_end
    s_load_dwordx16 s[16:31], s[0:1], 0
    s_load_dwordx4 s[32:35], s[0:1], 64
    v_lshlrev_b32 v10, 4, v0
    v_lshrrev_b32 v2, 6, v0
    v_and_b32 v0, 63, v0
    v_readfirstlane_b32 s36, v2
    v_lshlrev_b32 v1, 4, v0
    v_and_b32 v3, 31, v0
    v_lshrrev_b32 v4, 5, v0
    s_lshl_b32 s46, s36, 13
    s_mul_i32 s47, s36, 7168
    s_waitcnt lgkmcnt(0)
    s_mov_b32 s4, s34
    s_mov_b32 s5, s35
    s_mov_b32 s6, 0x10000000
    s_mov_b32 s7, 0x00020000
    s_cmp_lt_u32 s2, 112
    s_cbranch_scc1 Lprep_gu
    s_cmp_lt_u32 s2, 160
    s_cbranch_scc1 Lprep_qkv
    s_cmp_lt_u32 s2, 176
    s_cbranch_scc1 Lprep_wo
    s_cmp_lt_u32 s2, 232
    s_cbranch_scc1 Lprep_wd
    s_cmp_lt_u32 s2, 296
    s_cbranch_scc1 Lprep_x
    s_sub_u32 s43, s2, 296
    s_lshl_b32 s43, s43, 16
    s_add_u32 s43, s43, 8732672
    v_mov_b32 v16, -1
    v_mov_b32 v17, -1
    v_mov_b32 v18, -1
    v_mov_b32 v19, -1
    buffer_store_dwordx4 v[16:19], v10, s[4:7], s43 offen sc1
    s_add_u32 s43, s43, 4096
    buffer_store_dwordx4 v[16:19], v10, s[4:7], s43 offen sc1
    s_add_u32 s43, s43, 4096
    buffer_store_dwordx4 v[16:19], v10, s[4:7], s43 offen sc1
    s_add_u32 s43, s43, 4096
    buffer_store_dwordx4 v[16:19], v10, s[4:7], s43 offen sc1
    s_add_u32 s43, s43, 4096
    buffer_store_dwordx4 v[16:19], v10, s[4:7], s43 offen sc1
    s_add_u32 s43, s43, 4096
    buffer_store_dwordx4 v[16:19], v10, s[4:7], s43 offen sc1
    s_add_u32 s43, s43, 4096
    buffer_store_dwordx4 v[16:19], v10, s[4:7], s43 offen sc1
    s_add_u32 s43, s43, 4096
    buffer_store_dwordx4 v[16:19], v10, s[4:7], s43 offen sc1
    s_add_u32 s43, s43, 4096
    buffer_store_dwordx4 v[16:19], v10, s[4:7], s43 offen sc1
    s_add_u32 s43, s43, 4096
    buffer_store_dwordx4 v[16:19], v10, s[4:7], s43 offen sc1
    s_add_u32 s43, s43, 4096
    buffer_store_dwordx4 v[16:19], v10, s[4:7], s43 offen sc1
    s_add_u32 s43, s43, 4096
    buffer_store_dwordx4 v[16:19], v10, s[4:7], s43 offen sc1
    s_add_u32 s43, s43, 4096
    buffer_store_dwordx4 v[16:19], v10, s[4:7], s43 offen sc1
    s_add_u32 s43, s43, 4096
    buffer_store_dwordx4 v[16:19], v10, s[4:7], s43 offen sc1
    s_add_u32 s43, s43, 4096
    buffer_store_dwordx4 v[16:19], v10, s[4:7], s43 offen sc1
    s_add_u32 s43, s43, 4096
    buffer_store_dwordx4 v[16:19], v10, s[4:7], s43 offen sc1
    s_add_u32 s43, s43, 4096
    s_branch Lprep_end
Lprep_qkv:
    s_nop 0
    s_mov_b32 s8, s18
    s_mov_b32 s9, s19
    s_mov_b32 s10, 0x126000
    s_mov_b32 s11, 0x00020000
    s_sub_u32 s43, s2, 112
    s_and_b32 s44, s43, 3
    s_bfe_u32 s37, s43, 0x20002
    s_lshr_b32 s38, s43, 4
    s_mul_i32 s39, s38, 896
    s_mul_i32 s41, s37, 224
    s_add_u32 s39, s39, s41
    v_lshrrev_b32 v5, 4, v0
    v_mul_u32_u24 v5, 2688, v5
    v_and_b32 v6, 15, v0
    v_lshl_add_u32 v5, v6, 4, v5
    s_lshl_b32 s40, s44, 2
    s_add_u32 s40, s40, s36
    s_mul_i32 s40, s40, 75264
    s_add_u32 s40, s40, s39
    s_mov_b32 s41, s47
    s_mov_b32 m0, s41
    s_nop 0
    buffer_load_dwordx4 v5, s[8:11], s40 offen lds
    s_add_u32 s40, s40, 10752
    s_add_u32 s41, s41, 1024
    s_mov_b32 m0, s41
    s_nop 0
    buffer_load_dwordx4 v5, s[8:11], s40 offen lds
    s_add_u32 s40, s40, 10752
    s_add_u32 s41, s41, 1024
    s_mov_b32 m0, s41
    s_nop 0
    buffer_load_dwordx4 v5, s[8:11], s40 offen lds
    s_add_u32 s40, s40, 10752
    s_add_u32 s41, s41, 1024
    s_mov_b32 m0, s41
    s_nop 0
    buffer_load_dwordx4 v5, s[8:11], s40 offen lds
    s_add_u32 s40, s40, 10752
    s_add_u32 s41, s41, 1024
    s_mov_b32 m0, s41
    s_nop 0
    buffer_load_dwordx4 v5, s[8:11], s40 offen lds
    s_add_u32 s40, s40, 10752
    s_add_u32 s41, s41, 1024
    s_mov_b32 m0, s41
    s_nop 0
    buffer_load_dwordx4 v5, s[8:11], s40 offen lds
    s_add_u32 s40, s40, 10752
    s_add_u32 s41, s41, 1024
    s_mov_b32 m0, s41
    s_nop 0
    buffer_load_dwordx4 v5, s[8:11], s40 offen lds
    s_add_u32 s40, s40, 10752
    s_add_u32 s41, s41, 1024
    s_lshl_b32 s42, s37, 2
    s_add_u32 s42, s42, s36
    s_mul_i32 s42, s42, 3
    s_add_u32 s42, s42, s38
    s_mul_i32 s42, s42, 29696
    s_add_u32 s42, s42, 0
    s_mov_b32 s45, 1
    s_mul_i32 s39, s36, 56
    v_bfe_u32 v6, v0, 4, 1
    v_lshlrev_b32 v7, 5, v6
    s_branch Lprep_T
Lprep_gu:
    s_nop 3
    s_and_b32 s44, s2, 3
    s_lshr_b32 s37, s2, 2
    s_lshl_b32 s42, s37, 2
    s_add_u32 s42, s42, s36
    s_mul_i32 s42, s42, 29696
    s_add_u32 s42, s42, 1884160
    s_lshl_b32 s37, s37, 7
    s_lshl_b32 s38, s44, 2
    s_add_u32 s38, s38, s36
    s_mul_i32 s38, s38, 100352
    s_add_u32 s37, s37, s38
    v_lshrrev_b32 v7, 4, v0
    v_mul_u32_u24 v7, 3584, v7
    v_and_b32 v6, 7, v0
    v_lshl_add_u32 v7, v6, 4, v7
    v_add_u32 v7, s37, v7
    v_and_b32 v6, 8, v0
    v_cmp_eq_u32 vcc, 0, v6
    v_mov_b32 v8, s26
    v_mov_b32 v9, s27
    v_mov_b32 v12, s24
    v_mov_b32 v13, s25
    v_cndmask_b32 v8, v8, v12, vcc
    v_cndmask_b32 v9, v9, v13, vcc
    v_add_co_u32 v8, vcc, v8, v7
    s_nop 1
    v_addc_co_u32 v9, vcc, 0, v9, vcc
    s_mov_b32 s48, 14336
    s_mov_b32 s49, 0
    s_mov_b32 s41, s47
    s_mov_b32 m0, s41
    s_nop 0
    global_load_lds_dwordx4 v[8:9], off
    v_lshl_add_u64 v[8:9], v[8:9], 0, s[48:49]
    s_add_u32 s41, s41, 1024
    s_mov_b32 m0, s41
    s_nop 0
    global_load_lds_dwordx4 v[8:9], off
    v_lshl_add_u64 v[8:9], v[8:9], 0, s[48:49]
    s_add_u32 s41, s41, 1024
    s_mov_b32 m0, s41
    s_nop 0
    global_load_lds_dwordx4 v[8:9], off
    v_lshl_add_u64 v[8:9], v[8:9], 0, s[48:49]
    s_add_u32 s41, s41, 1024
    s_mov_b32 m0, s41
    s_nop 0
    global_load_lds_dwordx4 v[8:9], off
    v_lshl_add_u64 v[8:9], v[8:9], 0, s[48:49]
    s_add_u32 s41, s41, 1024
    s_mov_b32 m0, s41
    s_nop 0
    global_load_lds_dwordx4 v[8:9], off
    v_lshl_add_u64 v[8:9], v[8:9], 0, s[48:49]
    s_add_u32 s41, s41, 1024
    s_mov_b32 m0, s41
    s_nop 0
    global_load_lds_dwordx4 v[8:9], off
    v_lshl_add_u64 v[8:9], v[8:9], 0, s[48:49]
    s_add_u32 s41, s41, 1024
    s_mov_b32 m0, s41
    s_nop 0
    global_load_lds_dwordx4 v[8:9], off
    v_lshl_add_u64 v[8:9], v[8:9], 0, s[48:49]
    s_add_u32 s41, s41, 1024
    s_mov_b32 s45, 2
    s_lshl_b32 s39, s36, 5
    v_bfe_u32 v6, v0, 4, 1
    v_lshlrev_b32 v7, 7, v6
Lprep_T:
    s_nop 4
    v_bfe_u32 v6, v0, 2, 2
    v_lshl_add_u32 v5, v4, 3, v6
    v_lshlrev_b32 v5, 8, v5
    v_add_u32 v5, v5, v7
    v_and_b32 v6, 3, v0
    v_lshl_add_u32 v5, v6, 3, v5
    v_add_u32 v5, s39, v5
    s_mul_i32 s41, s44, 7168
    s_add_u32 s41, s41, s42
    s_waitcnt vmcnt(0)
    s_barrier
    ds_read_b64_tr_b16 v[16:17], v5 offset:0
    ds_read_b64_tr_b16 v[18:19], v5 offset:1024
    ds_read_b64_tr_b16 v[20:21], v5 offset:4096
    ds_read_b64_tr_b16 v[22:23], v5 offset:5120
    ds_read_b64_tr_b16 v[24:25], v5 offset:8192
    ds_read_b64_tr_b16 v[26:27], v5 offset:9216
    ds_read_b64_tr_b16 v[28:29], v5 offset:12288
    ds_read_b64_tr_b16 v[30:31], v5 offset:13312
    ds_read_b64_tr_b16 v[32:33], v5 offset:16384
    ds_read_b64_tr_b16 v[34:35], v5 offset:17408
    ds_read_b64_tr_b16 v[36:37], v5 offset:20480
    ds_read_b64_tr_b16 v[38:39], v5 offset:21504
    ds_read_b64_tr_b16 v[40:41], v5 offset:24576
    ds_read_b64_tr_b16 v[42:43], v5 offset:25600
    s_waitcnt lgkmcnt(0)
    s_cmp_lg_u32 s45, 1
    s_cbranch_scc1 Lprep_z1
    s_mov_b32 s48, 0xf0000000
    s_mov_b32 s49, 0xf0000000
    s_mov_b64 exec, s[48:49]
    v_mov_b32 v16, 0
    v_mov_b32 v17, 0
    v_mov_b32 v18, 0
    v_mov_b32 v19, 0
    v_mov_b32 v20, 0
    v_mov_b32 v21, 0
    v_mov_b32 v22, 0
    v_mov_b32 v23, 0
    v_mov_b32 v24, 0
    v_mov_b32 v25, 0
    v_mov_b32 v26, 0
    v_mov_b32 v27, 0
    v_mov_b32 v28, 0
    v_mov_b32 v29, 0
    v_mov_b32 v30, 0
    v_mov_b32 v31, 0
    v_mov_b32 v32, 0
    v_mov_b32 v33, 0
    v_mov_b32 v34, 0
    v_mov_b32 v35, 0
    v_mov_b32 v36, 0
    v_mov_b32 v37, 0
    v_mov_b32 v38, 0
    v_mov_b32 v39, 0
    v_mov_b32 v40, 0
    v_mov_b32 v41, 0
    v_mov_b32 v42, 0
    v_mov_b32 v43, 0
    s_mov_b64 exec, -1
Lprep_z1:
    s_nop 3
    buffer_store_dwordx4 v[16:19], v1, s[4:7], s41 offen offset:0 sc1
    buffer_store_dwordx4 v[20:23], v1, s[4:7], s41 offen offset:1024 sc1
    buffer_store_dwordx4 v[24:27], v1, s[4:7], s41 offen offset:2048 sc1
    buffer_store_dwordx4 v[28:31], v1, s[4:7], s41 offen offset:3072 sc1
    s_add_u32 s41, s41, 4096
    buffer_store_dwordx4 v[32:35], v1, s[4:7], s41 offen offset:0 sc1
    buffer_store_dwordx4 v[36:39], v1, s[4:7], s41 offen offset:1024 sc1
    buffer_store_dwordx4 v[40:43], v1, s[4:7], s41 offen offset:2048 sc1
    v_mov_b32 v8, 0
    v_mov_b32 v9, 0
    v_mov_b32 v10, 0x3f803f80
    v_dot2c_f32_bf16 v8, v16, v10
    v_dot2c_f32_bf16 v9, v17, v10
    v_dot2c_f32_bf16 v8, v18, v10
    v_dot2c_f32_bf16 v9, v19, v10
    v_dot2c_f32_bf16 v8, v20, v10
    v_dot2c_f32_bf16 v9, v21, v10
    v_dot2c_f32_bf16 v8, v22, v10
    v_dot2c_f32_bf16 v9, v23, v10
    v_dot2c_f32_bf16 v8, v24, v10
    v_dot2c_f32_bf16 v9, v25, v10
    v_dot2c_f32_bf16 v8, v26, v10
    v_dot2c_f32_bf16 v9, v27, v10
    v_dot2c_f32_bf16 v8, v28, v10
    v_dot2c_f32_bf16 v9, v29, v10
    v_dot2c_f32_bf16 v8, v30, v10
    v_dot2c_f32_bf16 v9, v31, v10
    v_dot2c_f32_bf16 v8, v32, v10
    v_dot2c_f32_bf16 v9, v33, v10
    v_dot2c_f32_bf16 v8, v34, v10
    v_dot2c_f32_bf16 v9, v35, v10
    v_dot2c_f32_bf16 v8, v36, v10
    v_dot2c_f32_bf16 v9, v37, v10
    v_dot2c_f32_bf16 v8, v38, v10
    v_dot2c_f32_bf16 v9, v39, v10
    v_dot2c_f32_bf16 v8, v40, v10
    v_dot2c_f32_bf16 v9, v41, v10
    v_dot2c_f32_bf16 v8, v42, v10
    v_dot2c_f32_bf16 v9, v43, v10
    s_nop 3
    v_add_f32 v44, v8, v9
    v_mov_b32 v45, v44
    s_nop 1
    v_permlane32_swap_b32 v44, v45
    v_add_f32 v44, v44, v45
    v_cvt_pk_bf16_f32 v45, v44, v44
    v_lshlrev_b32 v46, 16, v45
    v_sub_f32 v47, v44, v46
    v_cvt_pk_bf16_f32 v48, v47, v47
    v_lshlrev_b32 v49, 16, v48
    v_sub_f32 v50, v47, v49
    v_cvt_pk_bf16_f32 v51, v50, v50
    v_and_b32 v45, 0xffff, v45
    v_or_b32 v52, v45, v49
    v_and_b32 v53, 0xffff, v51
    v_lshlrev_b32 v6, 4, v3
    s_lshr_b32 s41, s44, 1
    s_lshl_b32 s41, s41, 9
    s_and_b32 s40, s44, 1
    s_lshl_b32 s40, s40, 3
    s_add_u32 s41, s41, s40
    s_add_u32 s41, s41, s42
    s_add_u32 s41, s41, 28672
    buffer_store_dwordx2 v[52:53], v6, s[4:7], s41 offen sc1
    s_branch Lprep_end
Lprep_wo:
    s_nop 0
    s_mov_b32 s8, s20
    s_mov_b32 s9, s21
    s_mov_b32 s10, 0x62000
    s_mov_b32 s11, 0x00020000
    s_sub_u32 s37, s2, 160
    s_lshl_b32 s42, s37, 2
    s_add_u32 s42, s42, s36
    s_and_b32 s40, s42, 15
    s_mul_i32 s40, s40, 25088
    s_lshr_b32 s37, s37, 2
    s_mul_i32 s42, s42, 7168
    s_add_u32 s42, s42, 1425408
    s_mov_b32 s45, 3
    s_branch Lprep_F
Lprep_wd:
    s_nop 0
    s_mov_b32 s8, s28
    s_mov_b32 s9, s29
    s_mov_b32 s10, 0x188000
    s_mov_b32 s11, 0x00020000
    s_sub_u32 s38, s2, 176
    s_mul_hi_u32 s37, s38, 0x12492493
    s_mul_i32 s40, s37, 14
    s_sub_u32 s40, s38, s40
    s_mul_i32 s42, s36, 14
    s_add_u32 s40, s40, s42
    s_mul_i32 s40, s40, 28672
    s_lshl_b32 s42, s38, 2
    s_add_u32 s42, s42, s36
    s_mul_i32 s42, s42, 7168
    s_add_u32 s42, s42, 5210112
    s_mov_b32 s45, 4
Lprep_F:
    s_nop 0
    s_mul_i32 s37, s37, 224
    s_add_u32 s40, s40, s37
    v_lshrrev_b32 v7, 4, v0
    v_mul_u32_u24 v7, 896, v7
    v_and_b32 v6, 15, v0
    v_lshl_add_u32 v7, v6, 4, v7
    s_mov_b32 s41, s46
    s_mov_b32 m0, s41
    s_nop 0
    buffer_load_dwordx4 v7, s[8:11], s40 offen lds
    s_add_u32 s40, s40, 3584
    s_add_u32 s41, s41, 1024
    s_mov_b32 m0, s41
    s_nop 0
    buffer_load_dwordx4 v7, s[8:11], s40 offen lds
    s_add_u32 s40, s40, 3584
    s_add_u32 s41, s41, 1024
    s_mov_b32 m0, s41
    s_nop 0
    buffer_load_dwordx4 v7, s[8:11], s40 offen lds
    s_add_u32 s40, s40, 3584
    s_add_u32 s41, s41, 1024
    s_mov_b32 m0, s41
    s_nop 0
    buffer_load_dwordx4 v7, s[8:11], s40 offen lds
    s_add_u32 s40, s40, 3584
    s_add_u32 s41, s41, 1024
    s_mov_b32 m0, s41
    s_nop 0
    buffer_load_dwordx4 v7, s[8:11], s40 offen lds
    s_add_u32 s40, s40, 3584
    s_add_u32 s41, s41, 1024
    s_mov_b32 m0, s41
    s_nop 0
    buffer_load_dwordx4 v7, s[8:11], s40 offen lds
    s_add_u32 s40, s40, 3584
    s_add_u32 s41, s41, 1024
    s_mov_b32 m0, s41
    s_nop 0
    buffer_load_dwordx4 v7, s[8:11], s40 offen lds
    s_add_u32 s40, s40, 3584
    s_add_u32 s41, s41, 1024
    s_mov_b32 m0, s41
    s_nop 0
    buffer_load_dwordx4 v7, s[8:11], s40 offen lds
    s_add_u32 s40, s40, 3584
    s_add_u32 s41, s41, 1024
    v_lshlrev_b32 v5, 4, v4
    v_bfe_u32 v6, v0, 4, 1
    v_lshl_add_u32 v5, v6, 2, v5
    v_bfe_u32 v6, v0, 2, 2
    v_add_u32 v5, v5, v6
    v_lshlrev_b32 v5, 8, v5
    v_and_b32 v6, 3, v0
    v_lshl_add_u32 v5, v6, 3, v5
    v_add_u32 v5, s46, v5
    s_waitcnt vmcnt(0)
    ds_read_b64_tr_b16 v[16:17], v5 offset:0
    ds_read_b64_tr_b16 v[18:19], v5 offset:2048
    ds_read_b64_tr_b16 v[20:21], v5 offset:32
    ds_read_b64_tr_b16 v[22:23], v5 offset:2080
    ds_read_b64_tr_b16 v[24:25], v5 offset:64
    ds_read_b64_tr_b16 v[26:27], v5 offset:2112
    ds_read_b64_tr_b16 v[28:29], v5 offset:96
    ds_read_b64_tr_b16 v[30:31], v5 offset:2144
    ds_read_b64_tr_b16 v[32:33], v5 offset:128
    ds_read_b64_tr_b16 v[34:35], v5 offset:2176
    ds_read_b64_tr_b16 v[36:37], v5 offset:160
    ds_read_b64_tr_b16 v[38:39], v5 offset:2208
    ds_read_b64_tr_b16 v[40:41], v5 offset:192
    ds_read_b64_tr_b16 v[42:43], v5 offset:2240
    s_waitcnt lgkmcnt(0)
    s_cmp_lg_u32 s45, 3
    s_cbranch_scc1 Lprep_z2
    s_mov_b32 s48, 0
    s_mov_b32 s49, 0xffff0000
    s_mov_b64 exec, s[48:49]
    v_mov_b32 v18, 0
    v_mov_b32 v19, 0
    v_mov_b32 v22, 0
    v_mov_b32 v23, 0
    v_mov_b32 v26, 0
    v_mov_b32 v27, 0
    v_mov_b32 v30, 0
    v_mov_b32 v31, 0
    v_mov_b32 v34, 0
    v_mov_b32 v35, 0
    v_mov_b32 v38, 0
    v_mov_b32 v39, 0
    v_mov_b32 v42, 0
    v_mov_b32 v43, 0
    s_mov_b64 exec, -1
Lprep_z2:
    s_nop 3
    buffer_store_dwordx4 v[16:19], v1, s[4:7], s42 offen offset:0 sc1
    buffer_store_dwordx4 v[20:23], v1, s[4:7], s42 offen offset:1024 sc1
    buffer_store_dwordx4 v[24:27], v1, s[4:7], s42 offen offset:2048 sc1
    buffer_store_dwordx4 v[28:31], v1, s[4:7], s42 offen offset:3072 sc1
    s_add_u32 s42, s42, 4096
    buffer_store_dwordx4 v[32:35], v1, s[4:7], s42 offen offset:0 sc1
    buffer_store_dwordx4 v[36:39], v1, s[4:7], s42 offen offset:1024 sc1
    buffer_store_dwordx4 v[40:43], v1, s[4:7], s42 offen offset:2048 sc1
    s_branch Lprep_end
Lprep_x:
    s_nop 0
    s_mov_b32 s8, s16
    s_mov_b32 s9, s17
    s_mov_b32 s10, 0x1c0000
    s_mov_b32 s11, 0x00020000
    s_sub_u32 s43, s2, 232
    v_mul_u32_u24 v7, 896, v3
    v_lshlrev_b32 v8, 4, v4
    v_add_u32 v7, v7, v8
    s_mul_i32 s40, s43, 28672
    s_mul_i32 s41, s36, 224
    s_add_u32 s40, s40, s41
    buffer_load_dwordx4 v[16:19], v7, s[8:11], s40 offen offset:0
    buffer_load_dwordx4 v[20:23], v7, s[8:11], s40 offen offset:32
    buffer_load_dwordx4 v[24:27], v7, s[8:11], s40 offen offset:64
    buffer_load_dwordx4 v[28:31], v7, s[8:11], s40 offen offset:96
    buffer_load_dwordx4 v[32:35], v7, s[8:11], s40 offen offset:128
    buffer_load_dwordx4 v[36:39], v7, s[8:11], s40 offen offset:160
    buffer_load_dwordx4 v[40:43], v7, s[8:11], s40 offen offset:192
    v_and_b32 v8, 31, v0
    v_lshlrev_b32 v8, 2, v8
    s_lshl_b32 s41, s43, 7
    s_add_u32 s41, s41, 35995648
    v_mov_b32 v9, 0
    buffer_store_dword v9, v8, s[4:7], s41 offen sc1
    s_mul_i32 s42, s43, 28672
    s_add_u32 s42, s42, s47
    s_add_u32 s42, s42, 6832128
    s_waitcnt vmcnt(0)
    buffer_store_dwordx4 v[16:19], v1, s[4:7], s42 offen offset:0 sc1
    buffer_store_dwordx4 v[20:23], v1, s[4:7], s42 offen offset:1024 sc1
    buffer_store_dwordx4 v[24:27], v1, s[4:7], s42 offen offset:2048 sc1
    buffer_store_dwordx4 v[28:31], v1, s[4:7], s42 offen offset:3072 sc1
    s_add_u32 s42, s42, 4096
    buffer_store_dwordx4 v[32:35], v1, s[4:7], s42 offen offset:0 sc1
    buffer_store_dwordx4 v[36:39], v1, s[4:7], s42 offen offset:1024 sc1
    buffer_store_dwordx4 v[40:43], v1, s[4:7], s42 offen offset:2048 sc1
    v_mov_b32 v10, 0
    v_mov_b32 v11, 0
    v_mov_b32 v9, 0x3f803f80
    v_dot2c_f32_bf16 v10, v16, v9
    v_dot2c_f32_bf16 v11, v16, v16
    v_dot2c_f32_bf16 v10, v17, v9
    v_dot2c_f32_bf16 v11, v17, v17
    v_dot2c_f32_bf16 v10, v18, v9
    v_dot2c_f32_bf16 v11, v18, v18
    v_dot2c_f32_bf16 v10, v19, v9
    v_dot2c_f32_bf16 v11, v19, v19
    v_dot2c_f32_bf16 v10, v20, v9
    v_dot2c_f32_bf16 v11, v20, v20
    v_dot2c_f32_bf16 v10, v21, v9
    v_dot2c_f32_bf16 v11, v21, v21
    v_dot2c_f32_bf16 v10, v22, v9
    v_dot2c_f32_bf16 v11, v22, v22
    v_dot2c_f32_bf16 v10, v23, v9
    v_dot2c_f32_bf16 v11, v23, v23
    v_dot2c_f32_bf16 v10, v24, v9
    v_dot2c_f32_bf16 v11, v24, v24
    v_dot2c_f32_bf16 v10, v25, v9
    v_dot2c_f32_bf16 v11, v25, v25
    v_dot2c_f32_bf16 v10, v26, v9
    v_dot2c_f32_bf16 v11, v26, v26
    v_dot2c_f32_bf16 v10, v27, v9
    v_dot2c_f32_bf16 v11, v27, v27
    v_dot2c_f32_bf16 v10, v28, v9
    v_dot2c_f32_bf16 v11, v28, v28
    v_dot2c_f32_bf16 v10, v29, v9
    v_dot2c_f32_bf16 v11, v29, v29
    v_dot2c_f32_bf16 v10, v30, v9
    v_dot2c_f32_bf16 v11, v30, v30
    v_dot2c_f32_bf16 v10, v31, v9
    v_dot2c_f32_bf16 v11, v31, v31
    v_dot2c_f32_bf16 v10, v32, v9
    v_dot2c_f32_bf16 v11, v32, v32
    v_dot2c_f32_bf16 v10, v33, v9
    v_dot2c_f32_bf16 v11, v33, v33
    v_dot2c_f32_bf16 v10, v34, v9
    v_dot2c_f32_bf16 v11, v34, v34
    v_dot2c_f32_bf16 v10, v35, v9
    v_dot2c_f32_bf16 v11, v35, v35
    v_dot2c_f32_bf16 v10, v36, v9
    v_dot2c_f32_bf16 v11, v36, v36
    v_dot2c_f32_bf16 v10, v37, v9
    v_dot2c_f32_bf16 v11, v37, v37
    v_dot2c_f32_bf16 v10, v38, v9
    v_dot2c_f32_bf16 v11, v38, v38
    v_dot2c_f32_bf16 v10, v39, v9
    v_dot2c_f32_bf16 v11, v39, v39
    v_dot2c_f32_bf16 v10, v40, v9
    v_dot2c_f32_bf16 v11, v40, v40
    v_dot2c_f32_bf16 v10, v41, v9
    v_dot2c_f32_bf16 v11, v41, v41
    v_dot2c_f32_bf16 v10, v42, v9
    v_dot2c_f32_bf16 v11, v42, v42
    v_dot2c_f32_bf16 v10, v43, v9
    v_dot2c_f32_bf16 v11, v43, v43
    s_nop 3
    v_mov_b32 v12, v10
    v_mov_b32 v13, v11
    s_nop 0
    v_permlane32_swap_b32 v10, v12
    v_permlane32_swap_b32 v11, v13
    v_add_f32 v10, v10, v12
    v_add_f32 v11, v11, v13
    v_lshlrev_b32 v8, 5, v3
    s_lshl_b32 s41, s43, 10
    s_lshl_b32 s40, s36, 3
    s_add_u32 s41, s41, s40
    s_add_u32 s41, s41, 8667136
    buffer_store_dwordx2 v[10:11], v8, s[4:7], s41 offen sc1
Lprep_end:
    s_endpgm
.section .rodata,"a"
.p2align 6
.amdhsa_kernel prep_kernel
  .amdhsa_next_free_vgpr 64
  .amdhsa_next_free_sgpr 102
  .amdhsa_accum_offset 64
  .amdhsa_group_segment_fixed_size 0
  .amdhsa_kernarg_size 80
  .amdhsa_user_sgpr_count 2
  .amdhsa_user_sgpr_kernarg_segment_ptr 1
  .amdhsa_system_sgpr_workgroup_id_x 1
.end_amdhsa_kernel
.text

.text
.globl main_kernel
.p2align 8
.type main_kernel,@function
main_kernel:
    s_cmp_ge_u32 s2, 256
    s_cbranch_scc1 Lmain_end
    s_load_dwordx2 s[30:31], s[0:1], 0
    s_load_dwordx2 s[32:33], s[0:1], 56
    s_load_dwordx4 s[52:55], s[0:1], 64
    v_lshrrev_b32 v4, 6, v0
    v_and_b32 v0, 63, v0
    v_readfirstlane_b32 s18, v4
    v_lshlrev_b32 v1, 4, v0
    s_and_b32 s16, s2, 7
    s_lshl_b32 s16, s16, 1
    s_lshr_b32 s42, s2, 7
    s_add_u32 s16, s16, s42
    s_lshr_b32 s17, s2, 3
    s_and_b32 s17, s17, 15
    s_lshr_b32 s19, s17, 2
    s_and_b32 s20, s17, 3
    s_and_b32 s29, s18, 3
    s_lshl_b32 s43, s18, 2
    s_xor_b32 s44, s43, 16
    s_add_u32 s43, s43, 148992
    s_add_u32 s44, s44, 148992
    v_mov_b32 v126, s43
    v_mov_b32 v5, 0
    ds_write_b32 v126, v5
    s_getreg_b32 s45, hwreg(HW_REG_XCC_ID)
    s_and_b32 s45, s45, 15
    s_add_u32 s45, s45, 1
    s_waitcnt lgkmcnt(0)
    s_mov_b32 s4, s54
    s_mov_b32 s5, s55
    s_mov_b32 s6, 0x10000000
    s_mov_b32 s7, 0x00020000
    s_mov_b32 s8, s30
    s_mov_b32 s9, s31
    s_mov_b32 s10, 0x1c0000
    s_mov_b32 s11, 0x00020000
    s_mov_b32 s12, s32
    s_mov_b32 s13, s33
    s_mov_b32 s14, 0x1c0000
    s_mov_b32 s15, 0x00020000
    s_mov_b32 s36, s52
    s_mov_b32 s37, s53
    s_mov_b32 s38, 0x100
    s_mov_b32 s39, 0x00020000
    s_barrier
    s_cmp_ge_u32 s18, 4
    s_cbranch_scc1 Lhelper
    s_setprio 3
    v_add_u32 v2, 0x10000, v1
    v_add_u32 v3, 0x20000, v1
    s_lshl_b32 s21, s16, 2
    s_add_u32 s26, s21, s18
    s_add_u32 s27, s21, s19
    s_mul_i32 s47, s26, 28672
    s_add_u32 s47, s47, 6832128
    s_lshl_b32 s23, s26, 10
    s_add_u32 s23, s23, 8667136
    v_and_b32 v4, 31, v0
    v_lshlrev_b32 v4, 5, v4
    buffer_load_dwordx4 a[0:3], v1, s[4:7], s47 offen offset:0
    buffer_load_dwordx4 a[4:7], v1, s[4:7], s47 offen offset:1024
    buffer_load_dwordx4 a[8:11], v1, s[4:7], s47 offen offset:2048
    buffer_load_dwordx4 a[12:15], v1, s[4:7], s47 offen offset:3072
    s_add_u32 s47, s47, 4096
    buffer_load_dwordx4 a[16:19], v1, s[4:7], s47 offen offset:0
    buffer_load_dwordx4 a[20:23], v1, s[4:7], s47 offen offset:1024
    buffer_load_dwordx4 v[96:99], v4, s[4:7], s23 offen
    buffer_load_dwordx4 v[100:103], v4, s[4:7], s23 offen offset:16
    buffer_load_dwordx4 a[24:27], v1, s[4:7], s47 offen offset:2048
    buffer_load_dwordx4 a[28:31], v1, s[4:7], s47 offen offset:3072
    s_add_u32 s47, s47, 4096
    buffer_load_dwordx4 a[32:35], v1, s[4:7], s47 offen offset:0
    buffer_load_dwordx4 a[36:39], v1, s[4:7], s47 offen offset:1024
    buffer_load_dwordx4 a[40:43], v1, s[4:7], s47 offen offset:2048
    buffer_load_dwordx4 a[44:47], v1, s[4:7], s47 offen offset:3072
    s_add_u32 s47, s47, 4096
    buffer_load_dwordx4 a[48:51], v1, s[4:7], s47 offen offset:0
    buffer_load_dwordx4 a[52:55], v1, s[4:7], s47 offen offset:1024
    buffer_load_dwordx4 a[56:59], v1, s[4:7], s47 offen offset:2048
    buffer_load_dwordx4 a[60:63], v1, s[4:7], s47 offen offset:3072
    s_add_u32 s47, s47, 4096
    buffer_load_dwordx4 a[64:67], v1, s[4:7], s47 offen offset:0
    buffer_load_dwordx4 a[68:71], v1, s[4:7], s47 offen offset:1024
    buffer_load_dwordx4 a[72:75], v1, s[4:7], s47 offen offset:2048
    buffer_load_dwordx4 a[76:79], v1, s[4:7], s47 offen offset:3072
    s_add_u32 s47, s47, 4096
    buffer_load_dwordx4 a[80:83], v1, s[4:7], s47 offen offset:0
    buffer_load_dwordx4 a[84:87], v1, s[4:7], s47 offen offset:1024
    buffer_load_dwordx4 a[88:91], v1, s[4:7], s47 offen offset:2048
    buffer_load_dwordx4 a[92:95], v1, s[4:7], s47 offen offset:3072
    s_add_u32 s47, s47, 4096
    buffer_load_dwordx4 a[96:99], v1, s[4:7], s47 offen offset:0
    buffer_load_dwordx4 a[100:103], v1, s[4:7], s47 offen offset:1024
    buffer_load_dwordx4 a[104:107], v1, s[4:7], s47 offen offset:2048
    buffer_load_dwordx4 a[108:111], v1, s[4:7], s47 offen offset:3072
    v_mov_b32 v125, 1
    ds_write_b32 v126, v125
    s_lshl_b32 s21, s16, 8
    s_add_u32 s21, s21, 35995648
    s_lshl_b32 s22, s17, 4
    s_add_u32 s28, s21, s22
    s_lshl_b32 s23, s18, 2
    s_add_u32 s28, s28, s23
    s_lshl_b32 s24, s19, 2
    v_and_b32 v4, 15, v0
    v_lshlrev_b32 v4, 2, v4
    s_lshl_b32 s22, s18, 6
    s_add_u32 s22, s21, s22
    v_add_u32 v6, s22, v4
    v_accvgpr_write_b32 a124, v6
    v_and_b32 v4, 3, v0
    v_lshlrev_b32 v5, 4, v4
    s_add_u32 s22, s22, s24
    v_add_u32 v6, s22, v5
    v_accvgpr_write_b32 a125, v6
    v_and_b32 v4, 15, v0
    v_mul_u32_u24 v4, 464, v4
    v_lshrrev_b32 v5, 4, v0
    v_lshl_add_u32 v4, v5, 4, v4
    s_mul_i32 s21, s18, 14848
    s_add_u32 s21, s21, 89088
    v_add_u32 v121, s21, v4
    v_lshrrev_b32 v4, 3, v0
    s_lshl_b32 s21, s18, 3
    v_add_u32 v4, s21, v4
    v_and_b32 v5, 7, v0
    v_min_u32 v5, 6, v5
    v_mul_u32_u24 v6, 464, v4
    v_lshl_add_u32 v6, v5, 6, v6
    v_add_u32 v120, 89088, v6
    s_mul_i32 s21, s27, 28672
    s_mul_i32 s22, s20, 7168
    s_add_u32 s21, s21, s22
    v_lshlrev_b32 v6, 10, v5
    v_lshl_add_u32 v6, v4, 4, v6
    v_add_u32 v122, s21, v6
    s_lshl_b32 s21, s27, 5
    v_add_u32 v6, s21, v4
    v_mul_u32_u24 v7, 896, v6
    v_lshl_add_u32 v7, v5, 5, v7
    s_mul_i32 s22, s20, 224
    v_add_u32 v123, s22, v7
    v_lshlrev_b32 v7, 5, v6
    s_lshl_b32 s22, s20, 3
    v_add_u32 v124, s22, v7
    v_and_b32 v4, 15, v0
    v_lshlrev_b32 v4, 4, v4
    v_lshrrev_b32 v5, 5, v0
    v_lshl_add_u32 v4, v5, 8, v4
    v_bfe_u32 v5, v0, 4, 1
    v_lshl_add_u32 v127, v5, 14, v4
    buffer_load_dwordx4 v[108:111], v123, s[8:11], 0 offen offset:0
    buffer_load_dwordx4 v[112:115], v123, s[8:11], 0 offen offset:16
    v_mov_b32 v116, 149008
    ds_read_b128 v[116:119], v116
    s_waitcnt lgkmcnt(0)
    v_min3_u32 v116, v116, v117, v118
    v_min_u32 v116, v116, v119
    v_cmp_gt_u32 vcc, 1, v116
    s_nop 1
    s_cbranch_vccz Lc85d
    s_nop 1
    s_mov_b32 s25, 2000000
Lc85:
    s_nop 0
    s_sleep 1
    v_mov_b32 v116, 149008
    ds_read_b128 v[116:119], v116
    s_waitcnt lgkmcnt(0)
    v_min3_u32 v116, v116, v117, v118
    v_min_u32 v116, v116, v119
    v_cmp_gt_u32 vcc, 1, v116
    s_nop 1
    s_cbranch_vccz Lc85d
    s_sub_u32 s25, s25, 1
    s_cmp_lg_u32 s25, 0
    s_cbranch_scc1 Lc85
    s_nop 0
Lc85d:
    ds_read_b128 v[64:67], v1 offset:29696
    ds_read_b128 v[68:71], v1 offset:59392
    ds_read_b128 v[72:75], v1 offset:30720
    ds_read_b128 v[76:79], v1 offset:60416
    ds_read_b128 a[116:119], v1 offset:31744
    s_waitcnt vmcnt(31)
    s_waitcnt lgkmcnt(4)
    v_mfma_f32_32x32x16_bf16 v[32:47], v[64:67], a[0:3], 0
    ds_read_b128 a[120:123], v1 offset:61440
    s_waitcnt lgkmcnt(4)
    v_mfma_f32_32x32x16_bf16 v[48:63], a[0:3], v[68:71], 0
    ds_read_b128 v[64:67], v1 offset:32768
    s_waitcnt vmcnt(30)
    s_waitcnt lgkmcnt(4)
    v_mfma_f32_32x32x16_bf16 v[32:47], v[72:75], a[4:7], v[32:47]
    ds_read_b128 v[68:71], v1 offset:62464
    s_waitcnt lgkmcnt(4)
    v_mfma_f32_32x32x16_bf16 v[48:63], a[4:7], v[76:79], v[48:63]
    ds_read_b128 v[72:75], v1 offset:33792
    s_waitcnt vmcnt(29)
    s_waitcnt lgkmcnt(4)
    v_mfma_f32_32x32x16_bf16 v[32:47], a[116:119], a[8:11], v[32:47]
    ds_read_b128 v[76:79], v1 offset:63488
    s_waitcnt lgkmcnt(4)
    v_mfma_f32_32x32x16_bf16 v[48:63], a[8:11], a[120:123], v[48:63]
    ds_read_b128 a[116:119], v1 offset:34816
    s_waitcnt vmcnt(28)
    s_waitcnt lgkmcnt(4)
    v_mfma_f32_32x32x16_bf16 v[32:47], v[64:67], a[12:15], v[32:47]
    ds_read_b128 a[120:123], v1 offset:64512
    s_waitcnt lgkmcnt(4)
    v_mfma_f32_32x32x16_bf16 v[48:63], a[12:15], v[68:71], v[48:63]
    ds_read_b128 v[64:67], v1 offset:35840
    s_waitcnt vmcnt(27)
    s_waitcnt lgkmcnt(4)
    v_mfma_f32_32x32x16_bf16 v[32:47], v[72:75], a[16:19], v[32:47]
    ds_read_b128 v[68:71], v2 offset:0
    v_mov_b32 v116, 149008
    ds_read_b128 v[116:119], v116
    s_waitcnt lgkmcnt(5)
    v_mfma_f32_32x32x16_bf16 v[48:63], a[16:19], v[76:79], v[48:63]
    ds_read_b128 v[72:75], v1 offset:36864
    s_waitcnt vmcnt(26)
    s_waitcnt lgkmcnt(5)
    v_mfma_f32_32x32x16_bf16 v[32:47], a[116:119], a[20:23], v[32:47]
    ds_read_b128 v[76:79], v2 offset:1024
    s_waitcnt lgkmcnt(5)
    v_mfma_f32_32x32x16_bf16 v[48:63], a[20:23], a[120:123], v[48:63]
    s_waitcnt lgkmcnt(2)
    v_min3_u32 v116, v116, v117, v118
    v_min_u32 v116, v116, v119
    v_cmp_gt_u32 vcc, 2, v116
    s_nop 1
    s_cbranch_vccz Lc86d
    s_nop 4
    s_mov_b32 s25, 2000000
Lc86:
    s_nop 0
    s_sleep 1
    v_mov_b32 v116, 149008
    ds_read_b128 v[116:119], v116
    s_waitcnt lgkmcnt(0)
    v_min3_u32 v116, v116, v117, v118
    v_min_u32 v116, v116, v119
    v_cmp_gt_u32 vcc, 2, v116
    s_nop 1
    s_cbranch_vccz Lc86d
    s_sub_u32 s25, s25, 1
    s_cmp_lg_u32 s25, 0
    s_cbranch_scc1 Lc86
    s_nop 0
Lc86d:
    ds_read_b128 a[116:119], v1 offset:37888
    s_waitcnt vmcnt(23)
    v_mfma_f32_32x32x16_bf16 v[32:47], v[64:67], a[24:27], v[32:47]
    ds_read_b128 a[120:123], v2 offset:2048
    v_mfma_f32_32x32x16_bf16 v[48:63], a[24:27], v[68:71], v[48:63]
    ds_read_b128 v[64:67], v1 offset:38912
    s_waitcnt vmcnt(22)
    s_waitcnt lgkmcnt(4)
    v_mfma_f32_32x32x16_bf16 v[32:47], v[72:75], a[28:31], v[32:47]
    ds_read_b128 v[68:71], v2 offset:3072
    s_waitcnt lgkmcnt(4)
    v_mfma_f32_32x32x16_bf16 v[48:63], a[28:31], v[76:79], v[48:63]
    ds_read_b128 v[72:75], v1 offset:39936
    s_waitcnt vmcnt(21)
    s_waitcnt lgkmcnt(4)
    v_mfma_f32_32x32x16_bf16 v[32:47], a[116:119], a[32:35], v[32:47]
    ds_read_b128 v[76:79], v2 offset:4096
    s_waitcnt lgkmcnt(4)
    v_mfma_f32_32x32x16_bf16 v[48:63], a[32:35], a[120:123], v[48:63]
    ds_read_b128 a[116:119], v1 offset:40960
    s_waitcnt vmcnt(20)
    s_waitcnt lgkmcnt(4)
    v_mfma_f32_32x32x16_bf16 v[32:47], v[64:67], a[36:39], v[32:47]
    ds_read_b128 a[120:123], v2 offset:5120
    s_waitcnt lgkmcnt(4)
    v_mfma_f32_32x32x16_bf16 v[48:63], a[36:39], v[68:71], v[48:63]
    ds_read_b128 v[64:67], v1 offset:41984
    s_waitcnt vmcnt(19)
    s_waitcnt lgkmcnt(4)
    v_mfma_f32_32x32x16_bf16 v[32:47], v[72:75], a[40:43], v[32:47]
    ds_read_b128 v[68:71], v2 offset:6144
    s_waitcnt lgkmcnt(4)
    v_mfma_f32_32x32x16_bf16 v[48:63], a[40:43], v[76:79], v[48:63]
    ds_read_b128 v[72:75], v1 offset:43008
    s_waitcnt vmcnt(18)
    s_waitcnt lgkmcnt(4)
    v_mfma_f32_32x32x16_bf16 v[32:47], a[116:119], a[44:47], v[32:47]
    ds_read_b128 v[76:79], v2 offset:7168
    s_waitcnt lgkmcnt(4)
    v_mfma_f32_32x32x16_bf16 v[48:63], a[44:47], a[120:123], v[48:63]
    ds_read_b128 a[116:119], v1 offset:44032
    s_waitcnt vmcnt(17)
    s_waitcnt lgkmcnt(4)
    v_mfma_f32_32x32x16_bf16 v[32:47], v[64:67], a[48:51], v[32:47]
    ds_read_b128 a[120:123], v2 offset:8192
    v_mov_b32 v116, 149008
    ds_read_b128 v[116:119], v116
    v_add_f32 v96, v96, v98
    v_add_f32 v100, v100, v102
    v_add_f32 v97, v97, v99
    v_add_f32 v101, v101, v103
    s_waitcnt lgkmcnt(5)
    v_mfma_f32_32x32x16_bf16 v[48:63], a[48:51], v[68:71], v[48:63]
    ds_read_b128 v[64:67], v1 offset:45056
    v_add_f32 v96, v96, v100
    v_add_f32 v97, v97, v101
    v_mul_f32 v96, 0x3b124925, v96
    v_mul_f32 v97, 0x3b124925, v97
    s_waitcnt vmcnt(16)
    s_waitcnt lgkmcnt(5)
    v_mfma_f32_32x32x16_bf16 v[32:47], v[72:75], a[52:55], v[32:47]
    ds_read_b128 v[68:71], v2 offset:9216
    v_fma_f32 v97, -v96, v96, v97
    v_max_f32 v97, 0, v97
    v_cvt_pk_bf16_f32 v97, v97, v97
    v_lshlrev_b32 v97, 16, v97
    s_waitcnt lgkmcnt(5)
    v_mfma_f32_32x32x16_bf16 v[48:63], a[52:55], v[76:79], v[48:63]
    s_waitcnt lgkmcnt(2)
    v_min3_u32 v116, v116, v117, v118
    v_min_u32 v116, v116, v119
    v_cmp_gt_u32 vcc, 3, v116
    s_nop 1
    s_cbranch_vccz Lc87d
    s_nop 4
    s_mov_b32 s25, 2000000
Lc87:
    s_nop 0
    s_sleep 1
    v_mov_b32 v116, 149008
    ds_read_b128 v[116:119], v116
    s_waitcnt lgkmcnt(0)
    v_min3_u32 v116, v116, v117, v118
    v_min_u32 v116, v116, v119
    v_cmp_gt_u32 vcc, 3, v116
    s_nop 1
    s_cbranch_vccz Lc87d
    s_sub_u32 s25, s25, 1
    s_cmp_lg_u32 s25, 0
    s_cbranch_scc1 Lc87
    s_nop 0
Lc87d:
    ds_read_b128 v[72:75], v1 offset:46080
    v_add_f32 v97, 0x3727c5ac, v97
    v_cvt_pk_bf16_f32 v97, v97, v97
    v_lshlrev_b32 v97, 16, v97
    v_sqrt_f32 v97, v97
    s_waitcnt vmcnt(15)
    v_mfma_f32_32x32x16_bf16 v[32:47], a[116:119], a[56:59], v[32:47]
    ds_read_b128 v[76:79], v2 offset:10240
    v_sub_f32 v96, 0, v96
    v_cvt_pk_bf16_f32 v105, v97, v97
    v_lshlrev_b32 v105, 16, v105
    v_rcp_f32 v104, v105
    v_mfma_f32_32x32x16_bf16 v[48:63], a[56:59], a[120:123], v[48:63]
    ds_read_b128 a[116:119], v1 offset:47104
    v_cvt_pk_bf16_f32 v98, v96, v96
    v_and_b32 v99, 0xffff, v98
    v_accvgpr_write_b32 a112, v98
    v_accvgpr_write_b32 a113, v99
    s_waitcnt vmcnt(14)
    s_waitcnt lgkmcnt(4)
    v_mfma_f32_32x32x16_bf16 v[32:47], v[64:67], a[60:63], v[32:47]
    ds_read_b128 a[120:123], v2 offset:11264
    v_accvgpr_write_b32 a114, v98
    v_accvgpr_write_b32 a115, v99
    v_and_b32 v4, 31, v0
    v_lshlrev_b32 v4, 2, v4
    s_waitcnt lgkmcnt(4)
    v_mfma_f32_32x32x16_bf16 v[48:63], a[60:63], v[68:71], v[48:63]
    ds_read_b128 v[64:67], v1 offset:48128
    s_lshl_b32 s23, s18, 7
    s_add_u32 s23, s23, 148480
    v_add_u32 v4, s23, v4
    ds_write_b32 v4, v104
    s_waitcnt vmcnt(13)
    s_waitcnt lgkmcnt(5)
    v_mfma_f32_32x32x16_bf16 v[32:47], v[72:75], a[64:67], v[32:47]
    ds_read_b128 v[68:71], v2 offset:12288
    v_lshrrev_b32 v5, 5, v0
    v_lshlrev_b32 v5, 4, v5
    v_add_u32 v5, s23, v5
    ds_read_b128 v[80:83], v5 offset:0
    s_waitcnt lgkmcnt(6)
    v_mfma_f32_32x32x16_bf16 v[48:63], a[64:67], v[76:79], v[48:63]
    ds_read_b128 v[72:75], v1 offset:49152
    ds_read_b128 v[84:87], v5 offset:32
    ds_read_b128 v[88:91], v5 offset:64
    ds_read_b128 v[92:95], v5 offset:96
    s_lshl_b32 s21, s16, 4
    s_waitcnt vmcnt(12)
    s_waitcnt lgkmcnt(9)
    v_mfma_f32_32x32x16_bf16 v[32:47], a[116:119], a[68:71], v[32:47]
    ds_read_b128 v[76:79], v2 offset:13312
    s_add_u32 s21, s21, s17
    s_lshl_b32 s21, s21, 2
    s_add_u32 s21, s21, s18
    s_lshl_b32 s21, s21, 12
    s_waitcnt lgkmcnt(9)
    v_mfma_f32_32x32x16_bf16 v[48:63], a[68:71], a[120:123], v[48:63]
    ds_read_b128 a[116:119], v1 offset:50176
    s_add_u32 s24, s21, 8732672
    s_lshl_b32 s22, s18, 12
    v_add_u32 v6, s22, v2
    v_mov_b32 v7, -2
    s_waitcnt vmcnt(11)
    s_waitcnt lgkmcnt(9)
    v_mfma_f32_32x32x16_bf16 v[32:47], v[64:67], a[72:75], v[32:47]
    ds_read_b128 a[120:123], v2 offset:14336
    s_waitcnt lgkmcnt(8)
    v_mfma_f32_32x32x16_bf16 v[48:63], a[72:75], v[68:71], v[48:63]
    ds_read_b128 v[64:67], v1 offset:51200
    s_waitcnt vmcnt(10)
    s_waitcnt lgkmcnt(7)
    v_mfma_f32_32x32x16_bf16 v[32:47], v[72:75], a[76:79], v[32:47]
    ds_read_b128 v[68:71], v2 offset:15360
    s_waitcnt lgkmcnt(4)
    v_mfma_f32_32x32x16_bf16 v[48:63], a[76:79], v[76:79], v[48:63]
    ds_read_b128 v[72:75], v1 offset:52224
    s_waitcnt vmcnt(9)
    s_waitcnt lgkmcnt(4)
    v_mfma_f32_32x32x16_bf16 v[32:47], a[116:119], a[80:83], v[32:47]
    ds_read_b128 v[76:79], v2 offset:16384
    v_mov_b32 v116, 149008
    ds_read_b128 v[116:119], v116
    s_waitcnt lgkmcnt(5)
    v_mfma_f32_32x32x16_bf16 v[48:63], a[80:83], a[120:123], v[48:63]
    ds_read_b128 a[116:119], v1 offset:53248
    s_waitcnt vmcnt(8)
    s_waitcnt lgkmcnt(5)
    v_mfma_f32_32x32x16_bf16 v[32:47], v[64:67], a[84:87], v[32:47]
    ds_read_b128 a[120:123], v2 offset:17408
    s_waitcnt lgkmcnt(5)
    v_mfma_f32_32x32x16_bf16 v[48:63], a[84:87], v[68:71], v[48:63]
    s_waitcnt lgkmcnt(2)
    v_min3_u32 v116, v116, v117, v118
    v_min_u32 v116, v116, v119
    v_cmp_gt_u32 vcc, 4, v116
    s_nop 1
    s_cbranch_vccz Lc88d
    s_nop 4
    s_mov_b32 s25, 2000000
Lc88:
    s_nop 0
    s_sleep 1
    v_mov_b32 v116, 149008
    ds_read_b128 v[116:119], v116
    s_waitcnt lgkmcnt(0)
    v_min3_u32 v116, v116, v117, v118
    v_min_u32 v116, v116, v119
    v_cmp_gt_u32 vcc, 4, v116
    s_nop 1
    s_cbranch_vccz Lc88d
    s_sub_u32 s25, s25, 1
    s_cmp_lg_u32 s25, 0
    s_cbranch_scc1 Lc88
    s_nop 0
Lc88d:
    ds_read_b128 v[64:67], v1 offset:54272
    s_waitcnt vmcnt(7)
    v_mfma_f32_32x32x16_bf16 v[32:47], v[72:75], a[88:91], v[32:47]
    ds_read_b128 v[68:71], v2 offset:18432
    v_mfma_f32_32x32x16_bf16 v[48:63], a[88:91], v[76:79], v[48:63]
    ds_read_b128 v[72:75], v1 offset:55296
    s_waitcnt vmcnt(6)
    s_waitcnt lgkmcnt(4)
    v_mfma_f32_32x32x16_bf16 v[32:47], a[116:119], a[92:95], v[32:47]
    ds_read_b128 v[76:79], v2 offset:19456
    s_waitcnt lgkmcnt(4)
    v_mfma_f32_32x32x16_bf16 v[48:63], a[92:95], a[120:123], v[48:63]
    ds_read_b128 a[116:119], v1 offset:56320
    s_waitcnt vmcnt(5)
    s_waitcnt lgkmcnt(4)
    v_mfma_f32_32x32x16_bf16 v[32:47], v[64:67], a[96:99], v[32:47]
    ds_read_b128 a[120:123], v2 offset:20480
    s_waitcnt lgkmcnt(4)
    v_mfma_f32_32x32x16_bf16 v[48:63], a[96:99], v[68:71], v[48:63]
    ds_read_b128 v[64:67], v1 offset:57344
    s_waitcnt vmcnt(4)
    s_waitcnt lgkmcnt(4)
    v_mfma_f32_32x32x16_bf16 v[32:47], v[72:75], a[100:103], v[32:47]
    ds_read_b128 v[68:71], v2 offset:21504
    v_mov_b32 v116, 149008
    ds_read_b128 v[116:119], v116
    s_waitcnt lgkmcnt(5)
    v_mfma_f32_32x32x16_bf16 v[48:63], a[100:103], v[76:79], v[48:63]
    ds_read_b128 v[72:75], v1 offset:58368
    s_waitcnt vmcnt(3)
    s_waitcnt lgkmcnt(5)
    v_mfma_f32_32x32x16_bf16 v[32:47], a[116:119], a[104:107], v[32:47]
    ds_read_b128 v[76:79], v2 offset:22528
    s_waitcnt lgkmcnt(5)
    v_mfma_f32_32x32x16_bf16 v[48:63], a[104:107], a[120:123], v[48:63]
    s_waitcnt lgkmcnt(2)
    v_min3_u32 v116, v116, v117, v118
    v_min_u32 v116, v116, v119
    v_cmp_gt_u32 vcc, 5, v116
    s_nop 1
    s_cbranch_vccz Lc89d
    s_nop 4
    s_mov_b32 s25, 2000000
Lc89:
    s_nop 0
    s_sleep 1
    v_mov_b32 v116, 149008
    ds_read_b128 v[116:119], v116
    s_waitcnt lgkmcnt(0)
    v_min3_u32 v116, v116, v117, v118
    v_min_u32 v116, v116, v119
    v_cmp_gt_u32 vcc, 5, v116
    s_nop 1
    s_cbranch_vccz Lc89d
    s_sub_u32 s25, s25, 1
    s_cmp_lg_u32 s25, 0
    s_cbranch_scc1 Lc89
    s_nop 0
Lc89d:
    ds_read_b128 a[116:119], v1 offset:0
    s_waitcnt vmcnt(2)
    v_mfma_f32_32x32x16_bf16 v[32:47], v[64:67], a[108:111], v[32:47]
    ds_read_b128 a[120:123], v1 offset:1024
    v_mfma_f32_32x32x16_bf16 v[48:63], a[108:111], v[68:71], v[48:63]
    ds_read_b128 v[64:67], v1 offset:2048
    s_waitcnt lgkmcnt(4)
    v_mfma_f32_32x32x16_bf16 v[32:47], v[72:75], a[112:115], v[32:47]
    ds_read_b128 v[68:71], v1 offset:3072
    s_waitcnt lgkmcnt(4)
    v_mfma_f32_32x32x16_bf16 v[48:63], a[112:115], v[76:79], v[48:63]
    ds_read_b128 v[72:75], v1 offset:4096
    s_waitcnt lgkmcnt(4)
    v_mfma_f32_32x32x16_bf16 v[16:31], a[116:119], a[0:3], 0
    ds_read_b128 v[76:79], v1 offset:5120
    s_waitcnt lgkmcnt(4)
    v_mfma_f32_32x32x16_bf16 v[16:31], a[120:123], a[4:7], v[16:31]
    ds_read_b128 a[116:119], v1 offset:6144
    s_nop 1
    v_mul_f32 v32, v32, v104
    v_mul_f32 v33, v33, v104
    v_mul_f32 v34, v34, v104
    v_mul_f32 v35, v35, v104
    v_mul_f32 v36, v36, v104
    s_waitcnt lgkmcnt(4)
    v_mfma_f32_32x32x16_bf16 v[16:31], v[64:67], a[8:11], v[16:31]
    ds_read_b128 a[120:123], v1 offset:7168
    v_mul_f32 v37, v37, v104
    v_mul_f32 v38, v38, v104
    v_mul_f32 v39, v39, v104
    v_mul_f32 v40, v40, v104
    v_mul_f32 v41, v41, v104
    s_waitcnt lgkmcnt(4)
    v_mfma_f32_32x32x16_bf16 v[16:31], v[68:71], a[12:15], v[16:31]
    ds_read_b128 v[64:67], v1 offset:8192
    v_mul_f32 v42, v42, v104
    v_mul_f32 v43, v43, v104
    v_mul_f32 v44, v44, v104
    v_mul_f32 v45, v45, v104
    v_mul_f32 v46, v46, v104
    s_waitcnt lgkmcnt(4)
    v_mfma_f32_32x32x16_bf16 v[16:31], v[72:75], a[16:19], v[16:31]
    ds_read_b128 v[68:71], v1 offset:9216
    v_mul_f32 v47, v47, v104
    v_cvt_pk_bf16_f32 v8, v32, v33
    v_cvt_pk_bf16_f32 v9, v34, v35
    v_cvt_pk_bf16_f32 v10, v36, v37
    v_cvt_pk_bf16_f32 v11, v38, v39
    s_waitcnt lgkmcnt(4)
    v_mfma_f32_32x32x16_bf16 v[16:31], v[76:79], a[20:23], v[16:31]
    ds_read_b128 v[72:75], v1 offset:10240
    v_cvt_pk_bf16_f32 v12, v40, v41
    v_cvt_pk_bf16_f32 v13, v42, v43
    v_cvt_pk_bf16_f32 v14, v44, v45
    v_cvt_pk_bf16_f32 v15, v46, v47
    v_min_u32 v8, v8, v7
    s_waitcnt lgkmcnt(4)
    v_mfma_f32_32x32x16_bf16 v[16:31], a[116:119], a[24:27], v[16:31]
    ds_read_b128 v[76:79], v1 offset:11264
    v_min_u32 v9, v9, v7
    v_min_u32 v10, v10, v7
    v_min_u32 v11, v11, v7
    v_min_u32 v12, v12, v7
    v_min_u32 v13, v13, v7
    s_waitcnt lgkmcnt(4)
    v_mfma_f32_32x32x16_bf16 v[16:31], a[120:123], a[28:31], v[16:31]
    ds_read_b128 a[116:119], v1 offset:12288
    v_min_u32 v14, v14, v7
    v_min_u32 v15, v15, v7
    buffer_store_dwordx4 v[8:11], v1, s[4:7], s24 offen offset:0 sc1
    buffer_store_dwordx4 v[12:15], v1, s[4:7], s24 offen offset:1024 sc1
    s_waitcnt lgkmcnt(4)
    v_mfma_f32_32x32x16_bf16 v[16:31], v[64:67], a[32:35], v[16:31]
    ds_read_b128 a[120:123], v1 offset:13312
    v_mul_f32 v48, v48, v80
    v_mul_f32 v49, v49, v81
    v_mul_f32 v50, v50, v82
    v_mul_f32 v51, v51, v83
    v_mul_f32 v52, v52, v84
    s_waitcnt lgkmcnt(4)
    v_mfma_f32_32x32x16_bf16 v[16:31], v[68:71], a[36:39], v[16:31]
    ds_read_b128 v[64:67], v1 offset:14336
    v_mul_f32 v53, v53, v85
    v_mul_f32 v54, v54, v86
    v_mul_f32 v55, v55, v87
    v_mul_f32 v56, v56, v88
    v_mul_f32 v57, v57, v89
    s_waitcnt lgkmcnt(4)
    v_mfma_f32_32x32x16_bf16 v[16:31], v[72:75], a[40:43], v[16:31]
    ds_read_b128 v[68:71], v1 offset:15360
    v_mul_f32 v58, v58, v90
    v_mul_f32 v59, v59, v91
    v_mul_f32 v60, v60, v92
    v_mul_f32 v61, v61, v93
    v_mul_f32 v62, v62, v94
    s_waitcnt lgkmcnt(4)
    v_mfma_f32_32x32x16_bf16 v[16:31], v[76:79], a[44:47], v[16:31]
    ds_read_b128 v[72:75], v1 offset:16384
    v_mul_f32 v63, v63, v95
    v_cvt_pk_bf16_f32 v32, v48, v49
    v_cvt_pk_bf16_f32 v33, v50, v51
    v_cvt_pk_bf16_f32 v34, v52, v53
    v_cvt_pk_bf16_f32 v35, v54, v55
    s_waitcnt lgkmcnt(4)
    v_mfma_f32_32x32x16_bf16 v[16:31], a[116:119], a[48:51], v[16:31]
    ds_read_b128 v[76:79], v1 offset:17408
    v_cvt_pk_bf16_f32 v36, v56, v57
    v_cvt_pk_bf16_f32 v37, v58, v59
    v_cvt_pk_bf16_f32 v38, v60, v61
    v_cvt_pk_bf16_f32 v39, v62, v63
    v_min_u32 v32, v32, v7
    s_waitcnt lgkmcnt(4)
    v_mfma_f32_32x32x16_bf16 v[16:31], a[120:123], a[52:55], v[16:31]
    ds_read_b128 a[116:119], v1 offset:18432
    v_min_u32 v33, v33, v7
    v_min_u32 v34, v34, v7
    v_min_u32 v35, v35, v7
    v_min_u32 v36, v36, v7
    v_min_u32 v37, v37, v7
    s_waitcnt lgkmcnt(4)
    v_mfma_f32_32x32x16_bf16 v[16:31], v[64:67], a[56:59], v[16:31]
    ds_read_b128 a[120:123], v1 offset:19456
    v_min_u32 v38, v38, v7
    v_min_u32 v39, v39, v7
    s_mov_b32 s40, 0x10000000
    s_mov_b32 s41, 0x10000000
    s_mov_b64 exec, s[40:41]
    v_mov_b32 v32, 0x3f803f80
    v_mov_b32 v33, 0x3f803f80
    v_mov_b32 v34, 0x3f803f80
    v_mov_b32 v35, 0x3f803f80
    v_mov_b32 v36, 0x3f803f80
    v_mov_b32 v37, 0x3f803f80
    v_mov_b32 v38, 0x3f803f80
    v_mov_b32 v39, 0x3f803f80
    s_mov_b64 exec, -1
    buffer_store_dwordx4 v[32:35], v1, s[4:7], s24 offen offset:2048 sc1
    buffer_store_dwordx4 v[36:39], v1, s[4:7], s24 offen offset:3072 sc1
    s_waitcnt lgkmcnt(4)
    v_mfma_f32_32x32x16_bf16 v[16:31], v[68:71], a[60:63], v[16:31]
    ds_read_b128 v[64:67], v1 offset:20480
    ds_write_b128 v6, v[8:11] offset:56320
    ds_write_b128 v6, v[12:15] offset:57344
    ds_write_b128 v6, v[32:35] offset:58368
    ds_write_b128 v6, v[36:39] offset:59392
    s_waitcnt lgkmcnt(8)
    v_mfma_f32_32x32x16_bf16 v[16:31], v[72:75], a[64:67], v[16:31]
    ds_read_b128 v[68:71], v1 offset:21504
    s_waitcnt lgkmcnt(8)
    v_mfma_f32_32x32x16_bf16 v[16:31], v[76:79], a[68:71], v[16:31]
    ds_read_b128 v[72:75], v1 offset:22528
    s_waitcnt lgkmcnt(8)
    v_mfma_f32_32x32x16_bf16 v[16:31], a[116:119], a[72:75], v[16:31]
    ds_read_b128 v[76:79], v1 offset:23552
    s_waitcnt lgkmcnt(8)
    v_mfma_f32_32x32x16_bf16 v[16:31], a[120:123], a[76:79], v[16:31]
    ds_read_b128 a[116:119], v1 offset:24576
    s_waitcnt lgkmcnt(8)
    v_mfma_f32_32x32x16_bf16 v[16:31], v[64:67], a[80:83], v[16:31]
    ds_read_b128 a[120:123], v1 offset:25600
    s_waitcnt lgkmcnt(4)
    v_mfma_f32_32x32x16_bf16 v[16:31], v[68:71], a[84:87], v[16:31]
    ds_read_b128 v[64:67], v1 offset:26624
    s_waitcnt lgkmcnt(4)
    v_mfma_f32_32x32x16_bf16 v[16:31], v[72:75], a[88:91], v[16:31]
    ds_read_b128 v[68:71], v1 offset:27648
    s_waitcnt lgkmcnt(4)
    v_mfma_f32_32x32x16_bf16 v[16:31], v[76:79], a[92:95], v[16:31]
    ds_read_b128 v[72:75], v1 offset:28672
    s_waitcnt lgkmcnt(4)
    v_mfma_f32_32x32x16_bf16 v[16:31], a[116:119], a[96:99], v[16:31]
    s_waitcnt lgkmcnt(3)
    v_mfma_f32_32x32x16_bf16 v[16:31], a[120:123], a[100:103], v[16:31]
    s_waitcnt lgkmcnt(2)
    v_mfma_f32_32x32x16_bf16 v[16:31], v[64:67], a[104:107], v[16:31]
    s_waitcnt lgkmcnt(1)
    v_mfma_f32_32x32x16_bf16 v[16:31], v[68:71], a[108:111], v[16:31]
    s_waitcnt lgkmcnt(0)
    v_mfma_f32_32x32x16_bf16 v[16:31], v[72:75], a[112:115], v[16:31]
    v_mov_b32 v125, 2
    ds_write_b32 v126, v125
    s_lshr_b32 s21, s18, 1
    s_add_u32 s21, s21, s16
    s_lshl_b32 s22, s18, 1
    s_and_b32 s22, s22, 3
    s_max_u32 s23, s21, 2
    s_sub_u32 s23, s23, 2
    s_lshl_b32 s23, s23, 4
    s_add_u32 s23, s23, s17
    s_lshl_b32 s23, s23, 2
    s_add_u32 s23, s23, s22
    s_lshl_b32 s23, s23, 12
    s_add_u32 s23, s23, 8732672
    s_add_u32 s24, s23, 4096
    s_lshl_b32 s31, s20, 2
    s_add_u32 s31, s31, s18
    s_mul_i32 s31, s31, 28672
    s_add_u32 s31, s31, 1425408
    buffer_load_dwordx4 a[0:3], v1, s[4:7], s31 offen offset:0
    buffer_load_dwordx4 a[4:7], v1, s[4:7], s31 offen offset:1024
    buffer_load_dwordx4 a[8:11], v1, s[4:7], s31 offen offset:2048
    buffer_load_dwordx4 a[12:15], v1, s[4:7], s31 offen offset:3072
    s_add_u32 s31, s31, 4096
    buffer_load_dwordx4 a[16:19], v1, s[4:7], s31 offen offset:0
    buffer_load_dwordx4 a[20:23], v1, s[4:7], s31 offen offset:1024
    buffer_load_dwordx4 a[24:27], v1, s[4:7], s31 offen offset:2048
    buffer_load_dwordx4 a[28:31], v1, s[4:7], s31 offen offset:3072
    s_add_u32 s31, s31, 4096
    buffer_load_dwordx4 a[32:35], v1, s[4:7], s31 offen offset:0
    buffer_load_dwordx4 a[36:39], v1, s[4:7], s31 offen offset:1024
    buffer_load_dwordx4 a[40:43], v1, s[4:7], s31 offen offset:2048
    buffer_load_dwordx4 a[44:47], v1, s[4:7], s31 offen offset:3072
    s_add_u32 s31, s31, 4096
    buffer_load_dwordx4 a[48:51], v1, s[4:7], s31 offen offset:0
    buffer_load_dwordx4 a[52:55], v1, s[4:7], s31 offen offset:1024
    buffer_load_dwordx4 a[56:59], v1, s[4:7], s31 offen offset:2048
    buffer_load_dwordx4 a[60:63], v1, s[4:7], s31 offen offset:3072
    s_add_u32 s31, s31, 4096
    buffer_load_dwordx4 a[64:67], v1, s[4:7], s31 offen offset:0
    buffer_load_dwordx4 a[68:71], v1, s[4:7], s31 offen offset:1024
    buffer_load_dwordx4 a[72:75], v1, s[4:7], s31 offen offset:2048
    buffer_load_dwordx4 a[76:79], v1, s[4:7], s31 offen offset:3072
    s_add_u32 s31, s31, 4096
    buffer_load_dwordx4 a[80:83], v1, s[4:7], s31 offen offset:0
    buffer_load_dwordx4 a[84:87], v1, s[4:7], s31 offen offset:1024
    buffer_load_dwordx4 a[88:91], v1, s[4:7], s31 offen offset:2048
    buffer_load_dwordx4 a[92:95], v1, s[4:7], s31 offen offset:3072
    s_add_u32 s31, s31, 4096
    s_cmp_lt_u32 s21, 2
    s_cbranch_scc1 Lskip193
    buffer_load_dwordx4 v[64:67], v1, s[4:7], s23 offen offset:0 sc1
    buffer_load_dwordx4 v[68:71], v1, s[4:7], s23 offen offset:1024 sc1
    buffer_load_dwordx4 v[72:75], v1, s[4:7], s23 offen offset:2048 sc1
    buffer_load_dwordx4 v[76:79], v1, s[4:7], s23 offen offset:3072 sc1
    buffer_load_dwordx4 v[80:83], v1, s[4:7], s24 offen offset:0 sc1
    buffer_load_dwordx4 v[84:87], v1, s[4:7], s24 offen offset:1024 sc1
    buffer_load_dwordx4 v[88:91], v1, s[4:7], s24 offen offset:2048 sc1
    buffer_load_dwordx4 v[92:95], v1, s[4:7], s24 offen offset:3072 sc1
Lskip193:
    buffer_load_dwordx4 a[96:99], v1, s[4:7], s31 offen offset:0
    buffer_load_dwordx4 a[100:103], v1, s[4:7], s31 offen offset:1024
    buffer_load_dwordx4 a[104:107], v1, s[4:7], s31 offen offset:2048
    buffer_load_dwordx4 a[108:111], v1, s[4:7], s31 offen offset:3072
    v_mul_f32 v16, v16, v104
    v_mul_f32 v17, v17, v104
    v_mul_f32 v18, v18, v104
    v_mul_f32 v19, v19, v104
    v_mul_f32 v20, v20, v104
    v_mul_f32 v21, v21, v104
    v_mul_f32 v22, v22, v104
    v_mul_f32 v23, v23, v104
    v_mul_f32 v24, v24, v104
    v_mul_f32 v25, v25, v104
    v_mul_f32 v26, v26, v104
    v_mul_f32 v27, v27, v104
    v_mul_f32 v28, v28, v104
    v_mul_f32 v29, v29, v104
    v_mul_f32 v30, v30, v104
    v_mul_f32 v31, v31, v104
    s_mov_b32 s40, 0
    s_mov_b32 s41, -1
    s_mov_b64 exec, s[40:41]
    v_mov_b32 v28, 1.0
    s_mov_b64 exec, -1
    s_waitcnt lgkmcnt(0)
    v_and_b32 v7, 15, v0
    v_lshlrev_b32 v7, 2, v7
    s_lshl_b32 s30, s16, 7
    s_add_u32 s30, s30, 35999744
    v_add_u32 v7, s30, v7
    s_mov_b32 s25, 200000
Lpoll94:
    s_nop 3
    buffer_load_dword v4, v7, s[4:7], 0 offen sc1
    s_waitcnt vmcnt(0)
    v_cmp_gt_u32 vcc, 1, v4
    s_nop 1
    s_cbranch_vccz Lpoll94d
    s_sub_u32 s25, s25, 1
    s_cmp_lg_u32 s25, 0
    s_cbranch_scc1 Lpoll94
Lpoll94d:
    s_nop 0
    v_cmp_ne_u32 vcc, s45, v4
    s_nop 1
    s_cmp_eq_u64 vcc, 0
    s_cselect_b32 s45, 1, 0
    s_cmp_ge_u32 s21, 2
    s_cbranch_scc1 Lnofill90
    s_waitcnt vmcnt(4)
    v_mov_b32 v64, 0
    v_mov_b32 v65, 0
    v_mov_b32 v66, 0
    v_mov_b32 v67, 0
    v_mov_b32 v68, 0
    v_mov_b32 v69, 0
    v_mov_b32 v70, 0
    v_mov_b32 v71, 0
    v_mov_b32 v72, 0
    v_mov_b32 v73, 0
    v_mov_b32 v74, 0
    v_mov_b32 v75, 0
    v_mov_b32 v76, 0
    v_mov_b32 v77, 0
    v_mov_b32 v78, 0
    v_mov_b32 v79, 0
    v_mov_b32 v80, 0
    v_mov_b32 v81, 0
    v_mov_b32 v82, 0
    v_mov_b32 v83, 0
    v_mov_b32 v84, 0
    v_mov_b32 v85, 0
    v_mov_b32 v86, 0
    v_mov_b32 v87, 0
    v_mov_b32 v88, 0
    v_mov_b32 v89, 0
    v_mov_b32 v90, 0
    v_mov_b32 v91, 0
    v_mov_b32 v92, 0
    v_mov_b32 v93, 0
    v_mov_b32 v94, 0
    v_mov_b32 v95, 0
    s_mov_b32 s40, 0
    s_mov_b32 s41, -1
    s_mov_b64 exec, s[40:41]
    v_mov_b32 v70, 0xce6e
    v_mov_b32 v86, 0xce6e
    s_mov_b64 exec, -1
    s_branch Lnbjoin91
Lnofill90:
    s_nop 2
    s_mov_b32 s25, 200000
    s_waitcnt vmcnt(4)
Lretry92:
    s_nop 0
    v_max3_u32 v4, v64, v65, v66
    v_max3_u32 v5, v67, v68, v69
    v_max3_u32 v4, v4, v70, v71
    v_max3_u32 v5, v5, v72, v73
    v_max3_u32 v4, v4, v74, v75
    v_max3_u32 v5, v5, v76, v77
    v_max3_u32 v4, v4, v78, v79
    v_max3_u32 v5, v5, v80, v81
    v_max3_u32 v4, v4, v82, v83
    v_max3_u32 v5, v5, v84, v85
    v_max3_u32 v4, v4, v86, v87
    v_max3_u32 v5, v5, v88, v89
    v_max3_u32 v4, v4, v90, v91
    v_max3_u32 v5, v5, v92, v93
    v_max3_u32 v4, v4, v94, v95
    v_max_u32 v4, v4, v5
    v_cmp_eq_u32 vcc, -1, v4
    s_nop 1
    s_cbranch_vccz Lnbjoin91
    s_sub_u32 s25, s25, 1
    s_cmp_eq_u32 s25, 0
    s_cbranch_scc1 Lnbjoin91
    buffer_load_dwordx4 v[64:67], v1, s[4:7], s23 offen offset:0 sc1
    buffer_load_dwordx4 v[68:71], v1, s[4:7], s23 offen offset:1024 sc1
    buffer_load_dwordx4 v[72:75], v1, s[4:7], s23 offen offset:2048 sc1
    buffer_load_dwordx4 v[76:79], v1, s[4:7], s23 offen offset:3072 sc1
    buffer_load_dwordx4 v[80:83], v1, s[4:7], s24 offen offset:0 sc1
    buffer_load_dwordx4 v[84:87], v1, s[4:7], s24 offen offset:1024 sc1
    buffer_load_dwordx4 v[88:91], v1, s[4:7], s24 offen offset:2048 sc1
    buffer_load_dwordx4 v[92:95], v1, s[4:7], s24 offen offset:3072 sc1
    s_waitcnt vmcnt(0)
    s_branch Lretry92
Lnbjoin91:
    s_nop 0
    s_lshl_b32 s22, s18, 13
    v_add_u32 v6, s22, v2
    ds_write_b128 v6, v[64:67] offset:23552
    ds_write_b128 v6, v[68:71] offset:24576
    ds_write_b128 v6, v[72:75] offset:25600
    ds_write_b128 v6, v[76:79] offset:26624
    ds_write_b128 v6, v[80:83] offset:27648
    ds_write_b128 v6, v[84:87] offset:28672
    ds_write_b128 v6, v[88:91] offset:29696
    ds_write_b128 v6, v[92:95] offset:30720
    v_mov_b32 v125, 3
    ds_write_b32 v126, v125
    s_lshl_b32 s21, s20, 2
    s_add_u32 s21, s21, s18
    s_mul_i32 s21, s21, 28672
    s_add_u32 s21, s21, 1425408
    v_cvt_pk_bf16_f32 v8, v16, v17
    v_cvt_pk_bf16_f32 v9, v18, v19
    v_cvt_pk_bf16_f32 v10, v20, v21
    v_cvt_pk_bf16_f32 v11, v22, v23
    v_cvt_pk_bf16_f32 v12, v24, v25
    v_cvt_pk_bf16_f32 v13, v26, v27
    v_cvt_pk_bf16_f32 v14, v28, v29
    v_cvt_pk_bf16_f32 v15, v30, v31
    v_and_b32 v4, 31, v0
    v_lshrrev_b32 v5, 5, v0
    v_lshlrev_b32 v5, 2, v5
    v_sub_u32 v4, v4, v5
    v_mov_b32 v5, 0
    v_mov_b32 v7, 0xce6e6b28
    v_cmp_gt_i32 vcc, 0, v4
    v_cmp_gt_i32 s[40:41], 1, v4
    s_nop 0
    v_cndmask_b32 v32, v7, v5, vcc
    v_cndmask_b32 v48, v5, v7, vcc
    v_cndmask_b32 v33, v7, v5, s[40:41]
    v_cndmask_b32 v49, v5, v7, s[40:41]
    v_cmp_gt_i32 vcc, 2, v4
    v_cmp_gt_i32 s[40:41], 3, v4
    s_nop 0
    v_cndmask_b32 v34, v7, v5, vcc
    v_cndmask_b32 v50, v5, v7, vcc
    v_cndmask_b32 v35, v7, v5, s[40:41]
    v_cndmask_b32 v51, v5, v7, s[40:41]
    v_cmp_gt_i32 vcc, 8, v4
    v_cmp_gt_i32 s[40:41], 9, v4
    s_nop 0
    v_cndmask_b32 v36, v7, v5, vcc
    v_cndmask_b32 v52, v5, v7, vcc
    v_cndmask_b32 v37, v7, v5, s[40:41]
    v_cndmask_b32 v53, v5, v7, s[40:41]
    v_cmp_gt_i32 vcc, 10, v4
    v_cmp_gt_i32 s[40:41], 11, v4
    s_nop 0
    v_cndmask_b32 v38, v7, v5, vcc
    v_cndmask_b32 v54, v5, v7, vcc
    v_cndmask_b32 v39, v7, v5, s[40:41]
    v_cndmask_b32 v55, v5, v7, s[40:41]
    v_cmp_gt_i32 vcc, 16, v4
    v_cmp_gt_i32 s[40:41], 17, v4
    s_nop 0
    v_cndmask_b32 v40, v7, v5, vcc
    v_cndmask_b32 v56, v5, v7, vcc
    v_cndmask_b32 v41, v7, v5, s[40:41]
    v_cndmask_b32 v57, v5, v7, s[40:41]
    v_cmp_gt_i32 vcc, 18, v4
    v_cmp_gt_i32 s[40:41], 19, v4
    s_nop 0
    v_cndmask_b32 v42, v7, v5, vcc
    v_cndmask_b32 v58, v5, v7, vcc
    v_cndmask_b32 v43, v7, v5, s[40:41]
    v_cndmask_b32 v59, v5, v7, s[40:41]
    v_cmp_gt_i32 vcc, 24, v4
    v_cmp_gt_i32 s[40:41], 25, v4
    s_nop 0
    v_cndmask_b32 v44, v7, v5, vcc
    v_cndmask_b32 v60, v5, v7, vcc
    v_cndmask_b32 v45, v7, v5, s[40:41]
    v_cndmask_b32 v61, v5, v7, s[40:41]
    v_cmp_gt_i32 vcc, 26, v4
    v_cmp_gt_i32 s[40:41], 27, v4
    s_nop 0
    v_cndmask_b32 v46, v7, v5, vcc
    v_cndmask_b32 v62, v5, v7, vcc
    v_cndmask_b32 v47, v7, v5, s[40:41]
    v_cndmask_b32 v63, v5, v7, s[40:41]
    s_lshl_b32 s22, s18, 12
    v_add_u32 v6, s22, v2
    v_mov_b32 v116, 148992
    ds_read_b128 v[116:119], v116
    s_waitcnt lgkmcnt(0)
    v_min3_u32 v116, v116, v117, v118
    v_min_u32 v116, v116, v119
    v_cmp_gt_u32 vcc, 3, v116
    s_nop 1
    s_cbranch_vccz Lc95d
    s_nop 1
    s_mov_b32 s25, 2000000
Lc95:
    s_nop 0
    s_sleep 1
    v_mov_b32 v116, 148992
    ds_read_b128 v[116:119], v116
    s_waitcnt lgkmcnt(0)
    v_min3_u32 v116, v116, v117, v118
    v_min_u32 v116, v116, v119
    v_cmp_gt_u32 vcc, 3, v116
    s_nop 1
    s_cbranch_vccz Lc95d
    s_sub_u32 s25, s25, 1
    s_cmp_lg_u32 s25, 0
    s_cbranch_scc1 Lc95
    s_nop 0
Lc95d:
    ds_read_b128 v[96:99], v6 offset:27648
    ds_read_b128 v[100:103], v6 offset:28672
    v_mov_b32 v4, 0xff61b1e6
    v_mov_b32 v5, 0xff61b1e6
    s_waitcnt lgkmcnt(1)
    v_mfma_f32_32x32x16_bf16 v[64:79], v[96:99], v[8:11], 0
    ds_read_b128 v[104:107], v6 offset:31744
    s_waitcnt lgkmcnt(1)
    v_mfma_f32_32x32x16_bf16 v[64:79], v[100:103], v[12:15], v[64:79]
    ds_read_b128 v[96:99], v6 offset:32768
    s_waitcnt lgkmcnt(1)
    v_mfma_f32_32x32x16_bf16 v[80:95], v[104:107], v[8:11], 0
    ds_read_b128 v[100:103], v6 offset:35840
    s_waitcnt lgkmcnt(1)
    v_mfma_f32_32x32x16_bf16 v[80:95], v[96:99], v[12:15], v[80:95]
    ds_read_b128 v[104:107], v6 offset:36864
    s_nop 4
    v_max3_f32 v4, v4, v64, v65
    v_max3_f32 v5, v5, v66, v67
    v_max3_f32 v4, v4, v68, v69
    v_max3_f32 v5, v5, v70, v71
    v_max3_f32 v4, v4, v72, v73
    v_max3_f32 v5, v5, v74, v75
    v_max3_f32 v4, v4, v76, v77
    v_max3_f32 v5, v5, v78, v79
    s_waitcnt lgkmcnt(1)
    v_mfma_f32_32x32x16_bf16 v[64:79], v[100:103], v[8:11], 0
    ds_read_b128 v[96:99], v6 offset:39936
    s_waitcnt lgkmcnt(1)
    v_mfma_f32_32x32x16_bf16 v[64:79], v[104:107], v[12:15], v[64:79]
    ds_read_b128 v[100:103], v6 offset:40960
    v_max3_f32 v4, v4, v80, v81
    v_max3_f32 v5, v5, v82, v83
    v_max3_f32 v4, v4, v84, v85
    v_max3_f32 v5, v5, v86, v87
    v_max3_f32 v4, v4, v88, v89
    v_max3_f32 v5, v5, v90, v91
    v_max3_f32 v4, v4, v92, v93
    v_max3_f32 v5, v5, v94, v95
    s_waitcnt lgkmcnt(1)
    v_mfma_f32_32x32x16_bf16 v[80:95], v[96:99], v[8:11], 0
    ds_read_b128 v[104:107], v6 offset:44032
    s_waitcnt lgkmcnt(1)
    v_mfma_f32_32x32x16_bf16 v[80:95], v[100:103], v[12:15], v[80:95]
    ds_read_b128 v[96:99], v6 offset:45056
    v_max3_f32 v4, v4, v64, v65
    v_max3_f32 v5, v5, v66, v67
    v_max3_f32 v4, v4, v68, v69
    v_max3_f32 v5, v5, v70, v71
    v_max3_f32 v4, v4, v72, v73
    v_max3_f32 v5, v5, v74, v75
    v_max3_f32 v4, v4, v76, v77
    v_max3_f32 v5, v5, v78, v79
    s_waitcnt lgkmcnt(1)
    v_mfma_f32_32x32x16_bf16 v[64:79], v[104:107], v[8:11], 0
    ds_read_b128 v[100:103], v6 offset:48128
    s_waitcnt lgkmcnt(1)
    v_mfma_f32_32x32x16_bf16 v[64:79], v[96:99], v[12:15], v[64:79]
    ds_read_b128 v[104:107], v6 offset:49152
    v_max3_f32 v4, v4, v80, v81
    v_max3_f32 v5, v5, v82, v83
    v_max3_f32 v4, v4, v84, v85
    v_max3_f32 v5, v5, v86, v87
    v_max3_f32 v4, v4, v88, v89
    v_max3_f32 v5, v5, v90, v91
    v_max3_f32 v4, v4, v92, v93
    v_max3_f32 v5, v5, v94, v95
    s_waitcnt lgkmcnt(1)
    v_mfma_f32_32x32x16_bf16 v[80:95], v[100:103], v[8:11], 0
    ds_read_b128 v[96:99], v6 offset:52224
    s_waitcnt lgkmcnt(1)
    v_mfma_f32_32x32x16_bf16 v[80:95], v[104:107], v[12:15], v[80:95]
    ds_read_b128 v[100:103], v6 offset:53248
    v_max3_f32 v4, v4, v64, v65
    v_max3_f32 v5, v5, v66, v67
    v_max3_f32 v4, v4, v68, v69
    v_max3_f32 v5, v5, v70, v71
    v_max3_f32 v4, v4, v72, v73
    v_max3_f32 v5, v5, v74, v75
    v_max3_f32 v4, v4, v76, v77
    v_max3_f32 v5, v5, v78, v79
    s_waitcnt lgkmcnt(1)
    v_mfma_f32_32x32x16_bf16 v[64:79], v[96:99], v[8:11], 0
    ds_read_b128 v[104:107], v6 offset:23552
    s_waitcnt lgkmcnt(1)
    v_mfma_f32_32x32x16_bf16 v[64:79], v[100:103], v[12:15], v[64:79]
    ds_read_b128 v[96:99], v6 offset:24576
    v_max3_f32 v4, v4, v80, v81
    v_max3_f32 v5, v5, v82, v83
    v_max3_f32 v4, v4, v84, v85
    v_max3_f32 v5, v5, v86, v87
    v_max3_f32 v4, v4, v88, v89
    v_max3_f32 v5, v5, v90, v91
    v_max3_f32 v4, v4, v92, v93
    v_max3_f32 v5, v5, v94, v95
    s_waitcnt lgkmcnt(1)
    v_mfma_f32_32x32x16_bf16 v[32:47], v[104:107], v[8:11], v[32:47]
    ds_read_b128 v[100:103], v6 offset:56320
    s_waitcnt lgkmcnt(1)
    v_mfma_f32_32x32x16_bf16 v[32:47], v[96:99], v[12:15], v[32:47]
    ds_read_b128 v[104:107], v6 offset:57344
    v_max3_f32 v4, v4, v64, v65
    v_max3_f32 v5, v5, v66, v67
    v_max3_f32 v4, v4, v68, v69
    v_max3_f32 v5, v5, v70, v71
    v_max3_f32 v4, v4, v72, v73
    v_max3_f32 v5, v5, v74, v75
    v_max3_f32 v4, v4, v76, v77
    v_max3_f32 v5, v5, v78, v79
    s_waitcnt lgkmcnt(1)
    v_mfma_f32_32x32x16_bf16 v[48:63], v[100:103], v[8:11], v[48:63]
    s_waitcnt lgkmcnt(0)
    v_mfma_f32_32x32x16_bf16 v[48:63], v[104:107], v[12:15], v[48:63]
    v_max3_f32 v4, v4, v32, v33
    v_max3_f32 v5, v5, v34, v35
    v_max3_f32 v4, v4, v36, v37
    v_max3_f32 v5, v5, v38, v39
    v_max3_f32 v4, v4, v40, v41
    v_max3_f32 v5, v5, v42, v43
    v_max3_f32 v4, v4, v44, v45
    v_max3_f32 v5, v5, v46, v47
    s_nop 3
    v_max3_f32 v4, v4, v48, v49
    v_max3_f32 v5, v5, v50, v51
    v_max3_f32 v4, v4, v52, v53
    v_max3_f32 v5, v5, v54, v55
    v_max3_f32 v4, v4, v56, v57
    v_max3_f32 v5, v5, v58, v59
    v_max3_f32 v4, v4, v60, v61
    v_max3_f32 v5, v5, v62, v63
    v_max_f32 v4, v4, v5
    v_mov_b32 v5, v4
    s_nop 1
    v_permlane32_swap_b32 v4, v5
    v_max_f32 v4, v4, v5
    s_mov_b32 s30, 0x3e8b97f6
    v_mul_f32 v4, s30, v4
    ds_read_b128 v[96:99], v6 offset:25600
    ds_read_b128 v[100:103], v6 offset:26624
    v_fma_f32 v32, v32, s30, -v4
    v_fma_f32 v33, v33, s30, -v4
    v_exp_f32 v32, v32
    v_fma_f32 v34, v34, s30, -v4
    v_exp_f32 v33, v33
    v_fma_f32 v35, v35, s30, -v4
    v_exp_f32 v34, v34
    v_fma_f32 v36, v36, s30, -v4
    v_exp_f32 v35, v35
    v_fma_f32 v37, v37, s30, -v4
    v_exp_f32 v36, v36
    v_fma_f32 v38, v38, s30, -v4
    v_exp_f32 v37, v37
    v_fma_f32 v39, v39, s30, -v4
    v_exp_f32 v38, v38
    v_fma_f32 v40, v40, s30, -v4
    v_exp_f32 v39, v39
    v_fma_f32 v41, v41, s30, -v4
    v_exp_f32 v40, v40
    v_fma_f32 v42, v42, s30, -v4
    v_exp_f32 v41, v41
    v_fma_f32 v43, v43, s30, -v4
    v_exp_f32 v42, v42
    v_fma_f32 v44, v44, s30, -v4
    v_exp_f32 v43, v43
    v_fma_f32 v45, v45, s30, -v4
    v_exp_f32 v44, v44
    v_fma_f32 v46, v46, s30, -v4
    v_exp_f32 v45, v45
    v_fma_f32 v47, v47, s30, -v4
    v_exp_f32 v46, v46
    v_exp_f32 v47, v47
    v_cvt_pk_bf16_f32 v32, v32, v33
    v_cvt_pk_bf16_f32 v33, v34, v35
    v_cvt_pk_bf16_f32 v34, v36, v37
    v_cvt_pk_bf16_f32 v35, v38, v39
    v_cvt_pk_bf16_f32 v36, v40, v41
    v_cvt_pk_bf16_f32 v37, v42, v43
    v_cvt_pk_bf16_f32 v38, v44, v45
    v_cvt_pk_bf16_f32 v39, v46, v47
    v_fma_f32 v48, v48, s30, -v4
    v_fma_f32 v49, v49, s30, -v4
    v_exp_f32 v48, v48
    v_fma_f32 v50, v50, s30, -v4
    v_exp_f32 v49, v49
    v_fma_f32 v51, v51, s30, -v4
    v_exp_f32 v50, v50
    v_fma_f32 v52, v52, s30, -v4
    s_waitcnt lgkmcnt(1)
    v_mfma_f32_32x32x16_bf16 v[16:31], v[96:99], v[32:35], 0
    ds_read_b128 v[104:107], v6 offset:27648
    v_exp_f32 v51, v51
    v_fma_f32 v53, v53, s30, -v4
    v_exp_f32 v52, v52
    v_fma_f32 v54, v54, s30, -v4
    v_exp_f32 v53, v53
    v_fma_f32 v55, v55, s30, -v4
    v_exp_f32 v54, v54
    v_fma_f32 v56, v56, s30, -v4
    s_waitcnt lgkmcnt(1)
    v_mfma_f32_32x32x16_bf16 v[16:31], v[100:103], v[36:39], v[16:31]
    ds_read_b128 v[96:99], v6 offset:28672
    v_exp_f32 v55, v55
    v_fma_f32 v57, v57, s30, -v4
    v_exp_f32 v56, v56
    v_fma_f32 v58, v58, s30, -v4
    v_exp_f32 v57, v57
    v_fma_f32 v59, v59, s30, -v4
    v_exp_f32 v58, v58
    v_fma_f32 v60, v60, s30, -v4
    s_waitcnt lgkmcnt(1)
    v_mfma_f32_32x32x16_bf16 v[32:47], v[104:107], v[8:11], 0
    ds_read_b128 v[100:103], v6 offset:58368
    v_exp_f32 v59, v59
    v_fma_f32 v61, v61, s30, -v4
    v_exp_f32 v60, v60
    v_fma_f32 v62, v62, s30, -v4
    v_exp_f32 v61, v61
    v_fma_f32 v63, v63, s30, -v4
    v_exp_f32 v62, v62
    v_exp_f32 v63, v63
    s_waitcnt lgkmcnt(1)
    v_mfma_f32_32x32x16_bf16 v[32:47], v[96:99], v[12:15], v[32:47]
    ds_read_b128 v[104:107], v6 offset:59392
    v_cvt_pk_bf16_f32 v48, v48, v49
    v_cvt_pk_bf16_f32 v49, v50, v51
    v_cvt_pk_bf16_f32 v50, v52, v53
    v_cvt_pk_bf16_f32 v51, v54, v55
    v_cvt_pk_bf16_f32 v52, v56, v57
    v_cvt_pk_bf16_f32 v53, v58, v59
    v_cvt_pk_bf16_f32 v54, v60, v61
    v_cvt_pk_bf16_f32 v55, v62, v63
    v_fma_f32 v64, v64, s30, -v4
    v_fma_f32 v65, v65, s30, -v4
    v_exp_f32 v64, v64
    v_fma_f32 v66, v66, s30, -v4
    v_exp_f32 v65, v65
    v_fma_f32 v67, v67, s30, -v4
    v_exp_f32 v66, v66
    v_fma_f32 v68, v68, s30, -v4
    s_waitcnt lgkmcnt(1)
    v_mfma_f32_32x32x16_bf16 v[16:31], v[100:103], v[48:51], v[16:31]
    ds_read_b128 v[96:99], v6 offset:31744
    v_exp_f32 v67, v67
    v_fma_f32 v69, v69, s30, -v4
    v_exp_f32 v68, v68
    v_fma_f32 v70, v70, s30, -v4
    v_exp_f32 v69, v69
    v_fma_f32 v71, v71, s30, -v4
    v_exp_f32 v70, v70
    v_fma_f32 v72, v72, s30, -v4
    s_waitcnt lgkmcnt(1)
    v_mfma_f32_32x32x16_bf16 v[16:31], v[104:107], v[52:55], v[16:31]
    ds_read_b128 v[100:103], v6 offset:32768
    v_exp_f32 v71, v71
    v_fma_f32 v73, v73, s30, -v4
    v_exp_f32 v72, v72
    v_fma_f32 v74, v74, s30, -v4
    v_exp_f32 v73, v73
    v_fma_f32 v75, v75, s30, -v4
    v_exp_f32 v74, v74
    v_fma_f32 v76, v76, s30, -v4
    s_waitcnt lgkmcnt(1)
    v_mfma_f32_32x32x16_bf16 v[48:63], v[96:99], v[8:11], 0
    ds_read_b128 v[104:107], v6 offset:54272
    v_exp_f32 v75, v75
    v_fma_f32 v77, v77, s30, -v4
    v_exp_f32 v76, v76
    v_fma_f32 v78, v78, s30, -v4
    v_exp_f32 v77, v77
    v_fma_f32 v79, v79, s30, -v4
    v_exp_f32 v78, v78
    v_exp_f32 v79, v79
    s_waitcnt lgkmcnt(1)
    v_mfma_f32_32x32x16_bf16 v[48:63], v[100:103], v[12:15], v[48:63]
    ds_read_b128 v[96:99], v6 offset:55296
    v_cvt_pk_bf16_f32 v64, v64, v65
    v_cvt_pk_bf16_f32 v65, v66, v67
    v_cvt_pk_bf16_f32 v66, v68, v69
    v_cvt_pk_bf16_f32 v67, v70, v71
    v_cvt_pk_bf16_f32 v68, v72, v73
    v_cvt_pk_bf16_f32 v69, v74, v75
    v_cvt_pk_bf16_f32 v70, v76, v77
    v_cvt_pk_bf16_f32 v71, v78, v79
    v_fma_f32 v80, v80, s30, -v4
    v_fma_f32 v81, v81, s30, -v4
    v_exp_f32 v80, v80
    v_fma_f32 v82, v82, s30, -v4
    v_exp_f32 v81, v81
    v_fma_f32 v83, v83, s30, -v4
    v_exp_f32 v82, v82
    v_fma_f32 v84, v84, s30, -v4
    s_waitcnt lgkmcnt(1)
    v_mfma_f32_32x32x16_bf16 v[16:31], v[104:107], v[64:67], v[16:31]
    ds_read_b128 v[100:103], v6 offset:35840
    v_exp_f32 v83, v83
    v_fma_f32 v85, v85, s30, -v4
    v_exp_f32 v84, v84
    v_fma_f32 v86, v86, s30, -v4
    v_exp_f32 v85, v85
    v_fma_f32 v87, v87, s30, -v4
    v_exp_f32 v86, v86
    v_fma_f32 v88, v88, s30, -v4
    s_waitcnt lgkmcnt(1)
    v_mfma_f32_32x32x16_bf16 v[16:31], v[96:99], v[68:71], v[16:31]
    ds_read_b128 v[104:107], v6 offset:36864
    v_exp_f32 v87, v87
    v_fma_f32 v89, v89, s30, -v4
    v_exp_f32 v88, v88
    v_fma_f32 v90, v90, s30, -v4
    v_exp_f32 v89, v89
    v_fma_f32 v91, v91, s30, -v4
    v_exp_f32 v90, v90
    v_fma_f32 v92, v92, s30, -v4
    s_waitcnt lgkmcnt(1)
    v_mfma_f32_32x32x16_bf16 v[64:79], v[100:103], v[8:11], 0
    ds_read_b128 v[96:99], v6 offset:50176
    v_exp_f32 v91, v91
    v_fma_f32 v93, v93, s30, -v4
    v_exp_f32 v92, v92
    v_fma_f32 v94, v94, s30, -v4
    v_exp_f32 v93, v93
    v_fma_f32 v95, v95, s30, -v4
    v_exp_f32 v94, v94
    v_exp_f32 v95, v95
    s_waitcnt lgkmcnt(1)
    v_mfma_f32_32x32x16_bf16 v[64:79], v[104:107], v[12:15], v[64:79]
    ds_read_b128 v[100:103], v6 offset:51200
    v_cvt_pk_bf16_f32 v80, v80, v81
    v_cvt_pk_bf16_f32 v81, v82, v83
    v_cvt_pk_bf16_f32 v82, v84, v85
    v_cvt_pk_bf16_f32 v83, v86, v87
    v_cvt_pk_bf16_f32 v84, v88, v89
    v_cvt_pk_bf16_f32 v85, v90, v91
    v_cvt_pk_bf16_f32 v86, v92, v93
    v_cvt_pk_bf16_f32 v87, v94, v95
    v_fma_f32 v32, v32, s30, -v4
    v_fma_f32 v33, v33, s30, -v4
    v_exp_f32 v32, v32
    v_fma_f32 v34, v34, s30, -v4
    v_exp_f32 v33, v33
    v_fma_f32 v35, v35, s30, -v4
    v_exp_f32 v34, v34
    v_fma_f32 v36, v36, s30, -v4
    s_waitcnt lgkmcnt(1)
    v_mfma_f32_32x32x16_bf16 v[16:31], v[96:99], v[80:83], v[16:31]
    ds_read_b128 v[104:107], v6 offset:39936
    v_exp_f32 v35, v35
    v_fma_f32 v37, v37, s30, -v4
    v_exp_f32 v36, v36
    v_fma_f32 v38, v38, s30, -v4
    v_exp_f32 v37, v37
    v_fma_f32 v39, v39, s30, -v4
    v_exp_f32 v38, v38
    v_fma_f32 v40, v40, s30, -v4
    s_waitcnt lgkmcnt(1)
    v_mfma_f32_32x32x16_bf16 v[16:31], v[100:103], v[84:87], v[16:31]
    ds_read_b128 v[96:99], v6 offset:40960
    v_exp_f32 v39, v39
    v_fma_f32 v41, v41, s30, -v4
    v_exp_f32 v40, v40
    v_fma_f32 v42, v42, s30, -v4
    v_exp_f32 v41, v41
    v_fma_f32 v43, v43, s30, -v4
    v_exp_f32 v42, v42
    v_fma_f32 v44, v44, s30, -v4
    s_waitcnt lgkmcnt(1)
    v_mfma_f32_32x32x16_bf16 v[80:95], v[104:107], v[8:11], 0
    ds_read_b128 v[100:103], v6 offset:29696
    v_exp_f32 v43, v43
    v_fma_f32 v45, v45, s30, -v4
    v_exp_f32 v44, v44
    v_fma_f32 v46, v46, s30, -v4
    v_exp_f32 v45, v45
    v_fma_f32 v47, v47, s30, -v4
    v_exp_f32 v46, v46
    v_exp_f32 v47, v47
    s_waitcnt lgkmcnt(1)
    v_mfma_f32_32x32x16_bf16 v[80:95], v[96:99], v[12:15], v[80:95]
    ds_read_b128 v[104:107], v6 offset:30720
    v_cvt_pk_bf16_f32 v32, v32, v33
    v_cvt_pk_bf16_f32 v33, v34, v35
    v_cvt_pk_bf16_f32 v34, v36, v37
    v_cvt_pk_bf16_f32 v35, v38, v39
    v_cvt_pk_bf16_f32 v36, v40, v41
    v_cvt_pk_bf16_f32 v37, v42, v43
    v_cvt_pk_bf16_f32 v38, v44, v45
    v_cvt_pk_bf16_f32 v39, v46, v47
    v_fma_f32 v48, v48, s30, -v4
    v_fma_f32 v49, v49, s30, -v4
    v_exp_f32 v48, v48
    v_fma_f32 v50, v50, s30, -v4
    v_exp_f32 v49, v49
    v_fma_f32 v51, v51, s30, -v4
    v_exp_f32 v50, v50
    v_fma_f32 v52, v52, s30, -v4
    s_waitcnt lgkmcnt(1)
    v_mfma_f32_32x32x16_bf16 v[16:31], v[100:103], v[32:35], v[16:31]
    ds_read_b128 v[96:99], v6 offset:44032
    v_exp_f32 v51, v51
    v_fma_f32 v53, v53, s30, -v4
    v_exp_f32 v52, v52
    v_fma_f32 v54, v54, s30, -v4
    v_exp_f32 v53, v53
    v_fma_f32 v55, v55, s30, -v4
    v_exp_f32 v54, v54
    v_fma_f32 v56, v56, s30, -v4
    s_waitcnt lgkmcnt(1)
    v_mfma_f32_32x32x16_bf16 v[16:31], v[104:107], v[36:39], v[16:31]
    ds_read_b128 v[100:103], v6 offset:45056
    v_exp_f32 v55, v55
    v_fma_f32 v57, v57, s30, -v4
    v_exp_f32 v56, v56
    v_fma_f32 v58, v58, s30, -v4
    v_exp_f32 v57, v57
    v_fma_f32 v59, v59, s30, -v4
    v_exp_f32 v58, v58
    v_fma_f32 v60, v60, s30, -v4
    s_waitcnt lgkmcnt(1)
    v_mfma_f32_32x32x16_bf16 v[32:47], v[96:99], v[8:11], 0
    ds_read_b128 v[104:107], v6 offset:33792
    v_exp_f32 v59, v59
    v_fma_f32 v61, v61, s30, -v4
    v_exp_f32 v60, v60
    v_fma_f32 v62, v62, s30, -v4
    v_exp_f32 v61, v61
    v_fma_f32 v63, v63, s30, -v4
    v_exp_f32 v62, v62
    v_exp_f32 v63, v63
    s_waitcnt lgkmcnt(1)
    v_mfma_f32_32x32x16_bf16 v[32:47], v[100:103], v[12:15], v[32:47]
    ds_read_b128 v[96:99], v6 offset:34816
    v_cvt_pk_bf16_f32 v48, v48, v49
    v_cvt_pk_bf16_f32 v49, v50, v51
    v_cvt_pk_bf16_f32 v50, v52, v53
    v_cvt_pk_bf16_f32 v51, v54, v55
    v_cvt_pk_bf16_f32 v52, v56, v57
    v_cvt_pk_bf16_f32 v53, v58, v59
    v_cvt_pk_bf16_f32 v54, v60, v61
    v_cvt_pk_bf16_f32 v55, v62, v63
    v_fma_f32 v64, v64, s30, -v4
    v_fma_f32 v65, v65, s30, -v4
    v_exp_f32 v64, v64
    v_fma_f32 v66, v66, s30, -v4
    v_exp_f32 v65, v65
    v_fma_f32 v67, v67, s30, -v4
    v_exp_f32 v66, v66
    v_fma_f32 v68, v68, s30, -v4
    v_exp_f32 v67, v67
    v_fma_f32 v69, v69, s30, -v4
    v_exp_f32 v68, v68
    v_fma_f32 v70, v70, s30, -v4
    v_exp_f32 v69, v69
    s_waitcnt lgkmcnt(1)
    v_mfma_f32_32x32x16_bf16 v[16:31], v[104:107], v[48:51], v[16:31]
    ds_read_b128 v[100:103], v6 offset:37888
    v_fma_f32 v71, v71, s30, -v4
    v_exp_f32 v70, v70
    v_fma_f32 v72, v72, s30, -v4
    v_exp_f32 v71, v71
    v_fma_f32 v73, v73, s30, -v4
    v_exp_f32 v72, v72
    v_fma_f32 v74, v74, s30, -v4
    v_exp_f32 v73, v73
    v_fma_f32 v75, v75, s30, -v4
    v_exp_f32 v74, v74
    v_fma_f32 v76, v76, s30, -v4
    v_exp_f32 v75, v75
    v_fma_f32 v77, v77, s30, -v4
    s_waitcnt lgkmcnt(1)
    v_mfma_f32_32x32x16_bf16 v[16:31], v[96:99], v[52:55], v[16:31]
    ds_read_b128 v[104:107], v6 offset:38912
    v_exp_f32 v76, v76
    v_fma_f32 v78, v78, s30, -v4
    v_exp_f32 v77, v77
    v_fma_f32 v79, v79, s30, -v4
    v_exp_f32 v78, v78
    v_exp_f32 v79, v79
    v_cvt_pk_bf16_f32 v64, v64, v65
    v_cvt_pk_bf16_f32 v65, v66, v67
    v_cvt_pk_bf16_f32 v66, v68, v69
    v_cvt_pk_bf16_f32 v67, v70, v71
    v_cvt_pk_bf16_f32 v68, v72, v73
    v_cvt_pk_bf16_f32 v69, v74, v75
    v_cvt_pk_bf16_f32 v70, v76, v77
    v_cvt_pk_bf16_f32 v71, v78, v79
    v_fma_f32 v80, v80, s30, -v4
    v_fma_f32 v81, v81, s30, -v4
    v_exp_f32 v80, v80
    v_fma_f32 v82, v82, s30, -v4
    v_exp_f32 v81, v81
    v_fma_f32 v83, v83, s30, -v4
    v_exp_f32 v82, v82
    v_fma_f32 v84, v84, s30, -v4
    v_exp_f32 v83, v83
    v_fma_f32 v85, v85, s30, -v4
    v_exp_f32 v84, v84
    v_fma_f32 v86, v86, s30, -v4
    v_exp_f32 v85, v85
    s_waitcnt lgkmcnt(1)
    v_mfma_f32_32x32x16_bf16 v[16:31], v[100:103], v[64:67], v[16:31]
    ds_read_b128 v[96:99], v6 offset:41984
    v_fma_f32 v87, v87, s30, -v4
    v_exp_f32 v86, v86
    v_fma_f32 v88, v88, s30, -v4
    v_exp_f32 v87, v87
    v_fma_f32 v89, v89, s30, -v4
    v_exp_f32 v88, v88
    v_fma_f32 v90, v90, s30, -v4
    v_exp_f32 v89, v89
    v_fma_f32 v91, v91, s30, -v4
    v_exp_f32 v90, v90
    v_fma_f32 v92, v92, s30, -v4
    v_exp_f32 v91, v91
    v_fma_f32 v93, v93, s30, -v4
    s_waitcnt lgkmcnt(1)
    v_mfma_f32_32x32x16_bf16 v[16:31], v[104:107], v[68:71], v[16:31]
    ds_read_b128 v[100:103], v6 offset:43008
    v_exp_f32 v92, v92
    v_fma_f32 v94, v94, s30, -v4
    v_exp_f32 v93, v93
    v_fma_f32 v95, v95, s30, -v4
    v_exp_f32 v94, v94
    v_exp_f32 v95, v95
    v_cvt_pk_bf16_f32 v80, v80, v81
    v_cvt_pk_bf16_f32 v81, v82, v83
    v_cvt_pk_bf16_f32 v82, v84, v85
    v_cvt_pk_bf16_f32 v83, v86, v87
    v_cvt_pk_bf16_f32 v84, v88, v89
    v_cvt_pk_bf16_f32 v85, v90, v91
    v_cvt_pk_bf16_f32 v86, v92, v93
    v_cvt_pk_bf16_f32 v87, v94, v95
    v_fma_f32 v32, v32, s30, -v4
    v_fma_f32 v33, v33, s30, -v4
    v_exp_f32 v32, v32
    v_fma_f32 v34, v34, s30, -v4
    v_exp_f32 v33, v33
    v_fma_f32 v35, v35, s30, -v4
    v_exp_f32 v34, v34
    v_fma_f32 v36, v36, s30, -v4
    v_exp_f32 v35, v35
    v_fma_f32 v37, v37, s30, -v4
    v_exp_f32 v36, v36
    v_fma_f32 v38, v38, s30, -v4
    v_exp_f32 v37, v37
    s_waitcnt lgkmcnt(1)
    v_mfma_f32_32x32x16_bf16 v[16:31], v[96:99], v[80:83], v[16:31]
    ds_read_b128 v[104:107], v6 offset:46080
    v_fma_f32 v39, v39, s30, -v4
    v_exp_f32 v38, v38
    v_fma_f32 v40, v40, s30, -v4
    v_exp_f32 v39, v39
    v_fma_f32 v41, v41, s30, -v4
    v_exp_f32 v40, v40
    v_fma_f32 v42, v42, s30, -v4
    v_exp_f32 v41, v41
    v_fma_f32 v43, v43, s30, -v4
    v_exp_f32 v42, v42
    v_fma_f32 v44, v44, s30, -v4
    v_exp_f32 v43, v43
    v_fma_f32 v45, v45, s30, -v4
    s_waitcnt lgkmcnt(1)
    v_mfma_f32_32x32x16_bf16 v[16:31], v[100:103], v[84:87], v[16:31]
    ds_read_b128 v[96:99], v6 offset:47104
    v_exp_f32 v44, v44
    v_fma_f32 v46, v46, s30, -v4
    v_exp_f32 v45, v45
    v_fma_f32 v47, v47, s30, -v4
    v_exp_f32 v46, v46
    v_exp_f32 v47, v47
    v_cvt_pk_bf16_f32 v32, v32, v33
    v_cvt_pk_bf16_f32 v33, v34, v35
    v_cvt_pk_bf16_f32 v34, v36, v37
    v_cvt_pk_bf16_f32 v35, v38, v39
    v_cvt_pk_bf16_f32 v36, v40, v41
    v_cvt_pk_bf16_f32 v37, v42, v43
    v_cvt_pk_bf16_f32 v38, v44, v45
    v_cvt_pk_bf16_f32 v39, v46, v47
    s_waitcnt lgkmcnt(1)
    v_mfma_f32_32x32x16_bf16 v[16:31], v[104:107], v[32:35], v[16:31]
    s_waitcnt lgkmcnt(0)
    v_mfma_f32_32x32x16_bf16 v[16:31], v[96:99], v[36:39], v[16:31]
    v_mov_b32 v125, 4
    ds_write_b32 v126, v125
    s_lshl_b32 s21, s26, 5
    s_add_u32 s21, s21, s17
    s_lshl_b32 s21, s21, 10
    s_add_u32 s21, s21, 17121280
    s_nop 5
    v_mov_b32 v4, v28
    v_mov_b32 v5, v28
    s_nop 1
    v_permlane32_swap_b32 v4, v5
    v_rcp_f32 v5, v5
    s_nop 0
    v_mul_f32 v16, v16, v5
    v_mul_f32 v17, v17, v5
    v_mul_f32 v18, v18, v5
    v_mul_f32 v19, v19, v5
    v_mul_f32 v20, v20, v5
    v_mul_f32 v21, v21, v5
    v_mul_f32 v22, v22, v5
    v_mul_f32 v23, v23, v5
    v_mul_f32 v24, v24, v5
    v_mul_f32 v25, v25, v5
    v_mul_f32 v26, v26, v5
    v_mul_f32 v27, v27, v5
    v_mul_f32 v28, v28, v5
    v_mul_f32 v29, v29, v5
    v_mul_f32 v30, v30, v5
    v_mul_f32 v31, v31, v5
    v_cvt_pk_bf16_f32 v16, v16, v17
    v_cvt_pk_bf16_f32 v17, v18, v19
    v_cvt_pk_bf16_f32 v18, v20, v21
    v_cvt_pk_bf16_f32 v19, v22, v23
    v_cvt_pk_bf16_f32 v20, v24, v25
    v_cvt_pk_bf16_f32 v21, v26, v27
    v_cvt_pk_bf16_f32 v22, v28, v29
    v_cvt_pk_bf16_f32 v23, v30, v31
    buffer_store_dwordx4 v[16:19], v127, s[4:7], s21 offen offset:0 sc1
    buffer_store_dwordx4 v[20:23], v127, s[4:7], s21 offen offset:512 sc1
    v_mov_b32 v4, 2
    v_mov_b32 v5, 0
    s_waitcnt vmcnt(0)
    s_mov_b64 exec, 1
    s_cmp_lg_u32 s45, 0
    s_cbranch_scc1 Ltw96p
    buffer_store_dword v4, v5, s[4:7], s28 offen sc1
    s_branch Ltw96d
Ltw96p:
    buffer_store_dword v4, v5, s[4:7], s28 offen
Ltw96d:
    s_mov_b64 exec, -1
    s_lshl_b32 s21, s27, 5
    s_lshl_b32 s22, s18, 2
    s_add_u32 s21, s21, s22
    s_lshl_b32 s21, s21, 10
    s_add_u32 s21, s21, 17121280
    s_add_u32 s22, s21, 16384
    v_accvgpr_read_b32 v7, a125
    s_mov_b32 s25, 200000
Lpoll97:
    s_nop 3
    buffer_load_dword v4, v7, s[4:7], 0 offen sc1
    s_waitcnt vmcnt(0)
    v_cmp_gt_u32 vcc, 2, v4
    s_nop 1
    s_cbranch_vccz Lpoll97d
    s_sub_u32 s25, s25, 1
    s_cmp_lg_u32 s25, 0
    s_cbranch_scc1 Lpoll97
Lpoll97d:
    s_nop 0
    buffer_load_dwordx4 v[72:75], v1, s[4:7], s21 offen offset:0
    buffer_load_dwordx4 v[88:91], v1, s[4:7], s22 offen offset:0
    buffer_load_dwordx4 v[76:79], v1, s[4:7], s21 offen offset:1024
    buffer_load_dwordx4 v[92:95], v1, s[4:7], s22 offen offset:1024
    buffer_load_dwordx4 v[80:83], v1, s[4:7], s21 offen offset:2048
    buffer_load_dwordx4 v[96:99], v1, s[4:7], s22 offen offset:2048
    buffer_load_dwordx4 v[84:87], v1, s[4:7], s21 offen offset:3072
    buffer_load_dwordx4 v[100:103], v1, s[4:7], s22 offen offset:3072
    v_mov_b32 v116, 148992
    ds_read_b128 v[116:119], v116
    s_waitcnt lgkmcnt(0)
    v_min3_u32 v116, v116, v117, v118
    v_min_u32 v116, v116, v119
    v_cmp_gt_u32 vcc, 4, v116
    s_nop 1
    s_cbranch_vccz Lc98d
    s_nop 1
    s_mov_b32 s25, 2000000
Lc98:
    s_nop 0
    s_sleep 1
    v_mov_b32 v116, 148992
    ds_read_b128 v[116:119], v116
    s_waitcnt lgkmcnt(0)
    v_min3_u32 v116, v116, v117, v118
    v_min_u32 v116, v116, v119
    v_cmp_gt_u32 vcc, 4, v116
    s_nop 1
    s_cbranch_vccz Lc98d
    s_sub_u32 s25, s25, 1
    s_cmp_lg_u32 s25, 0
    s_cbranch_scc1 Lc98
    s_nop 0
Lc98d:
    s_waitcnt vmcnt(7)
    v_mfma_f32_16x16x32_bf16 v[16:19], a[0:3], v[72:75], 0
    v_mfma_f32_16x16x32_bf16 v[20:23], a[4:7], v[72:75], 0
    v_mfma_f32_16x16x32_bf16 v[24:27], a[8:11], v[72:75], 0
    v_mfma_f32_16x16x32_bf16 v[28:31], a[12:15], v[72:75], 0
    v_mfma_f32_16x16x32_bf16 v[32:35], a[16:19], v[72:75], 0
    v_mfma_f32_16x16x32_bf16 v[36:39], a[20:23], v[72:75], 0
    v_mfma_f32_16x16x32_bf16 v[40:43], a[24:27], v[72:75], 0
    s_waitcnt vmcnt(6)
    v_mfma_f32_16x16x32_bf16 v[44:47], a[0:3], v[88:91], 0
    v_mfma_f32_16x16x32_bf16 v[48:51], a[4:7], v[88:91], 0
    v_mfma_f32_16x16x32_bf16 v[52:55], a[8:11], v[88:91], 0
    v_mfma_f32_16x16x32_bf16 v[56:59], a[12:15], v[88:91], 0
    v_mfma_f32_16x16x32_bf16 v[60:63], a[16:19], v[88:91], 0
    v_mfma_f32_16x16x32_bf16 v[64:67], a[20:23], v[88:91], 0
    v_mfma_f32_16x16x32_bf16 v[68:71], a[24:27], v[88:91], 0
    s_waitcnt vmcnt(5)
    v_mfma_f32_16x16x32_bf16 v[16:19], a[28:31], v[76:79], v[16:19]
    v_mfma_f32_16x16x32_bf16 v[20:23], a[32:35], v[76:79], v[20:23]
    v_mfma_f32_16x16x32_bf16 v[24:27], a[36:39], v[76:79], v[24:27]
    v_mfma_f32_16x16x32_bf16 v[28:31], a[40:43], v[76:79], v[28:31]
    v_mfma_f32_16x16x32_bf16 v[32:35], a[44:47], v[76:79], v[32:35]
    v_mfma_f32_16x16x32_bf16 v[36:39], a[48:51], v[76:79], v[36:39]
    v_mfma_f32_16x16x32_bf16 v[40:43], a[52:55], v[76:79], v[40:43]
    s_waitcnt vmcnt(4)
    v_mfma_f32_16x16x32_bf16 v[44:47], a[28:31], v[92:95], v[44:47]
    v_mfma_f32_16x16x32_bf16 v[48:51], a[32:35], v[92:95], v[48:51]
    v_mfma_f32_16x16x32_bf16 v[52:55], a[36:39], v[92:95], v[52:55]
    v_mfma_f32_16x16x32_bf16 v[56:59], a[40:43], v[92:95], v[56:59]
    v_mfma_f32_16x16x32_bf16 v[60:63], a[44:47], v[92:95], v[60:63]
    v_mfma_f32_16x16x32_bf16 v[64:67], a[48:51], v[92:95], v[64:67]
    v_mfma_f32_16x16x32_bf16 v[68:71], a[52:55], v[92:95], v[68:71]
    s_waitcnt vmcnt(3)
    v_mfma_f32_16x16x32_bf16 v[16:19], a[56:59], v[80:83], v[16:19]
    v_mfma_f32_16x16x32_bf16 v[20:23], a[60:63], v[80:83], v[20:23]
    v_mfma_f32_16x16x32_bf16 v[24:27], a[64:67], v[80:83], v[24:27]
    v_mfma_f32_16x16x32_bf16 v[28:31], a[68:71], v[80:83], v[28:31]
    v_mfma_f32_16x16x32_bf16 v[32:35], a[72:75], v[80:83], v[32:35]
    v_mfma_f32_16x16x32_bf16 v[36:39], a[76:79], v[80:83], v[36:39]
    v_mfma_f32_16x16x32_bf16 v[40:43], a[80:83], v[80:83], v[40:43]
    s_waitcnt vmcnt(2)
    v_mfma_f32_16x16x32_bf16 v[44:47], a[56:59], v[96:99], v[44:47]
    v_mfma_f32_16x16x32_bf16 v[48:51], a[60:63], v[96:99], v[48:51]
    v_mfma_f32_16x16x32_bf16 v[52:55], a[64:67], v[96:99], v[52:55]
    v_mfma_f32_16x16x32_bf16 v[56:59], a[68:71], v[96:99], v[56:59]
    v_mfma_f32_16x16x32_bf16 v[60:63], a[72:75], v[96:99], v[60:63]
    v_mfma_f32_16x16x32_bf16 v[64:67], a[76:79], v[96:99], v[64:67]
    v_mfma_f32_16x16x32_bf16 v[68:71], a[80:83], v[96:99], v[68:71]
    s_waitcnt vmcnt(1)
    v_mfma_f32_16x16x32_bf16 v[16:19], a[84:87], v[84:87], v[16:19]
    v_mfma_f32_16x16x32_bf16 v[20:23], a[88:91], v[84:87], v[20:23]
    v_mfma_f32_16x16x32_bf16 v[24:27], a[92:95], v[84:87], v[24:27]
    v_mfma_f32_16x16x32_bf16 v[28:31], a[96:99], v[84:87], v[28:31]
    v_mfma_f32_16x16x32_bf16 v[32:35], a[100:103], v[84:87], v[32:35]
    v_mfma_f32_16x16x32_bf16 v[36:39], a[104:107], v[84:87], v[36:39]
    s_nop 2
    ds_write_b128 v121, v[16:19] offset:0
    v_mfma_f32_16x16x32_bf16 v[40:43], a[108:111], v[84:87], v[40:43]
    ds_write_b128 v121, v[20:23] offset:64
    s_waitcnt vmcnt(0)
    v_mfma_f32_16x16x32_bf16 v[44:47], a[84:87], v[100:103], v[44:47]
    ds_write_b128 v121, v[24:27] offset:128
    v_mfma_f32_16x16x32_bf16 v[48:51], a[88:91], v[100:103], v[48:51]
    ds_write_b128 v121, v[28:31] offset:192
    v_mfma_f32_16x16x32_bf16 v[52:55], a[92:95], v[100:103], v[52:55]
    ds_write_b128 v121, v[32:35] offset:256
    v_mfma_f32_16x16x32_bf16 v[56:59], a[96:99], v[100:103], v[56:59]
    ds_write_b128 v121, v[36:39] offset:320
    v_mfma_f32_16x16x32_bf16 v[60:63], a[100:103], v[100:103], v[60:63]
    ds_write_b128 v121, v[40:43] offset:384
    v_mfma_f32_16x16x32_bf16 v[64:67], a[104:107], v[100:103], v[64:67]
    ds_write_b128 v121, v[44:47] offset:7424
    v_mfma_f32_16x16x32_bf16 v[68:71], a[108:111], v[100:103], v[68:71]
    ds_write_b128 v121, v[48:51] offset:7488
    ds_write_b128 v121, v[52:55] offset:7552
    ds_write_b128 v121, v[56:59] offset:7616
    s_nop 0
    ds_write_b128 v121, v[60:63] offset:7680
    s_nop 0
    ds_write_b128 v121, v[64:67] offset:7744
    s_nop 0
    ds_write_b128 v121, v[68:71] offset:7808
    v_mov_b32 v125, 5
    ds_write_b32 v126, v125
    v_lshlrev_b32 v80, 16, v108
    v_and_b32 v81, 0xffff0000, v108
    v_lshlrev_b32 v82, 16, v109
    v_and_b32 v83, 0xffff0000, v109
    v_lshlrev_b32 v84, 16, v110
    v_and_b32 v85, 0xffff0000, v110
    v_lshlrev_b32 v86, 16, v111
    v_and_b32 v87, 0xffff0000, v111
    v_lshlrev_b32 v88, 16, v112
    v_and_b32 v89, 0xffff0000, v112
    v_lshlrev_b32 v90, 16, v113
    v_and_b32 v91, 0xffff0000, v113
    v_lshlrev_b32 v92, 16, v114
    v_and_b32 v93, 0xffff0000, v114
    v_lshlrev_b32 v94, 16, v115
    v_and_b32 v95, 0xffff0000, v115
    v_mov_b32 v116, 148992
    ds_read_b128 v[116:119], v116
    s_waitcnt lgkmcnt(0)
    v_min3_u32 v116, v116, v117, v118
    v_min_u32 v116, v116, v119
    v_cmp_gt_u32 vcc, 5, v116
    s_nop 1
    s_cbranch_vccz Lc99d
    s_nop 1
    s_mov_b32 s25, 2000000
Lc99:
    s_nop 0
    s_sleep 1
    v_mov_b32 v116, 148992
    ds_read_b128 v[116:119], v116
    s_waitcnt lgkmcnt(0)
    v_min3_u32 v116, v116, v117, v118
    v_min_u32 v116, v116, v119
    v_cmp_gt_u32 vcc, 5, v116
    s_nop 1
    s_cbranch_vccz Lc99d
    s_sub_u32 s25, s25, 1
    s_cmp_lg_u32 s25, 0
    s_cbranch_scc1 Lc99
    s_nop 0
Lc99d:
    ds_read_b128 v[16:19], v120 offset:0
    ds_read_b128 v[20:23], v120 offset:16
    ds_read_b128 v[24:27], v120 offset:32
    ds_read_b128 v[28:31], v120 offset:48
    ds_read_b128 v[32:35], v120 offset:14848
    ds_read_b128 v[36:39], v120 offset:14864
    ds_read_b128 v[40:43], v120 offset:14880
    ds_read_b128 v[44:47], v120 offset:14896
    ds_read_b128 v[48:51], v120 offset:29696
    ds_read_b128 v[52:55], v120 offset:29712
    ds_read_b128 v[56:59], v120 offset:29728
    ds_read_b128 v[60:63], v120 offset:29744
    ds_read_b128 v[64:67], v120 offset:44544
    ds_read_b128 v[68:71], v120 offset:44560
    ds_read_b128 v[72:75], v120 offset:44576
    ds_read_b128 v[76:79], v120 offset:44592
    s_mov_b32 s40, 0x7f7f7f7f
    s_mov_b32 s41, 0x7f7f7f7f
    s_mov_b32 s21, 6832128
    s_mov_b32 s22, 8667136
    s_waitcnt lgkmcnt(8)
    v_pk_add_f32 v[16:17], v[16:17], v[32:33]
    v_pk_add_f32 v[18:19], v[18:19], v[34:35]
    v_pk_add_f32 v[20:21], v[20:21], v[36:37]
    v_pk_add_f32 v[22:23], v[22:23], v[38:39]
    v_pk_add_f32 v[24:25], v[24:25], v[40:41]
    v_pk_add_f32 v[26:27], v[26:27], v[42:43]
    v_pk_add_f32 v[28:29], v[28:29], v[44:45]
    v_pk_add_f32 v[30:31], v[30:31], v[46:47]
    s_waitcnt lgkmcnt(0)
    v_mov_b32 v125, 6
    ds_write_b32 v126, v125
    v_pk_add_f32 v[48:49], v[48:49], v[64:65]
    v_pk_add_f32 v[50:51], v[50:51], v[66:67]
    v_pk_add_f32 v[52:53], v[52:53], v[68:69]
    v_pk_add_f32 v[54:55], v[54:55], v[70:71]
    v_pk_add_f32 v[56:57], v[56:57], v[72:73]
    v_pk_add_f32 v[58:59], v[58:59], v[74:75]
    v_pk_add_f32 v[60:61], v[60:61], v[76:77]
    v_pk_add_f32 v[62:63], v[62:63], v[78:79]
    v_pk_add_f32 v[16:17], v[16:17], v[48:49]
    v_pk_add_f32 v[18:19], v[18:19], v[50:51]
    v_pk_add_f32 v[20:21], v[20:21], v[52:53]
    v_pk_add_f32 v[22:23], v[22:23], v[54:55]
    v_pk_add_f32 v[24:25], v[24:25], v[56:57]
    v_pk_add_f32 v[26:27], v[26:27], v[58:59]
    v_pk_add_f32 v[28:29], v[28:29], v[60:61]
    v_pk_add_f32 v[30:31], v[30:31], v[62:63]
    v_cvt_pk_bf16_f32 v32, v16, v17
    v_cvt_pk_bf16_f32 v33, v18, v19
    v_cvt_pk_bf16_f32 v34, v20, v21
    v_cvt_pk_bf16_f32 v35, v22, v23
    v_cvt_pk_bf16_f32 v36, v24, v25
    v_cvt_pk_bf16_f32 v37, v26, v27
    v_cvt_pk_bf16_f32 v38, v28, v29
    v_cvt_pk_bf16_f32 v39, v30, v31
    v_lshlrev_b32 v16, 16, v32
    v_and_b32 v17, 0xffff0000, v32
    v_lshlrev_b32 v18, 16, v33
    v_and_b32 v19, 0xffff0000, v33
    v_lshlrev_b32 v20, 16, v34
    v_and_b32 v21, 0xffff0000, v34
    v_lshlrev_b32 v22, 16, v35
    v_and_b32 v23, 0xffff0000, v35
    v_lshlrev_b32 v24, 16, v36
    v_and_b32 v25, 0xffff0000, v36
    v_lshlrev_b32 v26, 16, v37
    v_and_b32 v27, 0xffff0000, v37
    v_lshlrev_b32 v28, 16, v38
    v_and_b32 v29, 0xffff0000, v38
    v_lshlrev_b32 v30, 16, v39
    v_and_b32 v31, 0xffff0000, v39
    v_pk_add_f32 v[16:17], v[16:17], v[80:81]
    v_pk_add_f32 v[18:19], v[18:19], v[82:83]
    v_pk_add_f32 v[20:21], v[20:21], v[84:85]
    v_pk_add_f32 v[22:23], v[22:23], v[86:87]
    v_pk_add_f32 v[24:25], v[24:25], v[88:89]
    v_pk_add_f32 v[26:27], v[26:27], v[90:91]
    v_pk_add_f32 v[28:29], v[28:29], v[92:93]
    v_pk_add_f32 v[30:31], v[30:31], v[94:95]
    v_cvt_pk_bf16_f32 v108, v16, v17
    v_cvt_pk_bf16_f32 v109, v18, v19
    v_cvt_pk_bf16_f32 v110, v20, v21
    v_cvt_pk_bf16_f32 v111, v22, v23
    v_cvt_pk_bf16_f32 v112, v24, v25
    v_cvt_pk_bf16_f32 v113, v26, v27
    v_cvt_pk_bf16_f32 v114, v28, v29
    v_cvt_pk_bf16_f32 v115, v30, v31
    v_mov_b32 v64, 0
    v_mov_b32 v65, 0
    v_mov_b32 v66, 0
    v_mov_b32 v67, 0
    v_mov_b32 v68, 0x3f803f80
    s_mov_b64 exec, s[40:41]
    s_cmp_lg_u32 s45, 0
    s_cbranch_scc1 Ltw100p
    buffer_store_dwordx4 v[108:111], v122, s[4:7], s21 offen offset:0 sc1
    buffer_store_dwordx4 v[112:115], v122, s[4:7], s21 offen offset:512 sc1
    s_branch Ltw100d
Ltw100p:
    buffer_store_dwordx4 v[108:111], v122, s[4:7], s21 offen offset:0
    buffer_store_dwordx4 v[112:115], v122, s[4:7], s21 offen offset:512
Ltw100d:
    v_dot2c_f32_bf16 v64, v108, v68
    v_dot2c_f32_bf16 v65, v108, v108
    v_dot2c_f32_bf16 v66, v109, v68
    v_dot2c_f32_bf16 v67, v109, v109
    v_dot2c_f32_bf16 v64, v110, v68
    v_dot2c_f32_bf16 v65, v110, v110
    v_dot2c_f32_bf16 v66, v111, v68
    v_dot2c_f32_bf16 v67, v111, v111
    v_dot2c_f32_bf16 v64, v112, v68
    v_dot2c_f32_bf16 v65, v112, v112
    v_dot2c_f32_bf16 v66, v113, v68
    v_dot2c_f32_bf16 v67, v113, v113
    v_dot2c_f32_bf16 v64, v114, v68
    v_dot2c_f32_bf16 v65, v114, v114
    v_dot2c_f32_bf16 v66, v115, v68
    v_dot2c_f32_bf16 v67, v115, v115
    s_mov_b64 exec, -1
    s_mov_b32 s40, 0x01010101
    s_mov_b32 s41, 0x01010101
    s_nop 1
    v_add_f32 v64, v64, v66
    v_add_f32 v65, v65, v67
    s_nop 0
    v_add_f32_dpp v66, v64, v64 quad_perm:[1,0,3,2] row_mask:0xf bank_mask:0xf
    v_add_f32_dpp v67, v65, v65 quad_perm:[1,0,3,2] row_mask:0xf bank_mask:0xf
    s_nop 0
    v_add_f32_dpp v64, v66, v66 quad_perm:[2,3,0,1] row_mask:0xf bank_mask:0xf
    v_add_f32_dpp v65, v67, v67 quad_perm:[2,3,0,1] row_mask:0xf bank_mask:0xf
    s_nop 0
    v_add_f32_dpp v66, v64, v64 row_half_mirror row_mask:0xf bank_mask:0xf
    v_add_f32_dpp v67, v65, v65 row_half_mirror row_mask:0xf bank_mask:0xf
    s_mov_b64 exec, s[40:41]
    s_cmp_lg_u32 s45, 0
    s_cbranch_scc1 Ltw101p
    buffer_store_dwordx2 v[66:67], v124, s[4:7], s22 offen sc1
    s_branch Ltw101d
Ltw101p:
    buffer_store_dwordx2 v[66:67], v124, s[4:7], s22 offen
Ltw101d:
    s_mov_b64 exec, -1
    v_mov_b32 v4, 3
    v_mov_b32 v5, 0
    s_waitcnt vmcnt(0)
    s_mov_b64 exec, 1
    s_cmp_lg_u32 s45, 0
    s_cbranch_scc1 Ltw102p
    buffer_store_dword v4, v5, s[4:7], s28 offen sc1
    s_branch Ltw102d
Ltw102p:
    buffer_store_dword v4, v5, s[4:7], s28 offen
Ltw102d:
    s_mov_b64 exec, -1
    s_mul_i32 s24, s26, 112
    s_mul_i32 s23, s17, 7
    s_add_u32 s24, s24, s23
    s_lshl_b32 s24, s24, 10
    s_add_u32 s24, s24, 21315584
    s_add_u32 s22, s24, 4096
    v_accvgpr_read_b32 v7, a124
    s_mov_b32 s25, 200000
Lpoll103:
    s_nop 3
    buffer_load_dword v4, v7, s[4:7], 0 offen sc1
    s_waitcnt vmcnt(0)
    v_cmp_gt_u32 vcc, 3, v4
    s_nop 1
    s_cbranch_vccz Lpoll103d
    s_sub_u32 s25, s25, 1
    s_cmp_lg_u32 s25, 0
    s_cbranch_scc1 Lpoll103
Lpoll103d:
    s_nop 0
    s_mul_i32 s47, s26, 28672
    s_add_u32 s47, s47, 6832128
    s_lshl_b32 s23, s26, 10
    s_add_u32 s23, s23, 8667136
    v_and_b32 v4, 31, v0
    v_lshlrev_b32 v4, 5, v4
    buffer_load_dwordx4 a[0:3], v1, s[4:7], s47 offen offset:0 sc1
    buffer_load_dwordx4 a[4:7], v1, s[4:7], s47 offen offset:1024 sc1
    buffer_load_dwordx4 a[8:11], v1, s[4:7], s47 offen offset:2048 sc1
    buffer_load_dwordx4 a[12:15], v1, s[4:7], s47 offen offset:3072 sc1
    s_add_u32 s47, s47, 4096
    buffer_load_dwordx4 a[16:19], v1, s[4:7], s47 offen offset:0 sc1
    buffer_load_dwordx4 a[20:23], v1, s[4:7], s47 offen offset:1024 sc1
    buffer_load_dwordx4 v[96:99], v4, s[4:7], s23 offen sc1
    buffer_load_dwordx4 v[100:103], v4, s[4:7], s23 offen offset:16 sc1
    buffer_load_dwordx4 a[24:27], v1, s[4:7], s47 offen offset:2048 sc1
    buffer_load_dwordx4 a[28:31], v1, s[4:7], s47 offen offset:3072 sc1
    s_add_u32 s47, s47, 4096
    buffer_load_dwordx4 a[32:35], v1, s[4:7], s47 offen offset:0 sc1
    buffer_load_dwordx4 a[36:39], v1, s[4:7], s47 offen offset:1024 sc1
    buffer_load_dwordx4 a[40:43], v1, s[4:7], s47 offen offset:2048 sc1
    buffer_load_dwordx4 a[44:47], v1, s[4:7], s47 offen offset:3072 sc1
    s_add_u32 s47, s47, 4096
    buffer_load_dwordx4 a[48:51], v1, s[4:7], s47 offen offset:0 sc1
    buffer_load_dwordx4 a[52:55], v1, s[4:7], s47 offen offset:1024 sc1
    v_mov_b32 v116, 149008
    ds_read_b128 v[116:119], v116
    s_waitcnt lgkmcnt(0)
    v_min3_u32 v116, v116, v117, v118
    v_min_u32 v116, v116, v119
    v_cmp_gt_u32 vcc, 6, v116
    s_nop 1
    s_cbranch_vccz Lc104d
    s_nop 1
    s_mov_b32 s25, 2000000
Lc104:
    s_nop 0
    s_sleep 1
    v_mov_b32 v116, 149008
    ds_read_b128 v[116:119], v116
    s_waitcnt lgkmcnt(0)
    v_min3_u32 v116, v116, v117, v118
    v_min_u32 v116, v116, v119
    v_cmp_gt_u32 vcc, 6, v116
    s_nop 1
    s_cbranch_vccz Lc104d
    s_sub_u32 s25, s25, 1
    s_cmp_lg_u32 s25, 0
    s_cbranch_scc1 Lc104
    s_nop 0
Lc104d:
    ds_read_b128 v[80:83], v1 offset:0
    ds_read_b128 v[84:87], v1 offset:29696
    ds_read_b128 v[88:91], v1 offset:59392
    ds_read_b128 v[92:95], v1 offset:1024
    ds_read_b128 a[116:119], v1 offset:30720
    s_waitcnt vmcnt(15)
    s_waitcnt lgkmcnt(4)
    v_mfma_f32_32x32x16_bf16 v[16:31], v[80:83], a[0:3], 0
    ds_read_b128 a[120:123], v1 offset:60416
    buffer_load_dwordx4 a[56:59], v1, s[4:7], s47 offen offset:2048 sc1
    s_waitcnt lgkmcnt(4)
    v_mfma_f32_32x32x16_bf16 v[32:47], v[84:87], a[0:3], 0
    ds_read_b128 v[80:83], v1 offset:2048
    s_waitcnt lgkmcnt(4)
    v_mfma_f32_32x32x16_bf16 v[48:63], v[88:91], a[0:3], 0
    ds_read_b128 v[84:87], v1 offset:31744
    buffer_load_dwordx4 a[60:63], v1, s[4:7], s47 offen offset:3072 sc1
    s_add_u32 s47, s47, 4096
    s_waitcnt vmcnt(16)
    s_waitcnt lgkmcnt(4)
    v_mfma_f32_32x32x16_bf16 v[16:31], v[92:95], a[4:7], v[16:31]
    ds_read_b128 v[88:91], v1 offset:61440
    s_waitcnt lgkmcnt(4)
    v_mfma_f32_32x32x16_bf16 v[32:47], a[116:119], a[4:7], v[32:47]
    ds_read_b128 v[92:95], v1 offset:3072
    buffer_load_dwordx4 a[64:67], v1, s[4:7], s47 offen offset:0 sc1
    s_waitcnt lgkmcnt(4)
    v_mfma_f32_32x32x16_bf16 v[48:63], a[120:123], a[4:7], v[48:63]
    ds_read_b128 a[116:119], v1 offset:32768
    s_waitcnt vmcnt(16)
    s_waitcnt lgkmcnt(4)
    v_mfma_f32_32x32x16_bf16 v[16:31], v[80:83], a[8:11], v[16:31]
    ds_read_b128 a[120:123], v1 offset:62464
    buffer_load_dwordx4 a[68:71], v1, s[4:7], s47 offen offset:1024 sc1
    s_waitcnt lgkmcnt(4)
    v_mfma_f32_32x32x16_bf16 v[32:47], v[84:87], a[8:11], v[32:47]
    ds_read_b128 v[80:83], v1 offset:4096
    s_waitcnt lgkmcnt(4)
    v_mfma_f32_32x32x16_bf16 v[48:63], v[88:91], a[8:11], v[48:63]
    ds_read_b128 v[84:87], v1 offset:33792
    buffer_load_dwordx4 a[72:75], v1, s[4:7], s47 offen offset:2048 sc1
    s_waitcnt vmcnt(17)
    s_waitcnt lgkmcnt(4)
    v_mfma_f32_32x32x16_bf16 v[16:31], v[92:95], a[12:15], v[16:31]
    ds_read_b128 v[88:91], v1 offset:63488
    s_waitcnt lgkmcnt(4)
    v_mfma_f32_32x32x16_bf16 v[32:47], a[116:119], a[12:15], v[32:47]
    ds_read_b128 v[92:95], v1 offset:5120
    buffer_load_dwordx4 a[76:79], v1, s[4:7], s47 offen offset:3072 sc1
    s_add_u32 s47, s47, 4096
    s_waitcnt lgkmcnt(4)
    v_mfma_f32_32x32x16_bf16 v[48:63], a[120:123], a[12:15], v[48:63]
    ds_read_b128 a[116:119], v1 offset:34816
    s_waitcnt vmcnt(17)
    s_waitcnt lgkmcnt(4)
    v_mfma_f32_32x32x16_bf16 v[16:31], v[80:83], a[16:19], v[16:31]
    ds_read_b128 a[120:123], v1 offset:64512
    buffer_load_dwordx4 a[80:83], v1, s[4:7], s47 offen offset:0 sc1
    s_waitcnt lgkmcnt(4)
    v_mfma_f32_32x32x16_bf16 v[32:47], v[84:87], a[16:19], v[32:47]
    ds_read_b128 v[80:83], v1 offset:6144
    s_waitcnt lgkmcnt(4)
    v_mfma_f32_32x32x16_bf16 v[48:63], v[88:91], a[16:19], v[48:63]
    ds_read_b128 v[84:87], v1 offset:35840
    buffer_load_dwordx4 a[84:87], v1, s[4:7], s47 offen offset:1024 sc1
    s_waitcnt vmcnt(18)
    s_waitcnt lgkmcnt(4)
    v_mfma_f32_32x32x16_bf16 v[16:31], v[92:95], a[20:23], v[16:31]
    ds_read_b128 v[88:91], v2 offset:0
    s_waitcnt lgkmcnt(4)
    v_mfma_f32_32x32x16_bf16 v[32:47], a[116:119], a[20:23], v[32:47]
    ds_read_b128 v[92:95], v1 offset:7168
    buffer_load_dwordx4 a[88:91], v1, s[4:7], s47 offen offset:2048 sc1
    s_waitcnt lgkmcnt(4)
    v_mfma_f32_32x32x16_bf16 v[48:63], a[120:123], a[20:23], v[48:63]
    ds_read_b128 a[116:119], v1 offset:36864
    s_waitcnt vmcnt(16)
    s_waitcnt lgkmcnt(4)
    v_mfma_f32_32x32x16_bf16 v[16:31], v[80:83], a[24:27], v[16:31]
    ds_read_b128 a[120:123], v2 offset:1024
    buffer_load_dwordx4 a[92:95], v1, s[4:7], s47 offen offset:3072 sc1
    s_add_u32 s47, s47, 4096
    s_waitcnt lgkmcnt(4)
    v_mfma_f32_32x32x16_bf16 v[32:47], v[84:87], a[24:27], v[32:47]
    ds_read_b128 v[80:83], v1 offset:8192
    s_waitcnt lgkmcnt(4)
    v_mfma_f32_32x32x16_bf16 v[48:63], v[88:91], a[24:27], v[48:63]
    ds_read_b128 v[84:87], v1 offset:37888
    buffer_load_dwordx4 a[96:99], v1, s[4:7], s47 offen offset:0 sc1
    s_waitcnt vmcnt(17)
    s_waitcnt lgkmcnt(4)
    v_mfma_f32_32x32x16_bf16 v[16:31], v[92:95], a[28:31], v[16:31]
    ds_read_b128 v[88:91], v2 offset:2048
    s_waitcnt lgkmcnt(4)
    v_mfma_f32_32x32x16_bf16 v[32:47], a[116:119], a[28:31], v[32:47]
    ds_read_b128 v[92:95], v1 offset:9216
    buffer_load_dwordx4 a[100:103], v1, s[4:7], s47 offen offset:1024 sc1
    s_waitcnt lgkmcnt(4)
    v_mfma_f32_32x32x16_bf16 v[48:63], a[120:123], a[28:31], v[48:63]
    ds_read_b128 a[116:119], v1 offset:38912
    s_waitcnt vmcnt(17)
    s_waitcnt lgkmcnt(4)
    v_mfma_f32_32x32x16_bf16 v[16:31], v[80:83], a[32:35], v[16:31]
    ds_read_b128 a[120:123], v2 offset:3072
    buffer_load_dwordx4 a[104:107], v1, s[4:7], s47 offen offset:2048 sc1
    s_waitcnt lgkmcnt(4)
    v_mfma_f32_32x32x16_bf16 v[32:47], v[84:87], a[32:35], v[32:47]
    ds_read_b128 v[80:83], v1 offset:10240
    s_waitcnt lgkmcnt(4)
    v_mfma_f32_32x32x16_bf16 v[48:63], v[88:91], a[32:35], v[48:63]
    ds_read_b128 v[84:87], v1 offset:39936
    buffer_load_dwordx4 a[108:111], v1, s[4:7], s47 offen offset:3072 sc1
    v_mov_b32 v125, 7
    ds_write_b32 v126, v125
    s_waitcnt vmcnt(18)
    s_waitcnt lgkmcnt(5)
    v_mfma_f32_32x32x16_bf16 v[16:31], v[92:95], a[36:39], v[16:31]
    ds_read_b128 v[88:91], v2 offset:4096
    s_waitcnt lgkmcnt(5)
    v_mfma_f32_32x32x16_bf16 v[32:47], a[116:119], a[36:39], v[32:47]
    ds_read_b128 v[92:95], v1 offset:11264
    s_waitcnt lgkmcnt(5)
    v_mfma_f32_32x32x16_bf16 v[48:63], a[120:123], a[36:39], v[48:63]
    ds_read_b128 a[116:119], v1 offset:40960
    s_waitcnt vmcnt(17)
    s_waitcnt lgkmcnt(5)
    v_mfma_f32_32x32x16_bf16 v[16:31], v[80:83], a[40:43], v[16:31]
    ds_read_b128 a[120:123], v2 offset:5120
    s_waitcnt lgkmcnt(5)
    v_mfma_f32_32x32x16_bf16 v[32:47], v[84:87], a[40:43], v[32:47]
    ds_read_b128 v[80:83], v1 offset:12288
    s_waitcnt lgkmcnt(4)
    v_mfma_f32_32x32x16_bf16 v[48:63], v[88:91], a[40:43], v[48:63]
    ds_read_b128 v[84:87], v1 offset:41984
    s_waitcnt vmcnt(16)
    s_waitcnt lgkmcnt(4)
    v_mfma_f32_32x32x16_bf16 v[16:31], v[92:95], a[44:47], v[16:31]
    ds_read_b128 v[88:91], v2 offset:6144
    s_waitcnt lgkmcnt(4)
    v_mfma_f32_32x32x16_bf16 v[32:47], a[116:119], a[44:47], v[32:47]
    ds_read_b128 v[92:95], v1 offset:13312
    s_waitcnt lgkmcnt(4)
    v_mfma_f32_32x32x16_bf16 v[48:63], a[120:123], a[44:47], v[48:63]
    ds_read_b128 a[116:119], v1 offset:43008
    s_waitcnt vmcnt(15)
    s_waitcnt lgkmcnt(4)
    v_mfma_f32_32x32x16_bf16 v[16:31], v[80:83], a[48:51], v[16:31]
    ds_read_b128 a[120:123], v2 offset:7168
    v_add_f32 v96, v96, v98
    v_add_f32 v100, v100, v102
    v_add_f32 v97, v97, v99
    v_add_f32 v101, v101, v103
    s_waitcnt lgkmcnt(4)
    v_mfma_f32_32x32x16_bf16 v[32:47], v[84:87], a[48:51], v[32:47]
    ds_read_b128 v[80:83], v1 offset:14336
    v_add_f32 v96, v96, v100
    v_add_f32 v97, v97, v101
    v_mul_f32 v96, 0x3b124925, v96
    v_mul_f32 v97, 0x3b124925, v97
    s_waitcnt lgkmcnt(4)
    v_mfma_f32_32x32x16_bf16 v[48:63], v[88:91], a[48:51], v[48:63]
    ds_read_b128 v[84:87], v1 offset:44032
    v_fma_f32 v97, -v96, v96, v97
    v_max_f32 v97, 0, v97
    v_cvt_pk_bf16_f32 v97, v97, v97
    v_lshlrev_b32 v97, 16, v97
    s_waitcnt vmcnt(14)
    s_waitcnt lgkmcnt(4)
    v_mfma_f32_32x32x16_bf16 v[16:31], v[92:95], a[52:55], v[16:31]
    ds_read_b128 v[88:91], v2 offset:8192
    v_add_f32 v97, 0x3727c5ac, v97
    v_cvt_pk_bf16_f32 v97, v97, v97
    v_lshlrev_b32 v97, 16, v97
    v_sqrt_f32 v97, v97
    s_waitcnt lgkmcnt(4)
    v_mfma_f32_32x32x16_bf16 v[32:47], a[116:119], a[52:55], v[32:47]
    ds_read_b128 v[92:95], v1 offset:15360
    v_sub_f32 v96, 0, v96
    v_cvt_pk_bf16_f32 v105, v97, v97
    v_lshlrev_b32 v105, 16, v105
    v_rcp_f32 v104, v105
    s_waitcnt lgkmcnt(4)
    v_mfma_f32_32x32x16_bf16 v[48:63], a[120:123], a[52:55], v[48:63]
    ds_read_b128 a[116:119], v1 offset:45056
    v_cvt_pk_bf16_f32 v98, v96, v96
    v_and_b32 v99, 0xffff, v98
    v_accvgpr_write_b32 a112, v98
    v_accvgpr_write_b32 a113, v99
    s_waitcnt vmcnt(13)
    s_waitcnt lgkmcnt(4)
    v_mfma_f32_32x32x16_bf16 v[16:31], v[80:83], a[56:59], v[16:31]
    ds_read_b128 a[120:123], v2 offset:9216
    v_accvgpr_write_b32 a114, v98
    v_accvgpr_write_b32 a115, v99
    v_mul_f32 v13, 0xc0135761, v104
    v_mul_f32 v14, v104, v104
    s_waitcnt lgkmcnt(4)
    v_mfma_f32_32x32x16_bf16 v[32:47], v[84:87], a[56:59], v[32:47]
    ds_read_b128 v[80:83], v1 offset:16384
    v_mul_f32 v14, v14, v13
    v_mul_f32 v14, 0x3d372713, v14
    v_mul_f32 v12, v105, v105
    s_waitcnt lgkmcnt(4)
    v_mfma_f32_32x32x16_bf16 v[48:63], v[88:91], a[56:59], v[48:63]
    ds_read_b128 v[84:87], v1 offset:46080
    s_waitcnt vmcnt(12)
    s_waitcnt lgkmcnt(4)
    v_mfma_f32_32x32x16_bf16 v[16:31], v[92:95], a[60:63], v[16:31]
    ds_read_b128 v[88:91], v2 offset:10240
    s_waitcnt lgkmcnt(4)
    v_mfma_f32_32x32x16_bf16 v[32:47], a[116:119], a[60:63], v[32:47]
    ds_read_b128 v[92:95], v1 offset:17408
    s_waitcnt lgkmcnt(4)
    v_mfma_f32_32x32x16_bf16 v[48:63], a[120:123], a[60:63], v[48:63]
    ds_read_b128 a[116:119], v1 offset:47104
    s_waitcnt vmcnt(11)
    s_waitcnt lgkmcnt(4)
    v_mfma_f32_32x32x16_bf16 v[16:31], v[80:83], a[64:67], v[16:31]
    ds_read_b128 a[120:123], v2 offset:11264
    s_waitcnt lgkmcnt(4)
    v_mfma_f32_32x32x16_bf16 v[32:47], v[84:87], a[64:67], v[32:47]
    ds_read_b128 v[80:83], v1 offset:18432
    s_waitcnt lgkmcnt(4)
    v_mfma_f32_32x32x16_bf16 v[48:63], v[88:91], a[64:67], v[48:63]
    ds_read_b128 v[84:87], v1 offset:48128
    s_waitcnt vmcnt(10)
    s_waitcnt lgkmcnt(4)
    v_mfma_f32_32x32x16_bf16 v[16:31], v[92:95], a[68:71], v[16:31]
    ds_read_b128 v[88:91], v2 offset:12288
    s_waitcnt lgkmcnt(4)
    v_mfma_f32_32x32x16_bf16 v[32:47], a[116:119], a[68:71], v[32:47]
    ds_read_b128 v[92:95], v1 offset:19456
    s_waitcnt lgkmcnt(4)
    v_mfma_f32_32x32x16_bf16 v[48:63], a[120:123], a[68:71], v[48:63]
    ds_read_b128 a[116:119], v1 offset:49152
    s_waitcnt vmcnt(9)
    s_waitcnt lgkmcnt(4)
    v_mfma_f32_32x32x16_bf16 v[16:31], v[80:83], a[72:75], v[16:31]
    ds_read_b128 a[120:123], v2 offset:13312
    s_waitcnt lgkmcnt(4)
    v_mfma_f32_32x32x16_bf16 v[32:47], v[84:87], a[72:75], v[32:47]
    ds_read_b128 v[80:83], v1 offset:20480
    s_waitcnt lgkmcnt(4)
    v_mfma_f32_32x32x16_bf16 v[48:63], v[88:91], a[72:75], v[48:63]
    ds_read_b128 v[84:87], v1 offset:50176
    s_waitcnt vmcnt(8)
    s_waitcnt lgkmcnt(4)
    v_mfma_f32_32x32x16_bf16 v[16:31], v[92:95], a[76:79], v[16:31]
    ds_read_b128 v[88:91], v2 offset:14336
    s_waitcnt lgkmcnt(4)
    v_mfma_f32_32x32x16_bf16 v[32:47], a[116:119], a[76:79], v[32:47]
    ds_read_b128 v[92:95], v1 offset:21504
    s_waitcnt lgkmcnt(4)
    v_mfma_f32_32x32x16_bf16 v[48:63], a[120:123], a[76:79], v[48:63]
    ds_read_b128 a[116:119], v1 offset:51200
    s_waitcnt vmcnt(7)
    s_waitcnt lgkmcnt(4)
    v_mfma_f32_32x32x16_bf16 v[16:31], v[80:83], a[80:83], v[16:31]
    ds_read_b128 a[120:123], v2 offset:15360
    s_waitcnt lgkmcnt(4)
    v_mfma_f32_32x32x16_bf16 v[32:47], v[84:87], a[80:83], v[32:47]
    ds_read_b128 v[80:83], v1 offset:22528
    s_waitcnt lgkmcnt(4)
    v_mfma_f32_32x32x16_bf16 v[48:63], v[88:91], a[80:83], v[48:63]
    ds_read_b128 v[84:87], v1 offset:52224
    s_waitcnt vmcnt(6)
    s_waitcnt lgkmcnt(4)
    v_mfma_f32_32x32x16_bf16 v[16:31], v[92:95], a[84:87], v[16:31]
    ds_read_b128 v[88:91], v2 offset:16384
    s_waitcnt lgkmcnt(4)
    v_mfma_f32_32x32x16_bf16 v[32:47], a[116:119], a[84:87], v[32:47]
    ds_read_b128 v[92:95], v1 offset:23552
    s_waitcnt lgkmcnt(4)
    v_mfma_f32_32x32x16_bf16 v[48:63], a[120:123], a[84:87], v[48:63]
    ds_read_b128 a[116:119], v1 offset:53248
    s_waitcnt vmcnt(5)
    s_waitcnt lgkmcnt(4)
    v_mfma_f32_32x32x16_bf16 v[16:31], v[80:83], a[88:91], v[16:31]
    ds_read_b128 a[120:123], v2 offset:17408
    s_waitcnt lgkmcnt(4)
    v_mfma_f32_32x32x16_bf16 v[32:47], v[84:87], a[88:91], v[32:47]
    ds_read_b128 v[80:83], v1 offset:24576
    s_waitcnt lgkmcnt(4)
    v_mfma_f32_32x32x16_bf16 v[48:63], v[88:91], a[88:91], v[48:63]
    ds_read_b128 v[84:87], v1 offset:54272
    s_waitcnt vmcnt(4)
    s_waitcnt lgkmcnt(4)
    v_mfma_f32_32x32x16_bf16 v[16:31], v[92:95], a[92:95], v[16:31]
    ds_read_b128 v[88:91], v2 offset:18432
    s_waitcnt lgkmcnt(4)
    v_mfma_f32_32x32x16_bf16 v[32:47], a[116:119], a[92:95], v[32:47]
    ds_read_b128 v[92:95], v1 offset:25600
    s_waitcnt lgkmcnt(4)
    v_mfma_f32_32x32x16_bf16 v[48:63], a[120:123], a[92:95], v[48:63]
    ds_read_b128 a[116:119], v1 offset:55296
    s_waitcnt vmcnt(3)
    s_waitcnt lgkmcnt(4)
    v_mfma_f32_32x32x16_bf16 v[16:31], v[80:83], a[96:99], v[16:31]
    ds_read_b128 a[120:123], v2 offset:19456
    s_waitcnt lgkmcnt(4)
    v_mfma_f32_32x32x16_bf16 v[32:47], v[84:87], a[96:99], v[32:47]
    ds_read_b128 v[80:83], v1 offset:26624
    s_waitcnt lgkmcnt(4)
    v_mfma_f32_32x32x16_bf16 v[48:63], v[88:91], a[96:99], v[48:63]
    ds_read_b128 v[84:87], v1 offset:56320
    s_waitcnt vmcnt(2)
    s_waitcnt lgkmcnt(4)
    v_mfma_f32_32x32x16_bf16 v[16:31], v[92:95], a[100:103], v[16:31]
    ds_read_b128 v[88:91], v2 offset:20480
    s_waitcnt lgkmcnt(4)
    v_mfma_f32_32x32x16_bf16 v[32:47], a[116:119], a[100:103], v[32:47]
    ds_read_b128 v[92:95], v1 offset:27648
    s_waitcnt lgkmcnt(4)
    v_mfma_f32_32x32x16_bf16 v[48:63], a[120:123], a[100:103], v[48:63]
    ds_read_b128 a[116:119], v1 offset:57344
    v_mov_b32 v116, 149008
    ds_read_b128 v[116:119], v116
    s_waitcnt vmcnt(1)
    s_waitcnt lgkmcnt(5)
    v_mfma_f32_32x32x16_bf16 v[16:31], v[80:83], a[104:107], v[16:31]
    ds_read_b128 a[120:123], v2 offset:21504
    s_waitcnt lgkmcnt(5)
    v_mfma_f32_32x32x16_bf16 v[32:47], v[84:87], a[104:107], v[32:47]
    ds_read_b128 v[80:83], v1 offset:28672
    s_waitcnt lgkmcnt(5)
    v_mfma_f32_32x32x16_bf16 v[48:63], v[88:91], a[104:107], v[48:63]
    ds_read_b128 v[84:87], v1 offset:58368
    s_waitcnt vmcnt(0)
    s_waitcnt lgkmcnt(5)
    v_mfma_f32_32x32x16_bf16 v[16:31], v[92:95], a[108:111], v[16:31]
    ds_read_b128 v[88:91], v2 offset:22528
    s_waitcnt lgkmcnt(5)
    v_mfma_f32_32x32x16_bf16 v[32:47], a[116:119], a[108:111], v[32:47]
    s_waitcnt lgkmcnt(4)
    v_min3_u32 v116, v116, v117, v118
    v_min_u32 v116, v116, v119
    v_cmp_gt_u32 vcc, 7, v116
    s_nop 1
    s_cbranch_vccz Lc105d
    s_nop 4
    s_mov_b32 s25, 2000000
Lc105:
    s_nop 0
    s_sleep 1
    v_mov_b32 v116, 149008
    ds_read_b128 v[116:119], v116
    s_waitcnt lgkmcnt(0)
    v_min3_u32 v116, v116, v117, v118
    v_min_u32 v116, v116, v119
    v_cmp_gt_u32 vcc, 7, v116
    s_nop 1
    s_cbranch_vccz Lc105d
    s_sub_u32 s25, s25, 1
    s_cmp_lg_u32 s25, 0
    s_cbranch_scc1 Lc105
    s_nop 0
Lc105d:
    ds_read_b128 v[92:95], v2 offset:23552
    s_waitcnt lgkmcnt(4)
    v_mfma_f32_32x32x16_bf16 v[48:63], a[120:123], a[108:111], v[48:63]
    ds_read_b128 a[116:119], v2 offset:24576
    s_waitcnt lgkmcnt(4)
    v_mfma_f32_32x32x16_bf16 v[16:31], v[80:83], a[112:115], v[16:31]
    ds_read_b128 a[120:123], v2 offset:25600
    s_waitcnt lgkmcnt(4)
    v_mfma_f32_32x32x16_bf16 v[32:47], v[84:87], a[112:115], v[32:47]
    ds_read_b128 v[80:83], v2 offset:26624
    s_waitcnt lgkmcnt(4)
    v_mfma_f32_32x32x16_bf16 v[48:63], v[88:91], a[112:115], v[48:63]
    ds_read_b128 v[84:87], v2 offset:27648
    s_waitcnt lgkmcnt(4)
    v_mfma_f32_32x32x16_bf16 v[64:79], v[92:95], a[0:3], 0
    ds_read_b128 v[88:91], v2 offset:28672
    v_mov_b32 v125, 8
    ds_write_b32 v126, v125
    s_waitcnt lgkmcnt(5)
    v_mfma_f32_32x32x16_bf16 v[64:79], a[116:119], a[4:7], v[64:79]
    ds_read_b128 v[92:95], v2 offset:29696
    v_mul_f32 v96, v16, v16
    v_mul_f32 v97, v17, v17
    v_mul_f32 v98, v18, v18
    v_mul_f32 v99, v19, v19
    v_mul_f32 v100, v20, v20
    s_waitcnt lgkmcnt(5)
    v_mfma_f32_32x32x16_bf16 v[64:79], a[120:123], a[8:11], v[64:79]
    ds_read_b128 a[116:119], v2 offset:30720
    v_mul_f32 v101, v21, v21
    v_mul_f32 v102, v22, v22
    v_mul_f32 v103, v23, v23
    v_fma_f32 v96, v96, v14, v13
    v_fma_f32 v97, v97, v14, v13
    s_waitcnt lgkmcnt(5)
    v_mfma_f32_32x32x16_bf16 v[64:79], v[80:83], a[12:15], v[64:79]
    ds_read_b128 a[120:123], v2 offset:31744
    v_fma_f32 v98, v98, v14, v13
    v_fma_f32 v99, v99, v14, v13
    v_fma_f32 v100, v100, v14, v13
    v_fma_f32 v101, v101, v14, v13
    v_fma_f32 v102, v102, v14, v13
    s_waitcnt lgkmcnt(5)
    v_mfma_f32_32x32x16_bf16 v[64:79], v[84:87], a[16:19], v[64:79]
    ds_read_b128 v[80:83], v2 offset:32768
    v_fma_f32 v103, v103, v14, v13
    v_mul_f32 v96, v96, v16
    v_mul_f32 v97, v97, v17
    v_mul_f32 v98, v98, v18
    v_mul_f32 v99, v99, v19
    s_waitcnt lgkmcnt(5)
    v_mfma_f32_32x32x16_bf16 v[64:79], v[88:91], a[20:23], v[64:79]
    ds_read_b128 v[84:87], v2 offset:33792
    v_mul_f32 v100, v100, v20
    v_mul_f32 v101, v101, v21
    v_mul_f32 v102, v102, v22
    v_mul_f32 v103, v103, v23
    v_exp_f32 v96, v96
    s_waitcnt lgkmcnt(4)
    v_mfma_f32_32x32x16_bf16 v[64:79], v[92:95], a[24:27], v[64:79]
    ds_read_b128 v[88:91], v2 offset:34816
    v_mul_f32 v16, v16, v24
    v_exp_f32 v97, v97
    v_mul_f32 v17, v17, v25
    v_exp_f32 v98, v98
    s_waitcnt lgkmcnt(4)
    v_mfma_f32_32x32x16_bf16 v[64:79], a[116:119], a[28:31], v[64:79]
    ds_read_b128 v[92:95], v2 offset:35840
    v_mul_f32 v18, v18, v26
    v_exp_f32 v99, v99
    v_mul_f32 v19, v19, v27
    v_exp_f32 v100, v100
    s_waitcnt lgkmcnt(4)
    v_mfma_f32_32x32x16_bf16 v[64:79], a[120:123], a[32:35], v[64:79]
    ds_read_b128 a[116:119], v2 offset:36864
    v_mul_f32 v20, v20, v28
    v_exp_f32 v101, v101
    v_mul_f32 v21, v21, v29
    v_exp_f32 v102, v102
    s_waitcnt lgkmcnt(4)
    v_mfma_f32_32x32x16_bf16 v[64:79], v[80:83], a[36:39], v[64:79]
    ds_read_b128 a[120:123], v2 offset:37888
    v_mul_f32 v22, v22, v30
    v_exp_f32 v103, v103
    v_mul_f32 v23, v23, v31
    v_fma_f32 v96, v96, v12, v12
    s_waitcnt lgkmcnt(4)
    v_mfma_f32_32x32x16_bf16 v[64:79], v[84:87], a[40:43], v[64:79]
    ds_read_b128 v[80:83], v2 offset:38912
    v_fma_f32 v97, v97, v12, v12
    v_fma_f32 v98, v98, v12, v12
    v_fma_f32 v99, v99, v12, v12
    v_fma_f32 v100, v100, v12, v12
    v_fma_f32 v101, v101, v12, v12
    s_waitcnt lgkmcnt(4)
    v_mfma_f32_32x32x16_bf16 v[64:79], v[88:91], a[44:47], v[64:79]
    ds_read_b128 v[84:87], v2 offset:39936
    v_fma_f32 v102, v102, v12, v12
    v_fma_f32 v103, v103, v12, v12
    v_rcp_f32 v96, v96
    v_rcp_f32 v97, v97
    s_waitcnt lgkmcnt(4)
    v_mfma_f32_32x32x16_bf16 v[64:79], v[92:95], a[48:51], v[64:79]
    ds_read_b128 v[88:91], v2 offset:40960
    v_rcp_f32 v98, v98
    v_rcp_f32 v99, v99
    v_rcp_f32 v100, v100
    s_waitcnt lgkmcnt(4)
    v_mfma_f32_32x32x16_bf16 v[64:79], a[116:119], a[52:55], v[64:79]
    ds_read_b128 v[92:95], v2 offset:41984
    v_rcp_f32 v101, v101
    v_rcp_f32 v102, v102
    v_rcp_f32 v103, v103
    s_waitcnt lgkmcnt(4)
    v_mfma_f32_32x32x16_bf16 v[64:79], a[120:123], a[56:59], v[64:79]
    ds_read_b128 a[116:119], v2 offset:43008
    v_mul_f32 v96, v16, v96
    v_mul_f32 v97, v17, v97
    v_mul_f32 v98, v18, v98
    v_mul_f32 v99, v19, v99
    v_mul_f32 v100, v20, v100
    s_waitcnt lgkmcnt(4)
    v_mfma_f32_32x32x16_bf16 v[64:79], v[80:83], a[60:63], v[64:79]
    ds_read_b128 a[120:123], v2 offset:44032
    v_mul_f32 v101, v21, v101
    v_mul_f32 v102, v22, v102
    v_mul_f32 v103, v23, v103
    v_cvt_pk_bf16_f32 v104, v96, v97
    v_cvt_pk_bf16_f32 v105, v98, v99
    s_waitcnt lgkmcnt(4)
    v_mfma_f32_32x32x16_bf16 v[64:79], v[84:87], a[64:67], v[64:79]
    ds_read_b128 v[80:83], v2 offset:45056
    v_cvt_pk_bf16_f32 v106, v100, v101
    v_cvt_pk_bf16_f32 v107, v102, v103
    buffer_store_dwordx4 v[104:107], v1, s[4:7], s24 offen offset:0 sc1
    v_mul_f32 v96, v32, v32
    v_mul_f32 v97, v33, v33
    s_waitcnt lgkmcnt(4)
    v_mfma_f32_32x32x16_bf16 v[64:79], v[88:91], a[68:71], v[64:79]
    ds_read_b128 v[84:87], v2 offset:46080
    v_mul_f32 v98, v34, v34
    v_mul_f32 v99, v35, v35
    v_mul_f32 v100, v36, v36
    v_mul_f32 v101, v37, v37
    v_mul_f32 v102, v38, v38
    s_waitcnt lgkmcnt(4)
    v_mfma_f32_32x32x16_bf16 v[64:79], v[92:95], a[72:75], v[64:79]
    ds_read_b128 v[88:91], v2 offset:47104
    v_mul_f32 v103, v39, v39
    v_fma_f32 v96, v96, v14, v13
    v_fma_f32 v97, v97, v14, v13
    v_fma_f32 v98, v98, v14, v13
    v_fma_f32 v99, v99, v14, v13
    s_waitcnt lgkmcnt(4)
    v_mfma_f32_32x32x16_bf16 v[64:79], a[116:119], a[76:79], v[64:79]
    ds_read_b128 v[92:95], v2 offset:48128
    v_mov_b32 v116, 149008
    ds_read_b128 v[116:119], v116
    v_fma_f32 v100, v100, v14, v13
    v_fma_f32 v101, v101, v14, v13
    v_fma_f32 v102, v102, v14, v13
    v_fma_f32 v103, v103, v14, v13
    v_mul_f32 v96, v96, v32
    s_waitcnt lgkmcnt(5)
    v_mfma_f32_32x32x16_bf16 v[64:79], a[120:123], a[80:83], v[64:79]
    ds_read_b128 a[116:119], v2 offset:49152
    v_mul_f32 v97, v97, v33
    v_mul_f32 v98, v98, v34
    v_mul_f32 v99, v99, v35
    v_mul_f32 v100, v100, v36
    v_mul_f32 v101, v101, v37
    s_waitcnt lgkmcnt(5)
    v_mfma_f32_32x32x16_bf16 v[64:79], v[80:83], a[84:87], v[64:79]
    ds_read_b128 a[120:123], v2 offset:50176
    v_mul_f32 v102, v102, v38
    v_mul_f32 v103, v103, v39
    v_exp_f32 v96, v96
    v_mul_f32 v32, v32, v40
    s_waitcnt lgkmcnt(5)
    v_mfma_f32_32x32x16_bf16 v[64:79], v[84:87], a[88:91], v[64:79]
    ds_read_b128 v[80:83], v2 offset:51200
    v_exp_f32 v97, v97
    v_mul_f32 v33, v33, v41
    v_exp_f32 v98, v98
    s_waitcnt lgkmcnt(5)
    v_mfma_f32_32x32x16_bf16 v[64:79], v[88:91], a[92:95], v[64:79]
    ds_read_b128 v[84:87], v2 offset:52224
    v_mul_f32 v34, v34, v42
    v_exp_f32 v99, v99
    v_mul_f32 v35, v35, v43
    v_exp_f32 v100, v100
    s_waitcnt lgkmcnt(5)
    v_mfma_f32_32x32x16_bf16 v[64:79], v[92:95], a[96:99], v[64:79]
    s_waitcnt lgkmcnt(4)
    v_min3_u32 v116, v116, v117, v118
    v_min_u32 v116, v116, v119
    v_cmp_gt_u32 vcc, 8, v116
    s_nop 1
    s_cbranch_vccz Lc106d
    s_nop 4
    s_mov_b32 s25, 2000000
Lc106:
    s_nop 0
    s_sleep 1
    v_mov_b32 v116, 149008
    ds_read_b128 v[116:119], v116
    s_waitcnt lgkmcnt(0)
    v_min3_u32 v116, v116, v117, v118
    v_min_u32 v116, v116, v119
    v_cmp_gt_u32 vcc, 8, v116
    s_nop 1
    s_cbranch_vccz Lc106d
    s_sub_u32 s25, s25, 1
    s_cmp_lg_u32 s25, 0
    s_cbranch_scc1 Lc106
    s_nop 0
Lc106d:
    ds_read_b128 v[88:91], v2 offset:53248
    v_mul_f32 v36, v36, v44
    v_exp_f32 v101, v101
    v_mul_f32 v37, v37, v45
    v_exp_f32 v102, v102
    s_waitcnt lgkmcnt(4)
    v_mfma_f32_32x32x16_bf16 v[64:79], a[116:119], a[100:103], v[64:79]
    ds_read_b128 v[92:95], v2 offset:54272
    v_mul_f32 v38, v38, v46
    v_exp_f32 v103, v103
    v_mul_f32 v39, v39, v47
    v_fma_f32 v96, v96, v12, v12
    s_waitcnt lgkmcnt(4)
    v_mfma_f32_32x32x16_bf16 v[64:79], a[120:123], a[104:107], v[64:79]
    ds_read_b128 a[116:119], v2 offset:55296
    v_fma_f32 v97, v97, v12, v12
    v_fma_f32 v98, v98, v12, v12
    v_fma_f32 v99, v99, v12, v12
    v_fma_f32 v100, v100, v12, v12
    v_fma_f32 v101, v101, v12, v12
    s_waitcnt lgkmcnt(4)
    v_mfma_f32_32x32x16_bf16 v[64:79], v[80:83], a[108:111], v[64:79]
    ds_read_b128 a[120:123], v2 offset:56320
    v_fma_f32 v102, v102, v12, v12
    v_fma_f32 v103, v103, v12, v12
    v_rcp_f32 v96, v96
    v_rcp_f32 v97, v97
    s_waitcnt lgkmcnt(4)
    v_mfma_f32_32x32x16_bf16 v[64:79], v[84:87], a[112:115], v[64:79]
    ds_read_b128 v[80:83], v2 offset:57344
    v_rcp_f32 v98, v98
    v_rcp_f32 v99, v99
    v_rcp_f32 v100, v100
    s_waitcnt lgkmcnt(4)
    v_mfma_f32_32x32x16_bf16 v[16:31], v[88:91], a[0:3], 0
    ds_read_b128 v[84:87], v2 offset:58368
    v_mov_b32 v125, 9
    ds_write_b32 v126, v125
    v_rcp_f32 v101, v101
    v_rcp_f32 v102, v102
    v_rcp_f32 v103, v103
    s_waitcnt lgkmcnt(5)
    v_mfma_f32_32x32x16_bf16 v[16:31], v[92:95], a[4:7], v[16:31]
    ds_read_b128 v[88:91], v2 offset:59392
    v_mul_f32 v96, v32, v96
    v_mul_f32 v97, v33, v97
    v_mul_f32 v98, v34, v98
    v_mul_f32 v99, v35, v99
    v_mul_f32 v100, v36, v100
    s_waitcnt lgkmcnt(5)
    v_mfma_f32_32x32x16_bf16 v[16:31], a[116:119], a[8:11], v[16:31]
    ds_read_b128 v[92:95], v2 offset:60416
    v_mul_f32 v101, v37, v101
    v_mul_f32 v102, v38, v102
    v_mul_f32 v103, v39, v103
    v_cvt_pk_bf16_f32 v8, v96, v97
    v_cvt_pk_bf16_f32 v9, v98, v99
    s_waitcnt lgkmcnt(5)
    v_mfma_f32_32x32x16_bf16 v[16:31], a[120:123], a[12:15], v[16:31]
    ds_read_b128 a[116:119], v2 offset:61440
    v_cvt_pk_bf16_f32 v10, v100, v101
    v_cvt_pk_bf16_f32 v11, v102, v103
    buffer_store_dwordx4 v[8:11], v1, s[4:7], s24 offen offset:1024 sc1
    v_mul_f32 v96, v48, v48
    v_mul_f32 v97, v49, v49
    s_waitcnt lgkmcnt(5)
    v_mfma_f32_32x32x16_bf16 v[16:31], v[80:83], a[16:19], v[16:31]
    ds_read_b128 a[120:123], v2 offset:62464
    v_mul_f32 v98, v50, v50
    v_mul_f32 v99, v51, v51
    v_mul_f32 v100, v52, v52
    v_mul_f32 v101, v53, v53
    v_mul_f32 v102, v54, v54
    s_waitcnt lgkmcnt(5)
    v_mfma_f32_32x32x16_bf16 v[16:31], v[84:87], a[20:23], v[16:31]
    ds_read_b128 v[80:83], v2 offset:63488
    v_mul_f32 v103, v55, v55
    v_fma_f32 v96, v96, v14, v13
    v_fma_f32 v97, v97, v14, v13
    v_fma_f32 v98, v98, v14, v13
    v_fma_f32 v99, v99, v14, v13
    s_waitcnt lgkmcnt(4)
    v_mfma_f32_32x32x16_bf16 v[16:31], v[88:91], a[24:27], v[16:31]
    ds_read_b128 v[84:87], v2 offset:64512
    v_fma_f32 v100, v100, v14, v13
    v_fma_f32 v101, v101, v14, v13
    v_fma_f32 v102, v102, v14, v13
    v_fma_f32 v103, v103, v14, v13
    v_mul_f32 v96, v96, v48
    s_waitcnt lgkmcnt(4)
    v_mfma_f32_32x32x16_bf16 v[16:31], v[92:95], a[28:31], v[16:31]
    ds_read_b128 v[88:91], v3 offset:0
    v_mul_f32 v97, v97, v49
    v_mul_f32 v98, v98, v50
    v_mul_f32 v99, v99, v51
    v_mul_f32 v100, v100, v52
    v_mul_f32 v101, v101, v53
    s_waitcnt lgkmcnt(4)
    v_mfma_f32_32x32x16_bf16 v[16:31], a[116:119], a[32:35], v[16:31]
    ds_read_b128 v[92:95], v3 offset:1024
    v_mul_f32 v102, v102, v54
    v_mul_f32 v103, v103, v55
    v_exp_f32 v96, v96
    v_mul_f32 v48, v48, v56
    s_waitcnt lgkmcnt(4)
    v_mfma_f32_32x32x16_bf16 v[16:31], a[120:123], a[36:39], v[16:31]
    ds_read_b128 a[116:119], v3 offset:2048
    v_exp_f32 v97, v97
    v_mul_f32 v49, v49, v57
    v_exp_f32 v98, v98
    s_waitcnt lgkmcnt(4)
    v_mfma_f32_32x32x16_bf16 v[16:31], v[80:83], a[40:43], v[16:31]
    ds_read_b128 a[120:123], v3 offset:3072
    v_mul_f32 v50, v50, v58
    v_exp_f32 v99, v99
    v_mul_f32 v51, v51, v59
    v_exp_f32 v100, v100
    s_waitcnt lgkmcnt(4)
    v_mfma_f32_32x32x16_bf16 v[16:31], v[84:87], a[44:47], v[16:31]
    ds_read_b128 v[80:83], v3 offset:4096
    v_mul_f32 v52, v52, v60
    v_exp_f32 v101, v101
    v_mul_f32 v53, v53, v61
    v_exp_f32 v102, v102
    s_waitcnt lgkmcnt(4)
    v_mfma_f32_32x32x16_bf16 v[16:31], v[88:91], a[48:51], v[16:31]
    ds_read_b128 v[84:87], v3 offset:5120
    v_mul_f32 v54, v54, v62
    v_exp_f32 v103, v103
    v_mul_f32 v55, v55, v63
    v_fma_f32 v96, v96, v12, v12
    s_waitcnt lgkmcnt(4)
    v_mfma_f32_32x32x16_bf16 v[16:31], v[92:95], a[52:55], v[16:31]
    ds_read_b128 v[88:91], v3 offset:6144
    v_fma_f32 v97, v97, v12, v12
    v_fma_f32 v98, v98, v12, v12
    v_fma_f32 v99, v99, v12, v12
    v_fma_f32 v100, v100, v12, v12
    v_fma_f32 v101, v101, v12, v12
    s_waitcnt lgkmcnt(4)
    v_mfma_f32_32x32x16_bf16 v[16:31], a[116:119], a[56:59], v[16:31]
    ds_read_b128 v[92:95], v3 offset:7168
    v_fma_f32 v102, v102, v12, v12
    v_fma_f32 v103, v103, v12, v12
    v_rcp_f32 v96, v96
    v_rcp_f32 v97, v97
    s_waitcnt lgkmcnt(4)
    v_mfma_f32_32x32x16_bf16 v[16:31], a[120:123], a[60:63], v[16:31]
    ds_read_b128 a[116:119], v3 offset:8192
    v_rcp_f32 v98, v98
    v_rcp_f32 v99, v99
    v_rcp_f32 v100, v100
    s_waitcnt lgkmcnt(4)
    v_mfma_f32_32x32x16_bf16 v[16:31], v[80:83], a[64:67], v[16:31]
    ds_read_b128 a[120:123], v3 offset:9216
    v_rcp_f32 v101, v101
    v_rcp_f32 v102, v102
    v_rcp_f32 v103, v103
    s_waitcnt lgkmcnt(4)
    v_mfma_f32_32x32x16_bf16 v[16:31], v[84:87], a[68:71], v[16:31]
    ds_read_b128 v[80:83], v3 offset:10240
    v_mul_f32 v96, v48, v96
    v_mul_f32 v97, v49, v97
    v_mul_f32 v98, v50, v98
    v_mul_f32 v99, v51, v99
    v_mul_f32 v100, v52, v100
    s_waitcnt lgkmcnt(4)
    v_mfma_f32_32x32x16_bf16 v[16:31], v[88:91], a[72:75], v[16:31]
    ds_read_b128 v[84:87], v3 offset:11264
    v_mul_f32 v101, v53, v101
    v_mul_f32 v102, v54, v102
    v_mul_f32 v103, v55, v103
    v_cvt_pk_bf16_f32 v104, v96, v97
    v_cvt_pk_bf16_f32 v105, v98, v99
    s_waitcnt lgkmcnt(4)
    v_mfma_f32_32x32x16_bf16 v[16:31], v[92:95], a[76:79], v[16:31]
    ds_read_b128 v[88:91], v3 offset:12288
    v_mov_b32 v116, 149008
    ds_read_b128 v[116:119], v116
    v_cvt_pk_bf16_f32 v106, v100, v101
    v_cvt_pk_bf16_f32 v107, v102, v103
    buffer_store_dwordx4 v[104:107], v1, s[4:7], s24 offen offset:2048 sc1
    v_mul_f32 v96, v64, v64
    v_mul_f32 v97, v65, v65
    s_waitcnt lgkmcnt(5)
    v_mfma_f32_32x32x16_bf16 v[16:31], a[116:119], a[80:83], v[16:31]
    ds_read_b128 v[92:95], v3 offset:13312
    v_mul_f32 v98, v66, v66
    v_mul_f32 v99, v67, v67
    v_mul_f32 v100, v68, v68
    v_mul_f32 v101, v69, v69
    v_mul_f32 v102, v70, v70
    s_waitcnt lgkmcnt(5)
    v_mfma_f32_32x32x16_bf16 v[16:31], a[120:123], a[84:87], v[16:31]
    ds_read_b128 a[116:119], v3 offset:14336
    v_mul_f32 v103, v71, v71
    v_fma_f32 v96, v96, v14, v13
    v_fma_f32 v97, v97, v14, v13
    v_fma_f32 v98, v98, v14, v13
    v_fma_f32 v99, v99, v14, v13
    s_waitcnt lgkmcnt(5)
    v_mfma_f32_32x32x16_bf16 v[16:31], v[80:83], a[88:91], v[16:31]
    ds_read_b128 a[120:123], v3 offset:15360
    v_fma_f32 v100, v100, v14, v13
    v_fma_f32 v101, v101, v14, v13
    v_fma_f32 v102, v102, v14, v13
    v_fma_f32 v103, v103, v14, v13
    v_mul_f32 v96, v96, v64
    s_waitcnt lgkmcnt(5)
    v_mfma_f32_32x32x16_bf16 v[16:31], v[84:87], a[92:95], v[16:31]
    ds_read_b128 v[80:83], v3 offset:16384
    v_mul_f32 v97, v97, v65
    v_mul_f32 v98, v98, v66
    v_mul_f32 v99, v99, v67
    v_mul_f32 v100, v100, v68
    v_mul_f32 v101, v101, v69
    s_waitcnt lgkmcnt(5)
    v_mfma_f32_32x32x16_bf16 v[16:31], v[88:91], a[96:99], v[16:31]
    s_waitcnt lgkmcnt(4)
    v_min3_u32 v116, v116, v117, v118
    v_min_u32 v116, v116, v119
    v_cmp_gt_u32 vcc, 9, v116
    s_nop 1
    s_cbranch_vccz Lc107d
    s_nop 4
    s_mov_b32 s25, 2000000
Lc107:
    s_nop 0
    s_sleep 1
    v_mov_b32 v116, 149008
    ds_read_b128 v[116:119], v116
    s_waitcnt lgkmcnt(0)
    v_min3_u32 v116, v116, v117, v118
    v_min_u32 v116, v116, v119
    v_cmp_gt_u32 vcc, 9, v116
    s_nop 1
    s_cbranch_vccz Lc107d
    s_sub_u32 s25, s25, 1
    s_cmp_lg_u32 s25, 0
    s_cbranch_scc1 Lc107
    s_nop 0
Lc107d:
    ds_read_b128 v[84:87], v1 offset:0
    v_mul_f32 v102, v102, v70
    v_mul_f32 v103, v103, v71
    v_exp_f32 v96, v96
    v_mul_f32 v64, v64, v72
    s_waitcnt lgkmcnt(4)
    v_mfma_f32_32x32x16_bf16 v[16:31], v[92:95], a[100:103], v[16:31]
    ds_read_b128 v[88:91], v1 offset:1024
    v_exp_f32 v97, v97
    v_mul_f32 v65, v65, v73
    v_exp_f32 v98, v98
    s_waitcnt lgkmcnt(4)
    v_mfma_f32_32x32x16_bf16 v[16:31], a[116:119], a[104:107], v[16:31]
    ds_read_b128 v[92:95], v1 offset:2048
    v_mul_f32 v66, v66, v74
    v_exp_f32 v99, v99
    v_mul_f32 v67, v67, v75
    v_exp_f32 v100, v100
    s_waitcnt lgkmcnt(4)
    v_mfma_f32_32x32x16_bf16 v[16:31], a[120:123], a[108:111], v[16:31]
    ds_read_b128 a[116:119], v1 offset:3072
    v_mul_f32 v68, v68, v76
    v_exp_f32 v101, v101
    v_mul_f32 v69, v69, v77
    v_exp_f32 v102, v102
    s_waitcnt lgkmcnt(4)
    v_mfma_f32_32x32x16_bf16 v[16:31], v[80:83], a[112:115], v[16:31]
    ds_read_b128 a[120:123], v1 offset:4096
    v_mul_f32 v70, v70, v78
    v_exp_f32 v103, v103
    v_mul_f32 v71, v71, v79
    v_fma_f32 v96, v96, v12, v12
    s_waitcnt lgkmcnt(4)
    v_mfma_f32_32x32x16_bf16 v[32:47], v[84:87], a[0:3], 0
    ds_read_b128 v[80:83], v1 offset:5120
    v_mov_b32 v125, 10
    ds_write_b32 v126, v125
    v_fma_f32 v97, v97, v12, v12
    v_fma_f32 v98, v98, v12, v12
    v_fma_f32 v99, v99, v12, v12
    v_fma_f32 v100, v100, v12, v12
    v_fma_f32 v101, v101, v12, v12
    s_waitcnt lgkmcnt(5)
    v_mfma_f32_32x32x16_bf16 v[32:47], v[88:91], a[4:7], v[32:47]
    ds_read_b128 v[84:87], v1 offset:6144
    v_fma_f32 v102, v102, v12, v12
    v_fma_f32 v103, v103, v12, v12
    v_rcp_f32 v96, v96
    v_rcp_f32 v97, v97
    s_waitcnt lgkmcnt(5)
    v_mfma_f32_32x32x16_bf16 v[32:47], v[92:95], a[8:11], v[32:47]
    ds_read_b128 v[88:91], v1 offset:7168
    v_rcp_f32 v98, v98
    v_rcp_f32 v99, v99
    v_rcp_f32 v100, v100
    s_waitcnt lgkmcnt(5)
    v_mfma_f32_32x32x16_bf16 v[32:47], a[116:119], a[12:15], v[32:47]
    ds_read_b128 v[92:95], v1 offset:8192
    v_rcp_f32 v101, v101
    v_rcp_f32 v102, v102
    v_rcp_f32 v103, v103
    s_waitcnt lgkmcnt(5)
    v_mfma_f32_32x32x16_bf16 v[32:47], a[120:123], a[16:19], v[32:47]
    ds_read_b128 a[116:119], v1 offset:9216
    v_mul_f32 v96, v64, v96
    v_mul_f32 v97, v65, v97
    v_mul_f32 v98, v66, v98
    v_mul_f32 v99, v67, v99
    v_mul_f32 v100, v68, v100
    s_waitcnt lgkmcnt(5)
    v_mfma_f32_32x32x16_bf16 v[32:47], v[80:83], a[20:23], v[32:47]
    ds_read_b128 a[120:123], v1 offset:10240
    v_mul_f32 v101, v69, v101
    v_mul_f32 v102, v70, v102
    v_mul_f32 v103, v71, v103
    v_cvt_pk_bf16_f32 v8, v96, v97
    v_cvt_pk_bf16_f32 v9, v98, v99
    s_waitcnt lgkmcnt(4)
    v_mfma_f32_32x32x16_bf16 v[32:47], v[84:87], a[24:27], v[32:47]
    ds_read_b128 v[80:83], v1 offset:11264
    v_cvt_pk_bf16_f32 v10, v100, v101
    v_cvt_pk_bf16_f32 v11, v102, v103
    buffer_store_dwordx4 v[8:11], v1, s[4:7], s24 offen offset:3072 sc1
    v_mul_f32 v96, v16, v16
    v_mul_f32 v97, v17, v17
    s_waitcnt lgkmcnt(4)
    v_mfma_f32_32x32x16_bf16 v[32:47], v[88:91], a[28:31], v[32:47]
    ds_read_b128 v[84:87], v1 offset:12288
    v_mul_f32 v98, v18, v18
    v_mul_f32 v99, v19, v19
    v_mul_f32 v100, v20, v20
    v_mul_f32 v101, v21, v21
    v_mul_f32 v102, v22, v22
    s_waitcnt lgkmcnt(4)
    v_mfma_f32_32x32x16_bf16 v[32:47], v[92:95], a[32:35], v[32:47]
    ds_read_b128 v[88:91], v1 offset:13312
    v_mul_f32 v103, v23, v23
    v_fma_f32 v96, v96, v14, v13
    v_fma_f32 v97, v97, v14, v13
    v_fma_f32 v98, v98, v14, v13
    v_fma_f32 v99, v99, v14, v13
    s_waitcnt lgkmcnt(4)
    v_mfma_f32_32x32x16_bf16 v[32:47], a[116:119], a[36:39], v[32:47]
    ds_read_b128 v[92:95], v1 offset:14336
    v_fma_f32 v100, v100, v14, v13
    v_fma_f32 v101, v101, v14, v13
    v_fma_f32 v102, v102, v14, v13
    v_fma_f32 v103, v103, v14, v13
    v_mul_f32 v96, v96, v16
    s_waitcnt lgkmcnt(4)
    v_mfma_f32_32x32x16_bf16 v[32:47], a[120:123], a[40:43], v[32:47]
    ds_read_b128 a[116:119], v1 offset:15360
    v_mul_f32 v97, v97, v17
    v_mul_f32 v98, v98, v18
    v_mul_f32 v99, v99, v19
    v_mul_f32 v100, v100, v20
    v_mul_f32 v101, v101, v21
    s_waitcnt lgkmcnt(4)
    v_mfma_f32_32x32x16_bf16 v[32:47], v[80:83], a[44:47], v[32:47]
    ds_read_b128 a[120:123], v1 offset:16384
    v_mul_f32 v102, v102, v22
    v_mul_f32 v103, v103, v23
    v_exp_f32 v96, v96
    v_mul_f32 v16, v16, v24
    s_waitcnt lgkmcnt(4)
    v_mfma_f32_32x32x16_bf16 v[32:47], v[84:87], a[48:51], v[32:47]
    ds_read_b128 v[80:83], v1 offset:17408
    v_exp_f32 v97, v97
    v_mul_f32 v17, v17, v25
    v_exp_f32 v98, v98
    s_waitcnt lgkmcnt(4)
    v_mfma_f32_32x32x16_bf16 v[32:47], v[88:91], a[52:55], v[32:47]
    ds_read_b128 v[84:87], v1 offset:18432
    v_mul_f32 v18, v18, v26
    v_exp_f32 v99, v99
    v_mul_f32 v19, v19, v27
    v_exp_f32 v100, v100
    s_waitcnt lgkmcnt(4)
    v_mfma_f32_32x32x16_bf16 v[32:47], v[92:95], a[56:59], v[32:47]
    ds_read_b128 v[88:91], v1 offset:19456
    v_mul_f32 v20, v20, v28
    v_exp_f32 v101, v101
    v_mul_f32 v21, v21, v29
    v_exp_f32 v102, v102
    s_waitcnt lgkmcnt(4)
    v_mfma_f32_32x32x16_bf16 v[32:47], a[116:119], a[60:63], v[32:47]
    ds_read_b128 v[92:95], v1 offset:20480
    v_mul_f32 v22, v22, v30
    v_exp_f32 v103, v103
    v_mul_f32 v23, v23, v31
    v_fma_f32 v96, v96, v12, v12
    s_waitcnt lgkmcnt(4)
    v_mfma_f32_32x32x16_bf16 v[32:47], a[120:123], a[64:67], v[32:47]
    ds_read_b128 a[116:119], v1 offset:21504
    v_fma_f32 v97, v97, v12, v12
    v_fma_f32 v98, v98, v12, v12
    v_fma_f32 v99, v99, v12, v12
    v_fma_f32 v100, v100, v12, v12
    v_fma_f32 v101, v101, v12, v12
    s_waitcnt lgkmcnt(4)
    v_mfma_f32_32x32x16_bf16 v[32:47], v[80:83], a[68:71], v[32:47]
    ds_read_b128 a[120:123], v1 offset:22528
    v_fma_f32 v102, v102, v12, v12
    v_fma_f32 v103, v103, v12, v12
    v_rcp_f32 v96, v96
    v_rcp_f32 v97, v97
    s_waitcnt lgkmcnt(4)
    v_mfma_f32_32x32x16_bf16 v[32:47], v[84:87], a[72:75], v[32:47]
    ds_read_b128 v[80:83], v1 offset:23552
    v_rcp_f32 v98, v98
    v_rcp_f32 v99, v99
    v_rcp_f32 v100, v100
    s_waitcnt lgkmcnt(4)
    v_mfma_f32_32x32x16_bf16 v[32:47], v[88:91], a[76:79], v[32:47]
    ds_read_b128 v[84:87], v1 offset:24576
    v_mov_b32 v116, 149008
    ds_read_b128 v[116:119], v116
    v_rcp_f32 v101, v101
    v_rcp_f32 v102, v102
    v_rcp_f32 v103, v103
    s_waitcnt lgkmcnt(5)
    v_mfma_f32_32x32x16_bf16 v[32:47], v[92:95], a[80:83], v[32:47]
    ds_read_b128 v[88:91], v1 offset:25600
    v_mul_f32 v96, v16, v96
    v_mul_f32 v97, v17, v97
    v_mul_f32 v98, v18, v98
    v_mul_f32 v99, v19, v99
    v_mul_f32 v100, v20, v100
    s_waitcnt lgkmcnt(5)
    v_mfma_f32_32x32x16_bf16 v[32:47], a[116:119], a[84:87], v[32:47]
    ds_read_b128 v[92:95], v1 offset:26624
    v_mul_f32 v101, v21, v101
    v_mul_f32 v102, v22, v102
    v_mul_f32 v103, v23, v103
    v_cvt_pk_bf16_f32 v104, v96, v97
    v_cvt_pk_bf16_f32 v105, v98, v99
    s_waitcnt lgkmcnt(5)
    v_mfma_f32_32x32x16_bf16 v[32:47], a[120:123], a[88:91], v[32:47]
    ds_read_b128 a[116:119], v1 offset:27648
    v_cvt_pk_bf16_f32 v106, v100, v101
    v_cvt_pk_bf16_f32 v107, v102, v103
    buffer_store_dwordx4 v[104:107], v1, s[4:7], s22 offen offset:0 sc1
    s_waitcnt lgkmcnt(5)
    v_mfma_f32_32x32x16_bf16 v[32:47], v[80:83], a[92:95], v[32:47]
    ds_read_b128 a[120:123], v1 offset:28672
    s_waitcnt lgkmcnt(5)
    v_mfma_f32_32x32x16_bf16 v[32:47], v[84:87], a[96:99], v[32:47]
    s_waitcnt lgkmcnt(4)
    v_min3_u32 v116, v116, v117, v118
    v_min_u32 v116, v116, v119
    v_cmp_gt_u32 vcc, 10, v116
    s_nop 1
    s_cbranch_vccz Lc108d
    s_nop 4
    s_mov_b32 s25, 2000000
Lc108:
    s_nop 0
    s_sleep 1
    v_mov_b32 v116, 149008
    ds_read_b128 v[116:119], v116
    s_waitcnt lgkmcnt(0)
    v_min3_u32 v116, v116, v117, v118
    v_min_u32 v116, v116, v119
    v_cmp_gt_u32 vcc, 10, v116
    s_nop 1
    s_cbranch_vccz Lc108d
    s_sub_u32 s25, s25, 1
    s_cmp_lg_u32 s25, 0
    s_cbranch_scc1 Lc108
    s_nop 0
Lc108d:
    ds_read_b128 v[80:83], v1 offset:29696
    s_waitcnt lgkmcnt(4)
    v_mfma_f32_32x32x16_bf16 v[32:47], v[88:91], a[100:103], v[32:47]
    ds_read_b128 v[84:87], v1 offset:30720
    s_waitcnt lgkmcnt(4)
    v_mfma_f32_32x32x16_bf16 v[32:47], v[92:95], a[104:107], v[32:47]
    ds_read_b128 v[88:91], v1 offset:31744
    s_waitcnt lgkmcnt(4)
    v_mfma_f32_32x32x16_bf16 v[32:47], a[116:119], a[108:111], v[32:47]
    ds_read_b128 v[92:95], v1 offset:32768
    s_waitcnt lgkmcnt(4)
    v_mfma_f32_32x32x16_bf16 v[32:47], a[120:123], a[112:115], v[32:47]
    ds_read_b128 a[116:119], v1 offset:33792
    s_waitcnt lgkmcnt(4)
    v_mfma_f32_32x32x16_bf16 v[48:63], v[80:83], a[0:3], 0
    ds_read_b128 a[120:123], v1 offset:34816
    v_mov_b32 v125, 11
    ds_write_b32 v126, v125
    s_waitcnt lgkmcnt(5)
    v_mfma_f32_32x32x16_bf16 v[48:63], v[84:87], a[4:7], v[48:63]
    ds_read_b128 v[80:83], v1 offset:35840
    s_nop 2
    v_mul_f32 v96, v32, v32
    v_mul_f32 v97, v33, v33
    v_mul_f32 v98, v34, v34
    v_mul_f32 v99, v35, v35
    v_mul_f32 v100, v36, v36
    s_waitcnt lgkmcnt(5)
    v_mfma_f32_32x32x16_bf16 v[48:63], v[88:91], a[8:11], v[48:63]
    ds_read_b128 v[84:87], v1 offset:36864
    v_mul_f32 v101, v37, v37
    v_mul_f32 v102, v38, v38
    v_mul_f32 v103, v39, v39
    v_fma_f32 v96, v96, v14, v13
    v_fma_f32 v97, v97, v14, v13
    s_waitcnt lgkmcnt(5)
    v_mfma_f32_32x32x16_bf16 v[48:63], v[92:95], a[12:15], v[48:63]
    ds_read_b128 v[88:91], v1 offset:37888
    v_fma_f32 v98, v98, v14, v13
    v_fma_f32 v99, v99, v14, v13
    v_fma_f32 v100, v100, v14, v13
    v_fma_f32 v101, v101, v14, v13
    v_fma_f32 v102, v102, v14, v13
    s_waitcnt lgkmcnt(5)
    v_mfma_f32_32x32x16_bf16 v[48:63], a[116:119], a[16:19], v[48:63]
    ds_read_b128 v[92:95], v1 offset:38912
    v_fma_f32 v103, v103, v14, v13
    v_mul_f32 v96, v96, v32
    v_mul_f32 v97, v97, v33
    v_mul_f32 v98, v98, v34
    v_mul_f32 v99, v99, v35
    s_waitcnt lgkmcnt(5)
    v_mfma_f32_32x32x16_bf16 v[48:63], a[120:123], a[20:23], v[48:63]
    ds_read_b128 a[116:119], v1 offset:39936
    v_mul_f32 v100, v100, v36
    v_mul_f32 v101, v101, v37
    v_mul_f32 v102, v102, v38
    v_mul_f32 v103, v103, v39
    v_exp_f32 v96, v96
    s_waitcnt lgkmcnt(4)
    v_mfma_f32_32x32x16_bf16 v[48:63], v[80:83], a[24:27], v[48:63]
    ds_read_b128 a[120:123], v1 offset:40960
    v_mul_f32 v32, v32, v40
    v_exp_f32 v97, v97
    v_mul_f32 v33, v33, v41
    v_exp_f32 v98, v98
    s_waitcnt lgkmcnt(4)
    v_mfma_f32_32x32x16_bf16 v[48:63], v[84:87], a[28:31], v[48:63]
    ds_read_b128 v[80:83], v1 offset:41984
    v_mul_f32 v34, v34, v42
    v_exp_f32 v99, v99
    v_mul_f32 v35, v35, v43
    v_exp_f32 v100, v100
    s_waitcnt lgkmcnt(4)
    v_mfma_f32_32x32x16_bf16 v[48:63], v[88:91], a[32:35], v[48:63]
    ds_read_b128 v[84:87], v1 offset:43008
    v_mul_f32 v36, v36, v44
    v_exp_f32 v101, v101
    v_mul_f32 v37, v37, v45
    v_exp_f32 v102, v102
    s_waitcnt lgkmcnt(4)
    v_mfma_f32_32x32x16_bf16 v[48:63], v[92:95], a[36:39], v[48:63]
    ds_read_b128 v[88:91], v1 offset:44032
    v_mul_f32 v38, v38, v46
    v_exp_f32 v103, v103
    v_mul_f32 v39, v39, v47
    v_fma_f32 v96, v96, v12, v12
    s_waitcnt lgkmcnt(4)
    v_mfma_f32_32x32x16_bf16 v[48:63], a[116:119], a[40:43], v[48:63]
    ds_read_b128 v[92:95], v1 offset:45056
    v_fma_f32 v97, v97, v12, v12
    v_fma_f32 v98, v98, v12, v12
    v_fma_f32 v99, v99, v12, v12
    v_fma_f32 v100, v100, v12, v12
    v_fma_f32 v101, v101, v12, v12
    s_waitcnt lgkmcnt(4)
    v_mfma_f32_32x32x16_bf16 v[48:63], a[120:123], a[44:47], v[48:63]
    ds_read_b128 a[116:119], v1 offset:46080
    v_fma_f32 v102, v102, v12, v12
    v_fma_f32 v103, v103, v12, v12
    v_rcp_f32 v96, v96
    v_rcp_f32 v97, v97
    s_waitcnt lgkmcnt(4)
    v_mfma_f32_32x32x16_bf16 v[48:63], v[80:83], a[48:51], v[48:63]
    ds_read_b128 a[120:123], v1 offset:47104
    v_rcp_f32 v98, v98
    v_rcp_f32 v99, v99
    v_rcp_f32 v100, v100
    s_waitcnt lgkmcnt(4)
    v_mfma_f32_32x32x16_bf16 v[48:63], v[84:87], a[52:55], v[48:63]
    ds_read_b128 v[80:83], v1 offset:48128
    v_rcp_f32 v101, v101
    v_rcp_f32 v102, v102
    v_rcp_f32 v103, v103
    s_waitcnt lgkmcnt(4)
    v_mfma_f32_32x32x16_bf16 v[48:63], v[88:91], a[56:59], v[48:63]
    ds_read_b128 v[84:87], v1 offset:49152
    v_mul_f32 v96, v32, v96
    v_mul_f32 v97, v33, v97
    v_mul_f32 v98, v34, v98
    v_mul_f32 v99, v35, v99
    v_mul_f32 v100, v36, v100
    s_waitcnt lgkmcnt(4)
    v_mfma_f32_32x32x16_bf16 v[48:63], v[92:95], a[60:63], v[48:63]
    ds_read_b128 v[88:91], v1 offset:50176
    v_mul_f32 v101, v37, v101
    v_mul_f32 v102, v38, v102
    v_mul_f32 v103, v39, v103
    v_cvt_pk_bf16_f32 v8, v96, v97
    v_cvt_pk_bf16_f32 v9, v98, v99
    s_waitcnt lgkmcnt(4)
    v_mfma_f32_32x32x16_bf16 v[48:63], a[116:119], a[64:67], v[48:63]
    ds_read_b128 v[92:95], v1 offset:51200
    v_cvt_pk_bf16_f32 v10, v100, v101
    v_cvt_pk_bf16_f32 v11, v102, v103
    buffer_store_dwordx4 v[8:11], v1, s[4:7], s22 offen offset:1024 sc1
    s_waitcnt lgkmcnt(4)
    v_mfma_f32_32x32x16_bf16 v[48:63], a[120:123], a[68:71], v[48:63]
    ds_read_b128 a[116:119], v1 offset:52224
    s_waitcnt lgkmcnt(4)
    v_mfma_f32_32x32x16_bf16 v[48:63], v[80:83], a[72:75], v[48:63]
    ds_read_b128 a[120:123], v1 offset:53248
    s_waitcnt lgkmcnt(4)
    v_mfma_f32_32x32x16_bf16 v[48:63], v[84:87], a[76:79], v[48:63]
    ds_read_b128 v[80:83], v1 offset:54272
    s_waitcnt lgkmcnt(4)
    v_mfma_f32_32x32x16_bf16 v[48:63], v[88:91], a[80:83], v[48:63]
    ds_read_b128 v[84:87], v1 offset:55296
    s_waitcnt lgkmcnt(4)
    v_mfma_f32_32x32x16_bf16 v[48:63], v[92:95], a[84:87], v[48:63]
    ds_read_b128 v[88:91], v1 offset:56320
    s_waitcnt lgkmcnt(4)
    v_mfma_f32_32x32x16_bf16 v[48:63], a[116:119], a[88:91], v[48:63]
    ds_read_b128 v[92:95], v1 offset:57344
    s_waitcnt lgkmcnt(4)
    v_mfma_f32_32x32x16_bf16 v[48:63], a[120:123], a[92:95], v[48:63]
    ds_read_b128 a[116:119], v1 offset:58368
    s_waitcnt lgkmcnt(4)
    v_mfma_f32_32x32x16_bf16 v[48:63], v[80:83], a[96:99], v[48:63]
    s_waitcnt lgkmcnt(3)
    v_mfma_f32_32x32x16_bf16 v[48:63], v[84:87], a[100:103], v[48:63]
    s_waitcnt lgkmcnt(2)
    v_mfma_f32_32x32x16_bf16 v[48:63], v[88:91], a[104:107], v[48:63]
    s_waitcnt lgkmcnt(1)
    v_mfma_f32_32x32x16_bf16 v[48:63], v[92:95], a[108:111], v[48:63]
    s_waitcnt lgkmcnt(0)
    v_mfma_f32_32x32x16_bf16 v[48:63], a[116:119], a[112:115], v[48:63]
    v_mov_b32 v125, 12
    ds_write_b32 v126, v125
    s_nop 9
    v_mul_f32 v96, v48, v48
    v_mul_f32 v97, v49, v49
    v_mul_f32 v98, v50, v50
    v_mul_f32 v99, v51, v51
    v_mul_f32 v100, v52, v52
    v_mul_f32 v101, v53, v53
    v_mul_f32 v102, v54, v54
    v_mul_f32 v103, v55, v55
    v_fma_f32 v96, v96, v14, v13
    v_fma_f32 v97, v97, v14, v13
    v_fma_f32 v98, v98, v14, v13
    v_fma_f32 v99, v99, v14, v13
    v_fma_f32 v100, v100, v14, v13
    v_fma_f32 v101, v101, v14, v13
    v_fma_f32 v102, v102, v14, v13
    v_fma_f32 v103, v103, v14, v13
    v_mul_f32 v96, v96, v48
    v_mul_f32 v97, v97, v49
    v_mul_f32 v98, v98, v50
    v_mul_f32 v99, v99, v51
    v_mul_f32 v100, v100, v52
    v_mul_f32 v101, v101, v53
    v_mul_f32 v102, v102, v54
    v_mul_f32 v103, v103, v55
    v_exp_f32 v96, v96
    v_mul_f32 v48, v48, v56
    v_exp_f32 v97, v97
    v_mul_f32 v49, v49, v57
    v_exp_f32 v98, v98
    v_mul_f32 v50, v50, v58
    v_exp_f32 v99, v99
    v_mul_f32 v51, v51, v59
    v_exp_f32 v100, v100
    v_mul_f32 v52, v52, v60
    v_exp_f32 v101, v101
    v_mul_f32 v53, v53, v61
    v_exp_f32 v102, v102
    v_mul_f32 v54, v54, v62
    v_exp_f32 v103, v103
    v_mul_f32 v55, v55, v63
    v_fma_f32 v96, v96, v12, v12
    v_fma_f32 v97, v97, v12, v12
    v_fma_f32 v98, v98, v12, v12
    v_fma_f32 v99, v99, v12, v12
    v_fma_f32 v100, v100, v12, v12
    v_fma_f32 v101, v101, v12, v12
    v_fma_f32 v102, v102, v12, v12
    v_fma_f32 v103, v103, v12, v12
    v_rcp_f32 v96, v96
    v_rcp_f32 v97, v97
    v_rcp_f32 v98, v98
    v_rcp_f32 v99, v99
    v_rcp_f32 v100, v100
    v_rcp_f32 v101, v101
    v_rcp_f32 v102, v102
    v_rcp_f32 v103, v103
    v_mul_f32 v96, v48, v96
    v_mul_f32 v97, v49, v97
    v_mul_f32 v98, v50, v98
    v_mul_f32 v99, v51, v99
    v_mul_f32 v100, v52, v100
    v_mul_f32 v101, v53, v101
    v_mul_f32 v102, v54, v102
    v_mul_f32 v103, v55, v103
    v_cvt_pk_bf16_f32 v104, v96, v97
    v_cvt_pk_bf16_f32 v105, v98, v99
    v_cvt_pk_bf16_f32 v106, v100, v101
    v_cvt_pk_bf16_f32 v107, v102, v103
    buffer_store_dwordx4 v[104:107], v1, s[4:7], s22 offen offset:2048 sc1
    v_mov_b32 v4, 4
    v_mov_b32 v5, 0
    s_waitcnt vmcnt(0)
    s_mov_b64 exec, 1
    s_cmp_lg_u32 s45, 0
    s_cbranch_scc1 Ltw109p
    buffer_store_dword v4, v5, s[4:7], s28 offen sc1
    s_branch Ltw109d
Ltw109p:
    buffer_store_dword v4, v5, s[4:7], s28 offen
Ltw109d:
    s_mov_b64 exec, -1
    v_and_b32 v96, 15, v0
    v_lshlrev_b32 v96, 4, v96
    v_lshrrev_b32 v4, 4, v0
    v_lshl_add_u32 v96, v4, 9, v96
    s_mul_i32 s23, s18, 7168
    v_add_u32 v97, s23, v1
    v_add_u32 v98, s23, v2
    v_add_u32 v99, s23, v3
    s_mul_i32 s21, s27, 112
    s_mul_i32 s22, s18, 28
    s_add_u32 s21, s21, s22
    s_lshl_b32 s21, s21, 10
    s_add_u32 s21, s21, 21315584
    v_accvgpr_read_b32 v7, a125
    s_mov_b32 s25, 200000
Lpoll110:
    s_nop 3
    buffer_load_dword v4, v7, s[4:7], 0 offen sc1
    s_waitcnt vmcnt(0)
    v_cmp_gt_u32 vcc, 4, v4
    s_nop 1
    s_cbranch_vccz Lpoll110d
    s_sub_u32 s25, s25, 1
    s_cmp_lg_u32 s25, 0
    s_cbranch_scc1 Lpoll110
Lpoll110d:
    s_nop 0
    s_setprio 0
    buffer_load_dwordx4 a[0:3], v96, s[4:7], s21 offen offset:0
    buffer_load_dwordx4 a[4:7], v96, s[4:7], s21 offen offset:256
    buffer_load_dwordx4 a[8:11], v96, s[4:7], s21 offen offset:2048
    buffer_load_dwordx4 a[12:15], v96, s[4:7], s21 offen offset:2304
    s_add_u32 s21, s21, 4096
    v_mov_b32 v125, 13
    ds_write_b32 v126, v125
    buffer_load_dwordx4 a[16:19], v96, s[4:7], s21 offen offset:0
    buffer_load_dwordx4 a[20:23], v96, s[4:7], s21 offen offset:256
    buffer_load_dwordx4 a[24:27], v96, s[4:7], s21 offen offset:2048
    buffer_load_dwordx4 a[28:31], v96, s[4:7], s21 offen offset:2304
    s_add_u32 s21, s21, 4096
    buffer_load_dwordx4 a[32:35], v96, s[4:7], s21 offen offset:0
    buffer_load_dwordx4 a[36:39], v96, s[4:7], s21 offen offset:256
    buffer_load_dwordx4 a[40:43], v96, s[4:7], s21 offen offset:2048
    buffer_load_dwordx4 a[44:47], v96, s[4:7], s21 offen offset:2304
    s_add_u32 s21, s21, 4096
    buffer_load_dwordx4 a[48:51], v96, s[4:7], s21 offen offset:0
    buffer_load_dwordx4 a[52:55], v96, s[4:7], s21 offen offset:256
    buffer_load_dwordx4 a[56:59], v96, s[4:7], s21 offen offset:2048
    buffer_load_dwordx4 a[60:63], v96, s[4:7], s21 offen offset:2304
    s_add_u32 s21, s21, 4096
    buffer_load_dwordx4 a[64:67], v96, s[4:7], s21 offen offset:0
    buffer_load_dwordx4 a[68:71], v96, s[4:7], s21 offen offset:256
    v_mov_b32 v116, s44
    ds_read_b32 v116, v116
    s_waitcnt lgkmcnt(0)
    v_cmp_gt_u32 vcc, 11, v116
    s_nop 1
    s_cbranch_vccz Lc111d
    s_nop 1
    s_mov_b32 s25, 2000000
Lc111:
    s_nop 0
    s_sleep 1
    v_mov_b32 v116, s44
    ds_read_b32 v116, v116
    s_waitcnt lgkmcnt(0)
    v_cmp_gt_u32 vcc, 11, v116
    s_nop 1
    s_cbranch_vccz Lc111d
    s_sub_u32 s25, s25, 1
    s_cmp_lg_u32 s25, 0
    s_cbranch_scc1 Lc111
    s_nop 0
Lc111d:
    ds_read_b128 v[72:75], v97 offset:59392
    ds_read_b128 v[76:79], v97 offset:60416
    ds_read_b128 v[80:83], v97 offset:61440
    ds_read_b128 v[84:87], v97 offset:62464
    ds_read_b128 v[88:91], v97 offset:63488
    s_waitcnt vmcnt(16)
    s_waitcnt lgkmcnt(4)
    v_mfma_f32_16x16x32_bf16 v[16:19], v[72:75], a[0:3], 0
    v_mfma_f32_16x16x32_bf16 v[44:47], v[72:75], a[4:7], 0
    ds_read_b128 v[92:95], v97 offset:64512
    s_waitcnt lgkmcnt(4)
    v_mfma_f32_16x16x32_bf16 v[20:23], v[76:79], a[0:3], 0
    v_mfma_f32_16x16x32_bf16 v[48:51], v[76:79], a[4:7], 0
    ds_read_b128 v[72:75], v98 offset:0
    s_waitcnt lgkmcnt(4)
    v_mfma_f32_16x16x32_bf16 v[24:27], v[80:83], a[0:3], 0
    v_mfma_f32_16x16x32_bf16 v[52:55], v[80:83], a[4:7], 0
    ds_read_b128 v[76:79], v98 offset:23552
    s_waitcnt lgkmcnt(4)
    v_mfma_f32_16x16x32_bf16 v[28:31], v[84:87], a[0:3], 0
    v_mfma_f32_16x16x32_bf16 v[56:59], v[84:87], a[4:7], 0
    ds_read_b128 v[80:83], v98 offset:24576
    s_waitcnt lgkmcnt(4)
    v_mfma_f32_16x16x32_bf16 v[32:35], v[88:91], a[0:3], 0
    v_mfma_f32_16x16x32_bf16 v[60:63], v[88:91], a[4:7], 0
    ds_read_b128 v[84:87], v98 offset:25600
    s_waitcnt lgkmcnt(4)
    v_mfma_f32_16x16x32_bf16 v[36:39], v[92:95], a[0:3], 0
    v_mfma_f32_16x16x32_bf16 v[64:67], v[92:95], a[4:7], 0
    ds_read_b128 v[88:91], v98 offset:26624
    s_waitcnt lgkmcnt(4)
    v_mfma_f32_16x16x32_bf16 v[40:43], v[72:75], a[0:3], 0
    v_mfma_f32_16x16x32_bf16 v[68:71], v[72:75], a[4:7], 0
    ds_read_b128 v[92:95], v98 offset:27648
    s_mul_i32 s21, s20, 401408
    s_add_u32 s21, s21, s23
    s_add_u32 s21, s21, 5353472
    s_add_u32 s22, s23, 59392
    s_mov_b32 m0, s22
    s_nop 0
    buffer_load_dwordx4 v1, s[4:7], s21 offen offset:0 lds
    buffer_load_dwordx4 v1, s[4:7], s21 offen offset:1024 lds
    buffer_load_dwordx4 v1, s[4:7], s21 offen offset:2048 lds
    buffer_load_dwordx4 v1, s[4:7], s21 offen offset:3072 lds
    s_add_u32 s21, s21, 4096
    s_add_u32 s22, s22, 4096
    s_mov_b32 m0, s22
    s_nop 0
    buffer_load_dwordx4 v1, s[4:7], s21 offen offset:0 lds
    buffer_load_dwordx4 v1, s[4:7], s21 offen offset:1024 lds
    buffer_load_dwordx4 v1, s[4:7], s21 offen offset:2048 lds
    s_waitcnt vmcnt(21)
    s_waitcnt lgkmcnt(4)
    v_mfma_f32_16x16x32_bf16 v[16:19], v[76:79], a[8:11], v[16:19]
    v_mfma_f32_16x16x32_bf16 v[44:47], v[76:79], a[12:15], v[44:47]
    ds_read_b128 v[72:75], v98 offset:28672
    v_mov_b32 v125, 14
    ds_write_b32 v126, v125
    s_waitcnt lgkmcnt(5)
    v_mfma_f32_16x16x32_bf16 v[20:23], v[80:83], a[8:11], v[20:23]
    v_mfma_f32_16x16x32_bf16 v[48:51], v[80:83], a[12:15], v[48:51]
    ds_read_b128 v[76:79], v98 offset:29696
    s_waitcnt lgkmcnt(5)
    v_mfma_f32_16x16x32_bf16 v[24:27], v[84:87], a[8:11], v[24:27]
    v_mfma_f32_16x16x32_bf16 v[52:55], v[84:87], a[12:15], v[52:55]
    ds_read_b128 v[80:83], v98 offset:53248
    s_waitcnt lgkmcnt(5)
    v_mfma_f32_16x16x32_bf16 v[28:31], v[88:91], a[8:11], v[28:31]
    v_mfma_f32_16x16x32_bf16 v[56:59], v[88:91], a[12:15], v[56:59]
    ds_read_b128 v[84:87], v98 offset:54272
    s_waitcnt lgkmcnt(5)
    v_mfma_f32_16x16x32_bf16 v[32:35], v[92:95], a[8:11], v[32:35]
    v_mfma_f32_16x16x32_bf16 v[60:63], v[92:95], a[12:15], v[60:63]
    ds_read_b128 v[88:91], v98 offset:55296
    s_waitcnt lgkmcnt(5)
    v_mfma_f32_16x16x32_bf16 v[36:39], v[72:75], a[8:11], v[36:39]
    v_mfma_f32_16x16x32_bf16 v[64:67], v[72:75], a[12:15], v[64:67]
    ds_read_b128 v[92:95], v98 offset:56320
    s_waitcnt lgkmcnt(4)
    v_mfma_f32_16x16x32_bf16 v[40:43], v[76:79], a[8:11], v[40:43]
    v_mfma_f32_16x16x32_bf16 v[68:71], v[76:79], a[12:15], v[68:71]
    ds_read_b128 v[72:75], v98 offset:57344
    s_mul_i32 s21, s20, 401408
    s_add_u32 s21, s21, s23
    s_add_u32 s21, s21, 5382144
    s_add_u32 s22, s23, 89088
    s_mov_b32 m0, s22
    s_nop 0
    buffer_load_dwordx4 v1, s[4:7], s21 offen offset:0 lds
    buffer_load_dwordx4 v1, s[4:7], s21 offen offset:1024 lds
    buffer_load_dwordx4 v1, s[4:7], s21 offen offset:2048 lds
    buffer_load_dwordx4 v1, s[4:7], s21 offen offset:3072 lds
    s_add_u32 s21, s21, 4096
    s_add_u32 s22, s22, 4096
    s_mov_b32 m0, s22
    s_nop 0
    buffer_load_dwordx4 v1, s[4:7], s21 offen offset:0 lds
    buffer_load_dwordx4 v1, s[4:7], s21 offen offset:1024 lds
    buffer_load_dwordx4 v1, s[4:7], s21 offen offset:2048 lds
    s_waitcnt vmcnt(26)
    s_waitcnt lgkmcnt(4)
    v_mfma_f32_16x16x32_bf16 v[16:19], v[80:83], a[16:19], v[16:19]
    v_mfma_f32_16x16x32_bf16 v[44:47], v[80:83], a[20:23], v[44:47]
    ds_read_b128 v[76:79], v98 offset:58368
    v_mov_b32 v125, 15
    ds_write_b32 v126, v125
    s_waitcnt lgkmcnt(5)
    v_mfma_f32_16x16x32_bf16 v[20:23], v[84:87], a[16:19], v[20:23]
    v_mfma_f32_16x16x32_bf16 v[48:51], v[84:87], a[20:23], v[48:51]
    ds_read_b128 v[80:83], v98 offset:59392
    s_waitcnt lgkmcnt(5)
    v_mfma_f32_16x16x32_bf16 v[24:27], v[88:91], a[16:19], v[24:27]
    v_mfma_f32_16x16x32_bf16 v[52:55], v[88:91], a[20:23], v[52:55]
    ds_read_b128 v[84:87], v97 offset:0
    s_waitcnt lgkmcnt(5)
    v_mfma_f32_16x16x32_bf16 v[28:31], v[92:95], a[16:19], v[28:31]
    v_mfma_f32_16x16x32_bf16 v[56:59], v[92:95], a[20:23], v[56:59]
    ds_read_b128 v[88:91], v97 offset:1024
    s_waitcnt lgkmcnt(5)
    v_mfma_f32_16x16x32_bf16 v[32:35], v[72:75], a[16:19], v[32:35]
    v_mfma_f32_16x16x32_bf16 v[60:63], v[72:75], a[20:23], v[60:63]
    ds_read_b128 v[92:95], v97 offset:2048
    s_waitcnt lgkmcnt(5)
    v_mfma_f32_16x16x32_bf16 v[36:39], v[76:79], a[16:19], v[36:39]
    v_mfma_f32_16x16x32_bf16 v[64:67], v[76:79], a[20:23], v[64:67]
    ds_read_b128 v[72:75], v97 offset:3072
    s_waitcnt lgkmcnt(4)
    v_mfma_f32_16x16x32_bf16 v[40:43], v[80:83], a[16:19], v[40:43]
    v_mfma_f32_16x16x32_bf16 v[68:71], v[80:83], a[20:23], v[68:71]
    ds_read_b128 v[76:79], v97 offset:4096
    s_mul_i32 s21, s20, 401408
    s_add_u32 s21, s21, s23
    s_add_u32 s21, s21, 5410816
    s_add_u32 s22, s23, 118784
    s_mov_b32 m0, s22
    s_nop 0
    buffer_load_dwordx4 v1, s[4:7], s21 offen offset:0 lds
    buffer_load_dwordx4 v1, s[4:7], s21 offen offset:1024 lds
    buffer_load_dwordx4 v1, s[4:7], s21 offen offset:2048 lds
    buffer_load_dwordx4 v1, s[4:7], s21 offen offset:3072 lds
    s_add_u32 s21, s21, 4096
    s_add_u32 s22, s22, 4096
    s_mov_b32 m0, s22
    s_nop 0
    buffer_load_dwordx4 v1, s[4:7], s21 offen offset:0 lds
    buffer_load_dwordx4 v1, s[4:7], s21 offen offset:1024 lds
    buffer_load_dwordx4 v1, s[4:7], s21 offen offset:2048 lds
    s_waitcnt vmcnt(31)
    s_waitcnt lgkmcnt(4)
    v_mfma_f32_16x16x32_bf16 v[16:19], v[84:87], a[24:27], v[16:19]
    v_mfma_f32_16x16x32_bf16 v[44:47], v[84:87], a[28:31], v[44:47]
    ds_read_b128 v[80:83], v97 offset:5120
    v_mov_b32 v125, 16
    ds_write_b32 v126, v125
    s_waitcnt lgkmcnt(5)
    v_mfma_f32_16x16x32_bf16 v[20:23], v[88:91], a[24:27], v[20:23]
    v_mfma_f32_16x16x32_bf16 v[48:51], v[88:91], a[28:31], v[48:51]
    ds_read_b128 v[84:87], v97 offset:6144
    s_waitcnt lgkmcnt(5)
    v_mfma_f32_16x16x32_bf16 v[24:27], v[92:95], a[24:27], v[24:27]
    v_mfma_f32_16x16x32_bf16 v[52:55], v[92:95], a[28:31], v[52:55]
    ds_read_b128 v[88:91], v97 offset:29696
    s_waitcnt lgkmcnt(5)
    v_mfma_f32_16x16x32_bf16 v[28:31], v[72:75], a[24:27], v[28:31]
    v_mfma_f32_16x16x32_bf16 v[56:59], v[72:75], a[28:31], v[56:59]
    ds_read_b128 v[92:95], v97 offset:30720
    s_waitcnt lgkmcnt(5)
    v_mfma_f32_16x16x32_bf16 v[32:35], v[76:79], a[24:27], v[32:35]
    v_mfma_f32_16x16x32_bf16 v[60:63], v[76:79], a[28:31], v[60:63]
    ds_read_b128 v[72:75], v97 offset:31744
    s_waitcnt lgkmcnt(5)
    v_mfma_f32_16x16x32_bf16 v[36:39], v[80:83], a[24:27], v[36:39]
    v_mfma_f32_16x16x32_bf16 v[64:67], v[80:83], a[28:31], v[64:67]
    ds_read_b128 v[76:79], v97 offset:32768
    s_waitcnt lgkmcnt(4)
    v_mfma_f32_16x16x32_bf16 v[40:43], v[84:87], a[24:27], v[40:43]
    v_mfma_f32_16x16x32_bf16 v[68:71], v[84:87], a[28:31], v[68:71]
    ds_read_b128 v[80:83], v97 offset:33792
    s_mul_i32 s21, s20, 401408
    s_add_u32 s21, s21, s23
    s_add_u32 s21, s21, 5439488
    s_add_u32 s22, s23, 0
    s_mov_b32 m0, s22
    s_nop 0
    buffer_load_dwordx4 v1, s[4:7], s21 offen offset:0 lds
    buffer_load_dwordx4 v1, s[4:7], s21 offen offset:1024 lds
    buffer_load_dwordx4 v1, s[4:7], s21 offen offset:2048 lds
    buffer_load_dwordx4 v1, s[4:7], s21 offen offset:3072 lds
    s_add_u32 s21, s21, 4096
    s_add_u32 s22, s22, 4096
    s_mov_b32 m0, s22
    s_nop 0
    buffer_load_dwordx4 v1, s[4:7], s21 offen offset:0 lds
    buffer_load_dwordx4 v1, s[4:7], s21 offen offset:1024 lds
    buffer_load_dwordx4 v1, s[4:7], s21 offen offset:2048 lds
    s_waitcnt vmcnt(36)
    s_waitcnt lgkmcnt(4)
    v_mfma_f32_16x16x32_bf16 v[16:19], v[88:91], a[32:35], v[16:19]
    v_mfma_f32_16x16x32_bf16 v[44:47], v[88:91], a[36:39], v[44:47]
    ds_read_b128 v[84:87], v97 offset:34816
    v_mov_b32 v125, 17
    ds_write_b32 v126, v125
    s_waitcnt lgkmcnt(5)
    v_mfma_f32_16x16x32_bf16 v[20:23], v[92:95], a[32:35], v[20:23]
    v_mfma_f32_16x16x32_bf16 v[48:51], v[92:95], a[36:39], v[48:51]
    ds_read_b128 v[88:91], v97 offset:35840
    s_waitcnt lgkmcnt(5)
    v_mfma_f32_16x16x32_bf16 v[24:27], v[72:75], a[32:35], v[24:27]
    v_mfma_f32_16x16x32_bf16 v[52:55], v[72:75], a[36:39], v[52:55]
    s_waitcnt vmcnt(21)
    ds_read_b128 v[92:95], v97 offset:59392
    s_waitcnt lgkmcnt(5)
    v_mfma_f32_16x16x32_bf16 v[28:31], v[76:79], a[32:35], v[28:31]
    v_mfma_f32_16x16x32_bf16 v[56:59], v[76:79], a[36:39], v[56:59]
    ds_read_b128 v[72:75], v97 offset:60416
    s_waitcnt lgkmcnt(5)
    v_mfma_f32_16x16x32_bf16 v[32:35], v[80:83], a[32:35], v[32:35]
    v_mfma_f32_16x16x32_bf16 v[60:63], v[80:83], a[36:39], v[60:63]
    ds_read_b128 v[76:79], v97 offset:61440
    s_waitcnt lgkmcnt(5)
    v_mfma_f32_16x16x32_bf16 v[36:39], v[84:87], a[32:35], v[36:39]
    v_mfma_f32_16x16x32_bf16 v[64:67], v[84:87], a[36:39], v[64:67]
    ds_read_b128 v[80:83], v97 offset:62464
    s_waitcnt lgkmcnt(4)
    v_mfma_f32_16x16x32_bf16 v[40:43], v[88:91], a[32:35], v[40:43]
    v_mfma_f32_16x16x32_bf16 v[68:71], v[88:91], a[36:39], v[68:71]
    ds_read_b128 v[84:87], v97 offset:63488
    s_waitcnt lgkmcnt(4)
    v_mfma_f32_16x16x32_bf16 v[16:19], v[92:95], a[40:43], v[16:19]
    v_mfma_f32_16x16x32_bf16 v[44:47], v[92:95], a[44:47], v[44:47]
    ds_read_b128 v[88:91], v97 offset:64512
    v_mov_b32 v125, 18
    ds_write_b32 v126, v125
    s_waitcnt lgkmcnt(5)
    v_mfma_f32_16x16x32_bf16 v[20:23], v[72:75], a[40:43], v[20:23]
    v_mfma_f32_16x16x32_bf16 v[48:51], v[72:75], a[44:47], v[48:51]
    ds_read_b128 v[92:95], v98 offset:0
    s_waitcnt lgkmcnt(5)
    v_mfma_f32_16x16x32_bf16 v[24:27], v[76:79], a[40:43], v[24:27]
    v_mfma_f32_16x16x32_bf16 v[52:55], v[76:79], a[44:47], v[52:55]
    s_waitcnt vmcnt(14)
    ds_read_b128 v[72:75], v98 offset:23552
    s_waitcnt lgkmcnt(5)
    v_mfma_f32_16x16x32_bf16 v[28:31], v[80:83], a[40:43], v[28:31]
    v_mfma_f32_16x16x32_bf16 v[56:59], v[80:83], a[44:47], v[56:59]
    ds_read_b128 v[76:79], v98 offset:24576
    s_waitcnt lgkmcnt(5)
    v_mfma_f32_16x16x32_bf16 v[32:35], v[84:87], a[40:43], v[32:35]
    v_mfma_f32_16x16x32_bf16 v[60:63], v[84:87], a[44:47], v[60:63]
    ds_read_b128 v[80:83], v98 offset:25600
    s_waitcnt lgkmcnt(5)
    v_mfma_f32_16x16x32_bf16 v[36:39], v[88:91], a[40:43], v[36:39]
    v_mfma_f32_16x16x32_bf16 v[64:67], v[88:91], a[44:47], v[64:67]
    ds_read_b128 v[84:87], v98 offset:26624
    s_waitcnt lgkmcnt(4)
    v_mfma_f32_16x16x32_bf16 v[40:43], v[92:95], a[40:43], v[40:43]
    v_mfma_f32_16x16x32_bf16 v[68:71], v[92:95], a[44:47], v[68:71]
    ds_read_b128 v[88:91], v98 offset:27648
    s_waitcnt lgkmcnt(4)
    v_mfma_f32_16x16x32_bf16 v[16:19], v[72:75], a[48:51], v[16:19]
    v_mfma_f32_16x16x32_bf16 v[44:47], v[72:75], a[52:55], v[44:47]
    ds_read_b128 v[92:95], v98 offset:28672
    v_mov_b32 v125, 19
    ds_write_b32 v126, v125
    s_waitcnt lgkmcnt(5)
    v_mfma_f32_16x16x32_bf16 v[20:23], v[76:79], a[48:51], v[20:23]
    v_mfma_f32_16x16x32_bf16 v[48:51], v[76:79], a[52:55], v[48:51]
    ds_read_b128 v[72:75], v98 offset:29696
    s_waitcnt lgkmcnt(5)
    v_mfma_f32_16x16x32_bf16 v[24:27], v[80:83], a[48:51], v[24:27]
    v_mfma_f32_16x16x32_bf16 v[52:55], v[80:83], a[52:55], v[52:55]
    s_waitcnt vmcnt(7)
    ds_read_b128 v[76:79], v98 offset:53248
    s_waitcnt lgkmcnt(5)
    v_mfma_f32_16x16x32_bf16 v[28:31], v[84:87], a[48:51], v[28:31]
    v_mfma_f32_16x16x32_bf16 v[56:59], v[84:87], a[52:55], v[56:59]
    ds_read_b128 v[80:83], v98 offset:54272
    s_waitcnt lgkmcnt(5)
    v_mfma_f32_16x16x32_bf16 v[32:35], v[88:91], a[48:51], v[32:35]
    v_mfma_f32_16x16x32_bf16 v[60:63], v[88:91], a[52:55], v[60:63]
    ds_read_b128 v[84:87], v98 offset:55296
    s_waitcnt lgkmcnt(5)
    v_mfma_f32_16x16x32_bf16 v[36:39], v[92:95], a[48:51], v[36:39]
    v_mfma_f32_16x16x32_bf16 v[64:67], v[92:95], a[52:55], v[64:67]
    ds_read_b128 v[88:91], v98 offset:56320
    s_waitcnt lgkmcnt(4)
    v_mfma_f32_16x16x32_bf16 v[40:43], v[72:75], a[48:51], v[40:43]
    v_mfma_f32_16x16x32_bf16 v[68:71], v[72:75], a[52:55], v[68:71]
    ds_read_b128 v[92:95], v98 offset:57344
    s_waitcnt lgkmcnt(4)
    v_mfma_f32_16x16x32_bf16 v[16:19], v[76:79], a[56:59], v[16:19]
    v_mfma_f32_16x16x32_bf16 v[44:47], v[76:79], a[60:63], v[44:47]
    ds_read_b128 v[72:75], v98 offset:58368
    v_mov_b32 v125, 20
    ds_write_b32 v126, v125
    s_waitcnt lgkmcnt(5)
    v_mfma_f32_16x16x32_bf16 v[20:23], v[80:83], a[56:59], v[20:23]
    v_mfma_f32_16x16x32_bf16 v[48:51], v[80:83], a[60:63], v[48:51]
    ds_read_b128 v[76:79], v98 offset:59392
    s_waitcnt lgkmcnt(5)
    v_mfma_f32_16x16x32_bf16 v[24:27], v[84:87], a[56:59], v[24:27]
    v_mfma_f32_16x16x32_bf16 v[52:55], v[84:87], a[60:63], v[52:55]
    s_waitcnt vmcnt(0)
    ds_read_b128 v[80:83], v97 offset:0
    s_waitcnt lgkmcnt(5)
    v_mfma_f32_16x16x32_bf16 v[28:31], v[88:91], a[56:59], v[28:31]
    v_mfma_f32_16x16x32_bf16 v[56:59], v[88:91], a[60:63], v[56:59]
    ds_read_b128 v[84:87], v97 offset:1024
    s_waitcnt lgkmcnt(5)
    v_mfma_f32_16x16x32_bf16 v[32:35], v[92:95], a[56:59], v[32:35]
    v_mfma_f32_16x16x32_bf16 v[60:63], v[92:95], a[60:63], v[60:63]
    ds_read_b128 v[88:91], v97 offset:2048
    s_waitcnt lgkmcnt(5)
    v_mfma_f32_16x16x32_bf16 v[36:39], v[72:75], a[56:59], v[36:39]
    v_mfma_f32_16x16x32_bf16 v[64:67], v[72:75], a[60:63], v[64:67]
    ds_read_b128 v[92:95], v97 offset:3072
    s_waitcnt lgkmcnt(4)
    v_mfma_f32_16x16x32_bf16 v[40:43], v[76:79], a[56:59], v[40:43]
    v_mfma_f32_16x16x32_bf16 v[68:71], v[76:79], a[60:63], v[68:71]
    ds_read_b128 v[72:75], v97 offset:4096
    s_waitcnt lgkmcnt(4)
    v_mfma_f32_16x16x32_bf16 v[16:19], v[80:83], a[64:67], v[16:19]
    v_mfma_f32_16x16x32_bf16 v[44:47], v[80:83], a[68:71], v[44:47]
    ds_read_b128 v[76:79], v97 offset:5120
    v_mov_b32 v125, 21
    ds_write_b32 v126, v125
    s_waitcnt lgkmcnt(5)
    v_mfma_f32_16x16x32_bf16 v[20:23], v[84:87], a[64:67], v[20:23]
    v_mfma_f32_16x16x32_bf16 v[48:51], v[84:87], a[68:71], v[48:51]
    ds_read_b128 v[80:83], v97 offset:6144
    s_waitcnt lgkmcnt(5)
    v_mfma_f32_16x16x32_bf16 v[24:27], v[88:91], a[64:67], v[24:27]
    v_mfma_f32_16x16x32_bf16 v[52:55], v[88:91], a[68:71], v[52:55]
    s_waitcnt lgkmcnt(4)
    v_mfma_f32_16x16x32_bf16 v[28:31], v[92:95], a[64:67], v[28:31]
    v_mfma_f32_16x16x32_bf16 v[56:59], v[92:95], a[68:71], v[56:59]
    s_waitcnt lgkmcnt(3)
    v_mfma_f32_16x16x32_bf16 v[32:35], v[72:75], a[64:67], v[32:35]
    v_mfma_f32_16x16x32_bf16 v[60:63], v[72:75], a[68:71], v[60:63]
    s_waitcnt lgkmcnt(2)
    v_mfma_f32_16x16x32_bf16 v[36:39], v[76:79], a[64:67], v[36:39]
    v_mfma_f32_16x16x32_bf16 v[64:67], v[76:79], a[68:71], v[64:67]
    s_waitcnt lgkmcnt(0)
    v_mfma_f32_16x16x32_bf16 v[40:43], v[80:83], a[64:67], v[40:43]
    v_mfma_f32_16x16x32_bf16 v[68:71], v[80:83], a[68:71], v[68:71]
    v_mov_b32 v125, 22
    ds_write_b32 v126, v125
    s_setprio 3
    v_subrev_u32 v7, 59392, v120
    v_mov_b32 v116, 148992
    ds_read_b128 v[116:119], v116
    s_waitcnt lgkmcnt(0)
    v_min3_u32 v116, v116, v117, v118
    v_min_u32 v116, v116, v119
    v_cmp_gt_u32 vcc, 21, v116
    s_nop 1
    s_cbranch_vccz Lc112d
    s_nop 1
    s_mov_b32 s25, 2000000
Lc112:
    s_nop 0
    s_sleep 1
    v_mov_b32 v116, 148992
    ds_read_b128 v[116:119], v116
    s_waitcnt lgkmcnt(0)
    v_min3_u32 v116, v116, v117, v118
    v_min_u32 v116, v116, v119
    v_cmp_gt_u32 vcc, 21, v116
    s_nop 1
    s_cbranch_vccz Lc112d
    s_sub_u32 s25, s25, 1
    s_cmp_lg_u32 s25, 0
    s_cbranch_scc1 Lc112
    s_nop 0
Lc112d:
    ds_write_b128 v121, v[16:19] offset:0
    ds_write_b128 v121, v[20:23] offset:64
    ds_write_b128 v121, v[24:27] offset:128
    ds_write_b128 v121, v[28:31] offset:192
    ds_write_b128 v121, v[32:35] offset:256
    ds_write_b128 v121, v[36:39] offset:320
    ds_write_b128 v121, v[40:43] offset:384
    ds_write_b128 v121, v[44:47] offset:7424
    ds_write_b128 v121, v[48:51] offset:7488
    ds_write_b128 v121, v[52:55] offset:7552
    ds_write_b128 v121, v[56:59] offset:7616
    ds_write_b128 v121, v[60:63] offset:7680
    ds_write_b128 v121, v[64:67] offset:7744
    ds_write_b128 v121, v[68:71] offset:7808
    v_mov_b32 v125, 23
    ds_write_b32 v126, v125
    v_lshlrev_b32 v80, 16, v108
    v_and_b32 v81, 0xffff0000, v108
    v_lshlrev_b32 v82, 16, v109
    v_and_b32 v83, 0xffff0000, v109
    v_lshlrev_b32 v84, 16, v110
    v_and_b32 v85, 0xffff0000, v110
    v_lshlrev_b32 v86, 16, v111
    v_and_b32 v87, 0xffff0000, v111
    v_lshlrev_b32 v88, 16, v112
    v_and_b32 v89, 0xffff0000, v112
    v_lshlrev_b32 v90, 16, v113
    v_and_b32 v91, 0xffff0000, v113
    v_lshlrev_b32 v92, 16, v114
    v_and_b32 v93, 0xffff0000, v114
    v_lshlrev_b32 v94, 16, v115
    v_and_b32 v95, 0xffff0000, v115
    v_mov_b32 v116, 149008
    ds_read_b128 v[116:119], v116
    s_waitcnt lgkmcnt(0)
    v_min3_u32 v116, v116, v117, v118
    v_min_u32 v116, v116, v119
    v_cmp_gt_u32 vcc, 12, v116
    s_nop 1
    s_cbranch_vccz Lc113d
    s_nop 1
    s_mov_b32 s25, 2000000
Lc113:
    s_nop 0
    s_sleep 1
    v_mov_b32 v116, 149008
    ds_read_b128 v[116:119], v116
    s_waitcnt lgkmcnt(0)
    v_min3_u32 v116, v116, v117, v118
    v_min_u32 v116, v116, v119
    v_cmp_gt_u32 vcc, 12, v116
    s_nop 1
    s_cbranch_vccz Lc113d
    s_sub_u32 s25, s25, 1
    s_cmp_lg_u32 s25, 0
    s_cbranch_scc1 Lc113
    s_nop 0
Lc113d:
    ds_read_b128 v[16:19], v7 offset:0
    ds_read_b128 v[20:23], v7 offset:16
    ds_read_b128 v[24:27], v7 offset:32
    ds_read_b128 v[28:31], v7 offset:48
    ds_read_b128 v[32:35], v7 offset:14848
    ds_read_b128 v[36:39], v7 offset:14864
    ds_read_b128 v[40:43], v7 offset:14880
    ds_read_b128 v[44:47], v7 offset:14896
    ds_read_b128 v[48:51], v7 offset:29696
    ds_read_b128 v[52:55], v7 offset:29712
    ds_read_b128 v[56:59], v7 offset:29728
    ds_read_b128 v[60:63], v7 offset:29744
    ds_read_b128 v[64:67], v7 offset:44544
    ds_read_b128 v[68:71], v7 offset:44560
    ds_read_b128 v[72:75], v7 offset:44576
    ds_read_b128 v[76:79], v7 offset:44592
    s_waitcnt lgkmcnt(8)
    v_pk_add_f32 v[16:17], v[16:17], v[32:33]
    v_pk_add_f32 v[18:19], v[18:19], v[34:35]
    v_pk_add_f32 v[20:21], v[20:21], v[36:37]
    v_pk_add_f32 v[22:23], v[22:23], v[38:39]
    v_pk_add_f32 v[24:25], v[24:25], v[40:41]
    v_pk_add_f32 v[26:27], v[26:27], v[42:43]
    v_pk_add_f32 v[28:29], v[28:29], v[44:45]
    v_pk_add_f32 v[30:31], v[30:31], v[46:47]
    s_waitcnt lgkmcnt(0)
    v_mov_b32 v125, 24
    ds_write_b32 v126, v125
    v_pk_add_f32 v[48:49], v[48:49], v[64:65]
    v_pk_add_f32 v[50:51], v[50:51], v[66:67]
    v_pk_add_f32 v[52:53], v[52:53], v[68:69]
    v_pk_add_f32 v[54:55], v[54:55], v[70:71]
    v_pk_add_f32 v[56:57], v[56:57], v[72:73]
    v_pk_add_f32 v[58:59], v[58:59], v[74:75]
    v_pk_add_f32 v[60:61], v[60:61], v[76:77]
    v_pk_add_f32 v[62:63], v[62:63], v[78:79]
    v_pk_add_f32 v[96:97], v[16:17], v[48:49]
    v_pk_add_f32 v[98:99], v[18:19], v[50:51]
    v_pk_add_f32 v[100:101], v[20:21], v[52:53]
    v_pk_add_f32 v[102:103], v[22:23], v[54:55]
    v_pk_add_f32 v[104:105], v[24:25], v[56:57]
    v_pk_add_f32 v[106:107], v[26:27], v[58:59]
    v_pk_add_f32 v[8:9], v[28:29], v[60:61]
    v_pk_add_f32 v[10:11], v[30:31], v[62:63]
    v_mov_b32 v116, 148992
    ds_read_b128 v[116:119], v116
    s_waitcnt lgkmcnt(0)
    v_min3_u32 v116, v116, v117, v118
    v_min_u32 v116, v116, v119
    v_cmp_gt_u32 vcc, 23, v116
    s_nop 1
    s_cbranch_vccz Lc114d
    s_nop 1
    s_mov_b32 s25, 2000000
Lc114:
    s_nop 0
    s_sleep 1
    v_mov_b32 v116, 148992
    ds_read_b128 v[116:119], v116
    s_waitcnt lgkmcnt(0)
    v_min3_u32 v116, v116, v117, v118
    v_min_u32 v116, v116, v119
    v_cmp_gt_u32 vcc, 23, v116
    s_nop 1
    s_cbranch_vccz Lc114d
    s_sub_u32 s25, s25, 1
    s_cmp_lg_u32 s25, 0
    s_cbranch_scc1 Lc114
    s_nop 0
Lc114d:
    ds_read_b128 v[16:19], v120 offset:0
    ds_read_b128 v[20:23], v120 offset:16
    ds_read_b128 v[24:27], v120 offset:32
    ds_read_b128 v[28:31], v120 offset:48
    ds_read_b128 v[32:35], v120 offset:14848
    ds_read_b128 v[36:39], v120 offset:14864
    ds_read_b128 v[40:43], v120 offset:14880
    ds_read_b128 v[44:47], v120 offset:14896
    ds_read_b128 v[48:51], v120 offset:29696
    ds_read_b128 v[52:55], v120 offset:29712
    ds_read_b128 v[56:59], v120 offset:29728
    ds_read_b128 v[60:63], v120 offset:29744
    ds_read_b128 v[64:67], v120 offset:44544
    ds_read_b128 v[68:71], v120 offset:44560
    ds_read_b128 v[72:75], v120 offset:44576
    ds_read_b128 v[76:79], v120 offset:44592
    s_mov_b32 s40, 0x7f7f7f7f
    s_mov_b32 s41, 0x7f7f7f7f
    s_mov_b32 s21, 6832128
    s_mov_b32 s22, 8667136
    s_waitcnt lgkmcnt(8)
    v_pk_add_f32 v[16:17], v[16:17], v[32:33]
    v_pk_add_f32 v[18:19], v[18:19], v[34:35]
    v_pk_add_f32 v[20:21], v[20:21], v[36:37]
    v_pk_add_f32 v[22:23], v[22:23], v[38:39]
    v_pk_add_f32 v[24:25], v[24:25], v[40:41]
    v_pk_add_f32 v[26:27], v[26:27], v[42:43]
    v_pk_add_f32 v[28:29], v[28:29], v[44:45]
    v_pk_add_f32 v[30:31], v[30:31], v[46:47]
    v_pk_add_f32 v[16:17], v[16:17], v[96:97]
    v_pk_add_f32 v[18:19], v[18:19], v[98:99]
    v_pk_add_f32 v[20:21], v[20:21], v[100:101]
    v_pk_add_f32 v[22:23], v[22:23], v[102:103]
    v_pk_add_f32 v[24:25], v[24:25], v[104:105]
    v_pk_add_f32 v[26:27], v[26:27], v[106:107]
    v_pk_add_f32 v[28:29], v[28:29], v[8:9]
    v_pk_add_f32 v[30:31], v[30:31], v[10:11]
    s_waitcnt lgkmcnt(0)
    v_mov_b32 v125, 25
    ds_write_b32 v126, v125
    v_pk_add_f32 v[48:49], v[48:49], v[64:65]
    v_pk_add_f32 v[50:51], v[50:51], v[66:67]
    v_pk_add_f32 v[52:53], v[52:53], v[68:69]
    v_pk_add_f32 v[54:55], v[54:55], v[70:71]
    v_pk_add_f32 v[56:57], v[56:57], v[72:73]
    v_pk_add_f32 v[58:59], v[58:59], v[74:75]
    v_pk_add_f32 v[60:61], v[60:61], v[76:77]
    v_pk_add_f32 v[62:63], v[62:63], v[78:79]
    v_pk_add_f32 v[16:17], v[16:17], v[48:49]
    v_pk_add_f32 v[18:19], v[18:19], v[50:51]
    v_pk_add_f32 v[20:21], v[20:21], v[52:53]
    v_pk_add_f32 v[22:23], v[22:23], v[54:55]
    v_pk_add_f32 v[24:25], v[24:25], v[56:57]
    v_pk_add_f32 v[26:27], v[26:27], v[58:59]
    v_pk_add_f32 v[28:29], v[28:29], v[60:61]
    v_pk_add_f32 v[30:31], v[30:31], v[62:63]
    v_cvt_pk_bf16_f32 v32, v16, v17
    v_cvt_pk_bf16_f32 v33, v18, v19
    v_cvt_pk_bf16_f32 v34, v20, v21
    v_cvt_pk_bf16_f32 v35, v22, v23
    v_cvt_pk_bf16_f32 v36, v24, v25
    v_cvt_pk_bf16_f32 v37, v26, v27
    v_cvt_pk_bf16_f32 v38, v28, v29
    v_cvt_pk_bf16_f32 v39, v30, v31
    v_lshlrev_b32 v16, 16, v32
    v_and_b32 v17, 0xffff0000, v32
    v_lshlrev_b32 v18, 16, v33
    v_and_b32 v19, 0xffff0000, v33
    v_lshlrev_b32 v20, 16, v34
    v_and_b32 v21, 0xffff0000, v34
    v_lshlrev_b32 v22, 16, v35
    v_and_b32 v23, 0xffff0000, v35
    v_lshlrev_b32 v24, 16, v36
    v_and_b32 v25, 0xffff0000, v36
    v_lshlrev_b32 v26, 16, v37
    v_and_b32 v27, 0xffff0000, v37
    v_lshlrev_b32 v28, 16, v38
    v_and_b32 v29, 0xffff0000, v38
    v_lshlrev_b32 v30, 16, v39
    v_and_b32 v31, 0xffff0000, v39
    v_pk_add_f32 v[16:17], v[16:17], v[80:81]
    v_pk_add_f32 v[18:19], v[18:19], v[82:83]
    v_pk_add_f32 v[20:21], v[20:21], v[84:85]
    v_pk_add_f32 v[22:23], v[22:23], v[86:87]
    v_pk_add_f32 v[24:25], v[24:25], v[88:89]
    v_pk_add_f32 v[26:27], v[26:27], v[90:91]
    v_pk_add_f32 v[28:29], v[28:29], v[92:93]
    v_pk_add_f32 v[30:31], v[30:31], v[94:95]
    v_cvt_pk_bf16_f32 v108, v16, v17
    v_cvt_pk_bf16_f32 v109, v18, v19
    v_cvt_pk_bf16_f32 v110, v20, v21
    v_cvt_pk_bf16_f32 v111, v22, v23
    v_cvt_pk_bf16_f32 v112, v24, v25
    v_cvt_pk_bf16_f32 v113, v26, v27
    v_cvt_pk_bf16_f32 v114, v28, v29
    v_cvt_pk_bf16_f32 v115, v30, v31
    v_mov_b32 v64, 0
    v_mov_b32 v65, 0
    v_mov_b32 v66, 0
    v_mov_b32 v67, 0
    v_mov_b32 v68, 0x3f803f80
    s_mov_b64 exec, s[40:41]
    s_cmp_lg_u32 s45, 0
    s_cbranch_scc1 Ltw115p
    buffer_store_dwordx4 v[108:111], v122, s[4:7], s21 offen offset:0 sc1
    buffer_store_dwordx4 v[112:115], v122, s[4:7], s21 offen offset:512 sc1
    s_branch Ltw115d
Ltw115p:
    buffer_store_dwordx4 v[108:111], v122, s[4:7], s21 offen offset:0
    buffer_store_dwordx4 v[112:115], v122, s[4:7], s21 offen offset:512
Ltw115d:
    v_dot2c_f32_bf16 v64, v108, v68
    v_dot2c_f32_bf16 v65, v108, v108
    v_dot2c_f32_bf16 v66, v109, v68
    v_dot2c_f32_bf16 v67, v109, v109
    v_dot2c_f32_bf16 v64, v110, v68
    v_dot2c_f32_bf16 v65, v110, v110
    v_dot2c_f32_bf16 v66, v111, v68
    v_dot2c_f32_bf16 v67, v111, v111
    v_dot2c_f32_bf16 v64, v112, v68
    v_dot2c_f32_bf16 v65, v112, v112
    v_dot2c_f32_bf16 v66, v113, v68
    v_dot2c_f32_bf16 v67, v113, v113
    v_dot2c_f32_bf16 v64, v114, v68
    v_dot2c_f32_bf16 v65, v114, v114
    v_dot2c_f32_bf16 v66, v115, v68
    v_dot2c_f32_bf16 v67, v115, v115
    s_mov_b64 exec, -1
    s_mov_b32 s40, 0x01010101
    s_mov_b32 s41, 0x01010101
    s_nop 1
    v_add_f32 v64, v64, v66
    v_add_f32 v65, v65, v67
    s_nop 0
    v_add_f32_dpp v66, v64, v64 quad_perm:[1,0,3,2] row_mask:0xf bank_mask:0xf
    v_add_f32_dpp v67, v65, v65 quad_perm:[1,0,3,2] row_mask:0xf bank_mask:0xf
    s_nop 0
    v_add_f32_dpp v64, v66, v66 quad_perm:[2,3,0,1] row_mask:0xf bank_mask:0xf
    v_add_f32_dpp v65, v67, v67 quad_perm:[2,3,0,1] row_mask:0xf bank_mask:0xf
    s_nop 0
    v_add_f32_dpp v66, v64, v64 row_half_mirror row_mask:0xf bank_mask:0xf
    v_add_f32_dpp v67, v65, v65 row_half_mirror row_mask:0xf bank_mask:0xf
    s_mov_b64 exec, s[40:41]
    s_cmp_lg_u32 s45, 0
    s_cbranch_scc1 Ltw116p
    buffer_store_dwordx2 v[66:67], v124, s[4:7], s22 offen sc1
    s_branch Ltw116d
Ltw116p:
    buffer_store_dwordx2 v[66:67], v124, s[4:7], s22 offen
Ltw116d:
    s_mov_b64 exec, -1
    v_mov_b32 v4, 5
    v_mov_b32 v5, 0
    s_waitcnt vmcnt(0)
    s_mov_b64 exec, 1
    s_cmp_lg_u32 s45, 0
    s_cbranch_scc1 Ltw117p
    buffer_store_dword v4, v5, s[4:7], s28 offen sc1
    s_branch Ltw117d
Ltw117p:
    buffer_store_dword v4, v5, s[4:7], s28 offen
Ltw117d:
    s_mov_b64 exec, -1
    v_accvgpr_read_b32 v7, a124
    s_mov_b32 s25, 200000
Lpoll118:
    s_nop 3
    buffer_load_dword v4, v7, s[4:7], 0 offen sc1
    s_waitcnt vmcnt(0)
    v_cmp_gt_u32 vcc, 5, v4
    s_nop 1
    s_cbranch_vccz Lpoll118d
    s_sub_u32 s25, s25, 1
    s_cmp_lg_u32 s25, 0
    s_cbranch_scc1 Lpoll118
Lpoll118d:
    s_nop 0
    s_mul_i32 s47, s26, 28672
    s_add_u32 s47, s47, 6832128
    s_lshl_b32 s23, s26, 10
    s_add_u32 s23, s23, 8667136
    v_and_b32 v4, 31, v0
    v_lshlrev_b32 v4, 5, v4
    buffer_load_dwordx4 a[0:3], v1, s[4:7], s47 offen offset:0 sc1
    buffer_load_dwordx4 a[4:7], v1, s[4:7], s47 offen offset:1024 sc1
    buffer_load_dwordx4 a[8:11], v1, s[4:7], s47 offen offset:2048 sc1
    buffer_load_dwordx4 a[12:15], v1, s[4:7], s47 offen offset:3072 sc1
    s_add_u32 s47, s47, 4096
    buffer_load_dwordx4 a[16:19], v1, s[4:7], s47 offen offset:0 sc1
    buffer_load_dwordx4 a[20:23], v1, s[4:7], s47 offen offset:1024 sc1
    buffer_load_dwordx4 v[96:99], v4, s[4:7], s23 offen sc1
    buffer_load_dwordx4 v[100:103], v4, s[4:7], s23 offen offset:16 sc1
    buffer_load_dwordx4 a[24:27], v1, s[4:7], s47 offen offset:2048 sc1
    buffer_load_dwordx4 a[28:31], v1, s[4:7], s47 offen offset:3072 sc1
    s_add_u32 s47, s47, 4096
    buffer_load_dwordx4 a[32:35], v1, s[4:7], s47 offen offset:0 sc1
    buffer_load_dwordx4 a[36:39], v1, s[4:7], s47 offen offset:1024 sc1
    buffer_load_dwordx4 a[40:43], v1, s[4:7], s47 offen offset:2048 sc1
    buffer_load_dwordx4 a[44:47], v1, s[4:7], s47 offen offset:3072 sc1
    s_add_u32 s47, s47, 4096
    buffer_load_dwordx4 a[48:51], v1, s[4:7], s47 offen offset:0 sc1
    buffer_load_dwordx4 a[52:55], v1, s[4:7], s47 offen offset:1024 sc1
    v_mov_b32 v116, 148992
    ds_read_b128 v[116:119], v116
    s_waitcnt lgkmcnt(0)
    v_min3_u32 v116, v116, v117, v118
    v_min_u32 v116, v116, v119
    v_cmp_gt_u32 vcc, 25, v116
    s_nop 1
    s_cbranch_vccz Lc119d
    s_nop 1
    s_mov_b32 s25, 2000000
Lc119:
    s_nop 0
    s_sleep 1
    v_mov_b32 v116, 148992
    ds_read_b128 v[116:119], v116
    s_waitcnt lgkmcnt(0)
    v_min3_u32 v116, v116, v117, v118
    v_min_u32 v116, v116, v119
    v_cmp_gt_u32 vcc, 25, v116
    s_nop 1
    s_cbranch_vccz Lc119d
    s_sub_u32 s25, s25, 1
    s_cmp_lg_u32 s25, 0
    s_cbranch_scc1 Lc119
    s_nop 0
Lc119d:
    v_mov_b32 v116, 149008
    ds_read_b128 v[116:119], v116
    s_waitcnt lgkmcnt(0)
    v_min3_u32 v116, v116, v117, v118
    v_min_u32 v116, v116, v119
    v_cmp_gt_u32 vcc, 13, v116
    s_nop 1
    s_cbranch_vccz Lc120d
    s_nop 1
    s_mov_b32 s25, 2000000
Lc120:
    s_nop 0
    s_sleep 1
    v_mov_b32 v116, 149008
    ds_read_b128 v[116:119], v116
    s_waitcnt lgkmcnt(0)
    v_min3_u32 v116, v116, v117, v118
    v_min_u32 v116, v116, v119
    v_cmp_gt_u32 vcc, 13, v116
    s_nop 1
    s_cbranch_vccz Lc120d
    s_sub_u32 s25, s25, 1
    s_cmp_lg_u32 s25, 0
    s_cbranch_scc1 Lc120
    s_nop 0
Lc120d:
    ds_read_b128 v[64:67], v1 offset:0
    ds_read_b128 v[68:71], v1 offset:29696
    ds_read_b128 v[72:75], v1 offset:1024
    ds_read_b128 v[76:79], v1 offset:30720
    ds_read_b128 a[116:119], v1 offset:2048
    s_waitcnt vmcnt(15)
    s_waitcnt lgkmcnt(4)
    v_mfma_f32_32x32x16_bf16 v[32:47], v[64:67], a[0:3], 0
    ds_read_b128 a[120:123], v1 offset:31744
    buffer_load_dwordx4 a[56:59], v1, s[4:7], s47 offen offset:2048 sc1
    s_waitcnt lgkmcnt(4)
    v_mfma_f32_32x32x16_bf16 v[48:63], a[0:3], v[68:71], 0
    ds_read_b128 v[64:67], v1 offset:3072
    buffer_load_dwordx4 a[60:63], v1, s[4:7], s47 offen offset:3072 sc1
    s_add_u32 s47, s47, 4096
    s_waitcnt vmcnt(16)
    s_waitcnt lgkmcnt(4)
    v_mfma_f32_32x32x16_bf16 v[32:47], v[72:75], a[4:7], v[32:47]
    ds_read_b128 v[68:71], v1 offset:32768
    buffer_load_dwordx4 a[64:67], v1, s[4:7], s47 offen offset:0 sc1
    s_waitcnt lgkmcnt(4)
    v_mfma_f32_32x32x16_bf16 v[48:63], a[4:7], v[76:79], v[48:63]
    ds_read_b128 v[72:75], v1 offset:4096
    buffer_load_dwordx4 a[68:71], v1, s[4:7], s47 offen offset:1024 sc1
    s_waitcnt vmcnt(17)
    s_waitcnt lgkmcnt(4)
    v_mfma_f32_32x32x16_bf16 v[32:47], a[116:119], a[8:11], v[32:47]
    ds_read_b128 v[76:79], v1 offset:33792
    buffer_load_dwordx4 a[72:75], v1, s[4:7], s47 offen offset:2048 sc1
    s_waitcnt lgkmcnt(4)
    v_mfma_f32_32x32x16_bf16 v[48:63], a[8:11], a[120:123], v[48:63]
    ds_read_b128 a[116:119], v1 offset:5120
    buffer_load_dwordx4 a[76:79], v1, s[4:7], s47 offen offset:3072 sc1
    s_add_u32 s47, s47, 4096
    s_waitcnt vmcnt(18)
    s_waitcnt lgkmcnt(4)
    v_mfma_f32_32x32x16_bf16 v[32:47], v[64:67], a[12:15], v[32:47]
    ds_read_b128 a[120:123], v1 offset:34816
    buffer_load_dwordx4 a[80:83], v1, s[4:7], s47 offen offset:0 sc1
    s_waitcnt lgkmcnt(4)
    v_mfma_f32_32x32x16_bf16 v[48:63], a[12:15], v[68:71], v[48:63]
    ds_read_b128 v[64:67], v1 offset:6144
    buffer_load_dwordx4 a[84:87], v1, s[4:7], s47 offen offset:1024 sc1
    s_waitcnt vmcnt(19)
    s_waitcnt lgkmcnt(4)
    v_mfma_f32_32x32x16_bf16 v[32:47], v[72:75], a[16:19], v[32:47]
    ds_read_b128 v[68:71], v1 offset:35840
    buffer_load_dwordx4 a[88:91], v1, s[4:7], s47 offen offset:2048 sc1
    s_waitcnt lgkmcnt(4)
    v_mfma_f32_32x32x16_bf16 v[48:63], a[16:19], v[76:79], v[48:63]
    ds_read_b128 v[72:75], v1 offset:7168
    buffer_load_dwordx4 a[92:95], v1, s[4:7], s47 offen offset:3072 sc1
    s_add_u32 s47, s47, 4096
    s_waitcnt vmcnt(20)
    s_waitcnt lgkmcnt(4)
    v_mfma_f32_32x32x16_bf16 v[32:47], a[116:119], a[20:23], v[32:47]
    ds_read_b128 v[76:79], v1 offset:36864
    buffer_load_dwordx4 a[96:99], v1, s[4:7], s47 offen offset:0 sc1
    s_waitcnt lgkmcnt(4)
    v_mfma_f32_32x32x16_bf16 v[48:63], a[20:23], a[120:123], v[48:63]
    ds_read_b128 a[116:119], v1 offset:8192
    buffer_load_dwordx4 a[100:103], v1, s[4:7], s47 offen offset:1024 sc1
    s_waitcnt vmcnt(19)
    s_waitcnt lgkmcnt(4)
    v_mfma_f32_32x32x16_bf16 v[32:47], v[64:67], a[24:27], v[32:47]
    ds_read_b128 a[120:123], v1 offset:37888
    buffer_load_dwordx4 a[104:107], v1, s[4:7], s47 offen offset:2048 sc1
    s_waitcnt lgkmcnt(4)
    v_mfma_f32_32x32x16_bf16 v[48:63], a[24:27], v[68:71], v[48:63]
    ds_read_b128 v[64:67], v1 offset:9216
    buffer_load_dwordx4 a[108:111], v1, s[4:7], s47 offen offset:3072 sc1
    v_mov_b32 v125, 26
    ds_write_b32 v126, v125
    s_waitcnt vmcnt(20)
    s_waitcnt lgkmcnt(5)
    v_mfma_f32_32x32x16_bf16 v[32:47], v[72:75], a[28:31], v[32:47]
    ds_read_b128 v[68:71], v1 offset:38912
    s_waitcnt lgkmcnt(5)
    v_mfma_f32_32x32x16_bf16 v[48:63], a[28:31], v[76:79], v[48:63]
    ds_read_b128 v[72:75], v1 offset:10240
    s_waitcnt vmcnt(19)
    s_waitcnt lgkmcnt(5)
    v_mfma_f32_32x32x16_bf16 v[32:47], a[116:119], a[32:35], v[32:47]
    ds_read_b128 v[76:79], v1 offset:39936
    s_waitcnt lgkmcnt(5)
    v_mfma_f32_32x32x16_bf16 v[48:63], a[32:35], a[120:123], v[48:63]
    ds_read_b128 a[116:119], v1 offset:11264
    s_waitcnt vmcnt(18)
    s_waitcnt lgkmcnt(5)
    v_mfma_f32_32x32x16_bf16 v[32:47], v[64:67], a[36:39], v[32:47]
    ds_read_b128 a[120:123], v1 offset:40960
    s_waitcnt lgkmcnt(4)
    v_mfma_f32_32x32x16_bf16 v[48:63], a[36:39], v[68:71], v[48:63]
    ds_read_b128 v[64:67], v1 offset:12288
    s_waitcnt vmcnt(17)
    s_waitcnt lgkmcnt(4)
    v_mfma_f32_32x32x16_bf16 v[32:47], v[72:75], a[40:43], v[32:47]
    ds_read_b128 v[68:71], v1 offset:41984
    s_waitcnt lgkmcnt(4)
    v_mfma_f32_32x32x16_bf16 v[48:63], a[40:43], v[76:79], v[48:63]
    ds_read_b128 v[72:75], v1 offset:13312
    s_waitcnt vmcnt(16)
    s_waitcnt lgkmcnt(4)
    v_mfma_f32_32x32x16_bf16 v[32:47], a[116:119], a[44:47], v[32:47]
    ds_read_b128 v[76:79], v1 offset:43008
    s_waitcnt lgkmcnt(4)
    v_mfma_f32_32x32x16_bf16 v[48:63], a[44:47], a[120:123], v[48:63]
    ds_read_b128 a[116:119], v1 offset:14336
    s_waitcnt vmcnt(15)
    s_waitcnt lgkmcnt(4)
    v_mfma_f32_32x32x16_bf16 v[32:47], v[64:67], a[48:51], v[32:47]
    ds_read_b128 a[120:123], v1 offset:44032
    v_add_f32 v96, v96, v98
    v_add_f32 v100, v100, v102
    v_add_f32 v97, v97, v99
    v_add_f32 v101, v101, v103
    s_waitcnt lgkmcnt(4)
    v_mfma_f32_32x32x16_bf16 v[48:63], a[48:51], v[68:71], v[48:63]
    ds_read_b128 v[64:67], v1 offset:15360
    v_add_f32 v96, v96, v100
    v_add_f32 v97, v97, v101
    v_mul_f32 v96, 0x3b124925, v96
    v_mul_f32 v97, 0x3b124925, v97
    s_waitcnt vmcnt(14)
    s_waitcnt lgkmcnt(4)
    v_mfma_f32_32x32x16_bf16 v[32:47], v[72:75], a[52:55], v[32:47]
    ds_read_b128 v[68:71], v1 offset:45056
    v_fma_f32 v97, -v96, v96, v97
    v_max_f32 v97, 0, v97
    v_cvt_pk_bf16_f32 v97, v97, v97
    v_lshlrev_b32 v97, 16, v97
    s_waitcnt lgkmcnt(4)
    v_mfma_f32_32x32x16_bf16 v[48:63], a[52:55], v[76:79], v[48:63]
    ds_read_b128 v[72:75], v1 offset:16384
    v_add_f32 v97, 0x3727c5ac, v97
    v_cvt_pk_bf16_f32 v97, v97, v97
    v_lshlrev_b32 v97, 16, v97
    v_sqrt_f32 v97, v97
    s_waitcnt vmcnt(13)
    s_waitcnt lgkmcnt(4)
    v_mfma_f32_32x32x16_bf16 v[32:47], a[116:119], a[56:59], v[32:47]
    ds_read_b128 v[76:79], v1 offset:46080
    v_sub_f32 v96, 0, v96
    v_cvt_pk_bf16_f32 v105, v97, v97
    v_lshlrev_b32 v105, 16, v105
    v_rcp_f32 v104, v105
    s_waitcnt lgkmcnt(4)
    v_mfma_f32_32x32x16_bf16 v[48:63], a[56:59], a[120:123], v[48:63]
    ds_read_b128 a[116:119], v1 offset:17408
    v_cvt_pk_bf16_f32 v98, v96, v96
    v_and_b32 v99, 0xffff, v98
    v_accvgpr_write_b32 a112, v98
    v_accvgpr_write_b32 a113, v99
    s_waitcnt vmcnt(12)
    s_waitcnt lgkmcnt(4)
    v_mfma_f32_32x32x16_bf16 v[32:47], v[64:67], a[60:63], v[32:47]
    ds_read_b128 a[120:123], v1 offset:47104
    v_accvgpr_write_b32 a114, v98
    v_accvgpr_write_b32 a115, v99
    v_and_b32 v4, 31, v0
    v_lshlrev_b32 v4, 2, v4
    s_waitcnt lgkmcnt(4)
    v_mfma_f32_32x32x16_bf16 v[48:63], a[60:63], v[68:71], v[48:63]
    ds_read_b128 v[64:67], v1 offset:18432
    s_lshl_b32 s23, s18, 7
    s_add_u32 s23, s23, 148480
    v_add_u32 v4, s23, v4
    ds_write_b32 v4, v104
    s_waitcnt vmcnt(11)
    s_waitcnt lgkmcnt(5)
    v_mfma_f32_32x32x16_bf16 v[32:47], v[72:75], a[64:67], v[32:47]
    ds_read_b128 v[68:71], v1 offset:48128
    v_lshrrev_b32 v5, 5, v0
    v_lshlrev_b32 v5, 4, v5
    v_add_u32 v5, s23, v5
    ds_read_b128 v[80:83], v5 offset:0
    s_waitcnt lgkmcnt(6)
    v_mfma_f32_32x32x16_bf16 v[48:63], a[64:67], v[76:79], v[48:63]
    ds_read_b128 v[72:75], v1 offset:19456
    ds_read_b128 v[84:87], v5 offset:32
    ds_read_b128 v[88:91], v5 offset:64
    ds_read_b128 v[92:95], v5 offset:96
    s_lshl_b32 s21, s16, 4
    s_waitcnt vmcnt(10)
    s_waitcnt lgkmcnt(9)
    v_mfma_f32_32x32x16_bf16 v[32:47], a[116:119], a[68:71], v[32:47]
    ds_read_b128 v[76:79], v1 offset:49152
    s_add_u32 s21, s21, s17
    s_lshl_b32 s21, s21, 2
    s_add_u32 s21, s21, s18
    s_lshl_b32 s21, s21, 12
    s_waitcnt lgkmcnt(9)
    v_mfma_f32_32x32x16_bf16 v[48:63], a[68:71], a[120:123], v[48:63]
    ds_read_b128 a[116:119], v1 offset:20480
    s_add_u32 s24, s21, 12926976
    s_lshl_b32 s22, s18, 12
    v_add_u32 v6, s22, v2
    v_mov_b32 v7, -2
    s_waitcnt vmcnt(9)
    s_waitcnt lgkmcnt(9)
    v_mfma_f32_32x32x16_bf16 v[32:47], v[64:67], a[72:75], v[32:47]
    ds_read_b128 a[120:123], v1 offset:50176
    s_waitcnt lgkmcnt(8)
    v_mfma_f32_32x32x16_bf16 v[48:63], a[72:75], v[68:71], v[48:63]
    ds_read_b128 v[64:67], v1 offset:21504
    s_waitcnt vmcnt(8)
    s_waitcnt lgkmcnt(7)
    v_mfma_f32_32x32x16_bf16 v[32:47], v[72:75], a[76:79], v[32:47]
    ds_read_b128 v[68:71], v1 offset:51200
    s_waitcnt lgkmcnt(4)
    v_mfma_f32_32x32x16_bf16 v[48:63], a[76:79], v[76:79], v[48:63]
    ds_read_b128 v[72:75], v1 offset:22528
    s_waitcnt vmcnt(7)
    s_waitcnt lgkmcnt(4)
    v_mfma_f32_32x32x16_bf16 v[32:47], a[116:119], a[80:83], v[32:47]
    ds_read_b128 v[76:79], v1 offset:52224
    s_waitcnt lgkmcnt(4)
    v_mfma_f32_32x32x16_bf16 v[48:63], a[80:83], a[120:123], v[48:63]
    ds_read_b128 a[116:119], v1 offset:23552
    s_waitcnt vmcnt(6)
    s_waitcnt lgkmcnt(4)
    v_mfma_f32_32x32x16_bf16 v[32:47], v[64:67], a[84:87], v[32:47]
    ds_read_b128 a[120:123], v1 offset:53248
    s_waitcnt lgkmcnt(4)
    v_mfma_f32_32x32x16_bf16 v[48:63], a[84:87], v[68:71], v[48:63]
    ds_read_b128 v[64:67], v1 offset:24576
    s_waitcnt vmcnt(5)
    s_waitcnt lgkmcnt(4)
    v_mfma_f32_32x32x16_bf16 v[32:47], v[72:75], a[88:91], v[32:47]
    ds_read_b128 v[68:71], v1 offset:54272
    s_waitcnt lgkmcnt(4)
    v_mfma_f32_32x32x16_bf16 v[48:63], a[88:91], v[76:79], v[48:63]
    ds_read_b128 v[72:75], v1 offset:25600
    v_mov_b32 v116, 149008
    ds_read_b128 v[116:119], v116
    s_waitcnt vmcnt(4)
    s_waitcnt lgkmcnt(5)
    v_mfma_f32_32x32x16_bf16 v[32:47], a[116:119], a[92:95], v[32:47]
    ds_read_b128 v[76:79], v1 offset:55296
    s_waitcnt lgkmcnt(5)
    v_mfma_f32_32x32x16_bf16 v[48:63], a[92:95], a[120:123], v[48:63]
    ds_read_b128 a[116:119], v1 offset:26624
    s_waitcnt vmcnt(3)
    s_waitcnt lgkmcnt(5)
    v_mfma_f32_32x32x16_bf16 v[32:47], v[64:67], a[96:99], v[32:47]
    ds_read_b128 a[120:123], v1 offset:56320
    s_waitcnt lgkmcnt(5)
    v_mfma_f32_32x32x16_bf16 v[48:63], a[96:99], v[68:71], v[48:63]
    ds_read_b128 v[64:67], v1 offset:27648
    s_waitcnt vmcnt(2)
    s_waitcnt lgkmcnt(5)
    v_mfma_f32_32x32x16_bf16 v[32:47], v[72:75], a[100:103], v[32:47]
    ds_read_b128 v[68:71], v1 offset:57344
    s_waitcnt lgkmcnt(4)
    v_mfma_f32_32x32x16_bf16 v[48:63], a[100:103], v[76:79], v[48:63]
    ds_read_b128 v[72:75], v1 offset:28672
    s_waitcnt vmcnt(1)
    s_waitcnt lgkmcnt(4)
    v_mfma_f32_32x32x16_bf16 v[32:47], a[116:119], a[104:107], v[32:47]
    ds_read_b128 v[76:79], v1 offset:58368
    s_waitcnt lgkmcnt(4)
    v_mfma_f32_32x32x16_bf16 v[48:63], a[104:107], a[120:123], v[48:63]
    v_min3_u32 v116, v116, v117, v118
    v_min_u32 v116, v116, v119
    v_cmp_gt_u32 vcc, 14, v116
    s_nop 1
    s_cbranch_vccz Lc121d
    s_nop 5
    s_mov_b32 s25, 2000000
Lc121:
    s_nop 0
    s_sleep 1
    v_mov_b32 v116, 149008
    ds_read_b128 v[116:119], v116
    s_waitcnt lgkmcnt(0)
    v_min3_u32 v116, v116, v117, v118
    v_min_u32 v116, v116, v119
    v_cmp_gt_u32 vcc, 14, v116
    s_nop 1
    s_cbranch_vccz Lc121d
    s_sub_u32 s25, s25, 1
    s_cmp_lg_u32 s25, 0
    s_cbranch_scc1 Lc121
    s_nop 0
Lc121d:
    ds_read_b128 a[116:119], v1 offset:59392
    s_waitcnt vmcnt(0)
    s_waitcnt lgkmcnt(4)
    v_mfma_f32_32x32x16_bf16 v[32:47], v[64:67], a[108:111], v[32:47]
    ds_read_b128 a[120:123], v1 offset:60416
    s_waitcnt lgkmcnt(4)
    v_mfma_f32_32x32x16_bf16 v[48:63], a[108:111], v[68:71], v[48:63]
    ds_read_b128 v[64:67], v1 offset:61440
    s_waitcnt lgkmcnt(4)
    v_mfma_f32_32x32x16_bf16 v[32:47], v[72:75], a[112:115], v[32:47]
    ds_read_b128 v[68:71], v1 offset:62464
    s_waitcnt lgkmcnt(4)
    v_mfma_f32_32x32x16_bf16 v[48:63], a[112:115], v[76:79], v[48:63]
    ds_read_b128 v[72:75], v1 offset:63488
    s_waitcnt lgkmcnt(4)
    v_mfma_f32_32x32x16_bf16 v[16:31], a[116:119], a[0:3], 0
    ds_read_b128 v[76:79], v1 offset:64512
    s_waitcnt lgkmcnt(4)
    v_mfma_f32_32x32x16_bf16 v[16:31], a[120:123], a[4:7], v[16:31]
    ds_read_b128 a[116:119], v2 offset:0
    s_nop 1
    v_mul_f32 v32, v32, v104
    v_mul_f32 v33, v33, v104
    v_mul_f32 v34, v34, v104
    v_mul_f32 v35, v35, v104
    v_mul_f32 v36, v36, v104
    s_waitcnt lgkmcnt(4)
    v_mfma_f32_32x32x16_bf16 v[16:31], v[64:67], a[8:11], v[16:31]
    ds_read_b128 a[120:123], v2 offset:1024
    v_mul_f32 v37, v37, v104
    v_mul_f32 v38, v38, v104
    v_mul_f32 v39, v39, v104
    v_mul_f32 v40, v40, v104
    v_mul_f32 v41, v41, v104
    s_waitcnt lgkmcnt(4)
    v_mfma_f32_32x32x16_bf16 v[16:31], v[68:71], a[12:15], v[16:31]
    ds_read_b128 v[64:67], v2 offset:2048
    v_mul_f32 v42, v42, v104
    v_mul_f32 v43, v43, v104
    v_mul_f32 v44, v44, v104
    v_mul_f32 v45, v45, v104
    v_mul_f32 v46, v46, v104
    s_waitcnt lgkmcnt(4)
    v_mfma_f32_32x32x16_bf16 v[16:31], v[72:75], a[16:19], v[16:31]
    ds_read_b128 v[68:71], v2 offset:3072
    v_mul_f32 v47, v47, v104
    v_cvt_pk_bf16_f32 v8, v32, v33
    v_cvt_pk_bf16_f32 v9, v34, v35
    v_cvt_pk_bf16_f32 v10, v36, v37
    v_cvt_pk_bf16_f32 v11, v38, v39
    s_waitcnt lgkmcnt(4)
    v_mfma_f32_32x32x16_bf16 v[16:31], v[76:79], a[20:23], v[16:31]
    ds_read_b128 v[72:75], v2 offset:4096
    v_cvt_pk_bf16_f32 v12, v40, v41
    v_cvt_pk_bf16_f32 v13, v42, v43
    v_cvt_pk_bf16_f32 v14, v44, v45
    v_cvt_pk_bf16_f32 v15, v46, v47
    v_min_u32 v8, v8, v7
    s_waitcnt lgkmcnt(4)
    v_mfma_f32_32x32x16_bf16 v[16:31], a[116:119], a[24:27], v[16:31]
    ds_read_b128 v[76:79], v2 offset:5120
    v_min_u32 v9, v9, v7
    v_min_u32 v10, v10, v7
    v_min_u32 v11, v11, v7
    v_min_u32 v12, v12, v7
    v_min_u32 v13, v13, v7
    s_waitcnt lgkmcnt(4)
    v_mfma_f32_32x32x16_bf16 v[16:31], a[120:123], a[28:31], v[16:31]
    ds_read_b128 a[116:119], v2 offset:6144
    v_min_u32 v14, v14, v7
    v_min_u32 v15, v15, v7
    buffer_store_dwordx4 v[8:11], v1, s[4:7], s24 offen offset:0 sc1
    buffer_store_dwordx4 v[12:15], v1, s[4:7], s24 offen offset:1024 sc1
    s_waitcnt lgkmcnt(4)
    v_mfma_f32_32x32x16_bf16 v[16:31], v[64:67], a[32:35], v[16:31]
    ds_read_b128 a[120:123], v2 offset:7168
    v_mul_f32 v48, v48, v80
    v_mul_f32 v49, v49, v81
    v_mul_f32 v50, v50, v82
    v_mul_f32 v51, v51, v83
    v_mul_f32 v52, v52, v84
    s_waitcnt lgkmcnt(4)
    v_mfma_f32_32x32x16_bf16 v[16:31], v[68:71], a[36:39], v[16:31]
    ds_read_b128 v[64:67], v2 offset:8192
    v_mul_f32 v53, v53, v85
    v_mul_f32 v54, v54, v86
    v_mul_f32 v55, v55, v87
    v_mul_f32 v56, v56, v88
    v_mul_f32 v57, v57, v89
    s_waitcnt lgkmcnt(4)
    v_mfma_f32_32x32x16_bf16 v[16:31], v[72:75], a[40:43], v[16:31]
    ds_read_b128 v[68:71], v2 offset:9216
    v_mul_f32 v58, v58, v90
    v_mul_f32 v59, v59, v91
    v_mul_f32 v60, v60, v92
    v_mul_f32 v61, v61, v93
    v_mul_f32 v62, v62, v94
    s_waitcnt lgkmcnt(4)
    v_mfma_f32_32x32x16_bf16 v[16:31], v[76:79], a[44:47], v[16:31]
    ds_read_b128 v[72:75], v2 offset:10240
    v_mul_f32 v63, v63, v95
    v_cvt_pk_bf16_f32 v32, v48, v49
    v_cvt_pk_bf16_f32 v33, v50, v51
    v_cvt_pk_bf16_f32 v34, v52, v53
    v_cvt_pk_bf16_f32 v35, v54, v55
    s_waitcnt lgkmcnt(4)
    v_mfma_f32_32x32x16_bf16 v[16:31], a[116:119], a[48:51], v[16:31]
    ds_read_b128 v[76:79], v2 offset:11264
    v_cvt_pk_bf16_f32 v36, v56, v57
    v_cvt_pk_bf16_f32 v37, v58, v59
    v_cvt_pk_bf16_f32 v38, v60, v61
    v_cvt_pk_bf16_f32 v39, v62, v63
    v_min_u32 v32, v32, v7
    s_waitcnt lgkmcnt(4)
    v_mfma_f32_32x32x16_bf16 v[16:31], a[120:123], a[52:55], v[16:31]
    ds_read_b128 a[116:119], v2 offset:12288
    v_min_u32 v33, v33, v7
    v_min_u32 v34, v34, v7
    v_min_u32 v35, v35, v7
    v_min_u32 v36, v36, v7
    v_min_u32 v37, v37, v7
    s_waitcnt lgkmcnt(4)
    v_mfma_f32_32x32x16_bf16 v[16:31], v[64:67], a[56:59], v[16:31]
    ds_read_b128 a[120:123], v2 offset:13312
    v_min_u32 v38, v38, v7
    v_min_u32 v39, v39, v7
    s_mov_b32 s40, 0x10000000
    s_mov_b32 s41, 0x10000000
    s_mov_b64 exec, s[40:41]
    v_mov_b32 v32, 0x3f803f80
    v_mov_b32 v33, 0x3f803f80
    v_mov_b32 v34, 0x3f803f80
    v_mov_b32 v35, 0x3f803f80
    v_mov_b32 v36, 0x3f803f80
    v_mov_b32 v37, 0x3f803f80
    v_mov_b32 v38, 0x3f803f80
    v_mov_b32 v39, 0x3f803f80
    s_mov_b64 exec, -1
    buffer_store_dwordx4 v[32:35], v1, s[4:7], s24 offen offset:2048 sc1
    buffer_store_dwordx4 v[36:39], v1, s[4:7], s24 offen offset:3072 sc1
    s_waitcnt lgkmcnt(4)
    v_mfma_f32_32x32x16_bf16 v[16:31], v[68:71], a[60:63], v[16:31]
    ds_read_b128 v[64:67], v2 offset:14336
    ds_write_b128 v6, v[8:11] offset:56320
    ds_write_b128 v6, v[12:15] offset:57344
    ds_write_b128 v6, v[32:35] offset:58368
    ds_write_b128 v6, v[36:39] offset:59392
    s_waitcnt lgkmcnt(8)
    v_mfma_f32_32x32x16_bf16 v[16:31], v[72:75], a[64:67], v[16:31]
    ds_read_b128 v[68:71], v2 offset:15360
    s_waitcnt lgkmcnt(8)
    v_mfma_f32_32x32x16_bf16 v[16:31], v[76:79], a[68:71], v[16:31]
    ds_read_b128 v[72:75], v2 offset:16384
    s_waitcnt lgkmcnt(8)
    v_mfma_f32_32x32x16_bf16 v[16:31], a[116:119], a[72:75], v[16:31]
    ds_read_b128 v[76:79], v2 offset:17408
    s_waitcnt lgkmcnt(8)
    v_mfma_f32_32x32x16_bf16 v[16:31], a[120:123], a[76:79], v[16:31]
    ds_read_b128 a[116:119], v2 offset:18432
    s_waitcnt lgkmcnt(8)
    v_mfma_f32_32x32x16_bf16 v[16:31], v[64:67], a[80:83], v[16:31]
    ds_read_b128 a[120:123], v2 offset:19456
    s_waitcnt lgkmcnt(4)
    v_mfma_f32_32x32x16_bf16 v[16:31], v[68:71], a[84:87], v[16:31]
    ds_read_b128 v[64:67], v2 offset:20480
    s_waitcnt lgkmcnt(4)
    v_mfma_f32_32x32x16_bf16 v[16:31], v[72:75], a[88:91], v[16:31]
    ds_read_b128 v[68:71], v2 offset:21504
    s_waitcnt lgkmcnt(4)
    v_mfma_f32_32x32x16_bf16 v[16:31], v[76:79], a[92:95], v[16:31]
    ds_read_b128 v[72:75], v2 offset:22528
    s_waitcnt lgkmcnt(4)
    v_mfma_f32_32x32x16_bf16 v[16:31], a[116:119], a[96:99], v[16:31]
    s_waitcnt lgkmcnt(3)
    v_mfma_f32_32x32x16_bf16 v[16:31], a[120:123], a[100:103], v[16:31]
    s_waitcnt lgkmcnt(2)
    v_mfma_f32_32x32x16_bf16 v[16:31], v[64:67], a[104:107], v[16:31]
    s_waitcnt lgkmcnt(1)
    v_mfma_f32_32x32x16_bf16 v[16:31], v[68:71], a[108:111], v[16:31]
    s_waitcnt lgkmcnt(0)
    v_mfma_f32_32x32x16_bf16 v[16:31], v[72:75], a[112:115], v[16:31]
    v_mov_b32 v125, 27
    ds_write_b32 v126, v125
    s_lshr_b32 s21, s18, 1
    s_add_u32 s21, s21, s16
    s_lshl_b32 s22, s18, 1
    s_and_b32 s22, s22, 3
    s_max_u32 s23, s21, 2
    s_sub_u32 s23, s23, 2
    s_lshl_b32 s23, s23, 4
    s_add_u32 s23, s23, s17
    s_lshl_b32 s23, s23, 2
    s_add_u32 s23, s23, s22
    s_lshl_b32 s23, s23, 12
    s_add_u32 s23, s23, 12926976
    s_add_u32 s24, s23, 4096
    s_lshl_b32 s31, s20, 2
    s_add_u32 s31, s31, s18
    s_mul_i32 s31, s31, 28672
    s_add_u32 s31, s31, 1425408
    buffer_load_dwordx4 a[0:3], v1, s[4:7], s31 offen offset:0
    buffer_load_dwordx4 a[4:7], v1, s[4:7], s31 offen offset:1024
    buffer_load_dwordx4 a[8:11], v1, s[4:7], s31 offen offset:2048
    buffer_load_dwordx4 a[12:15], v1, s[4:7], s31 offen offset:3072
    s_add_u32 s31, s31, 4096
    buffer_load_dwordx4 a[16:19], v1, s[4:7], s31 offen offset:0
    buffer_load_dwordx4 a[20:23], v1, s[4:7], s31 offen offset:1024
    buffer_load_dwordx4 a[24:27], v1, s[4:7], s31 offen offset:2048
    buffer_load_dwordx4 a[28:31], v1, s[4:7], s31 offen offset:3072
    s_add_u32 s31, s31, 4096
    buffer_load_dwordx4 a[32:35], v1, s[4:7], s31 offen offset:0
    buffer_load_dwordx4 a[36:39], v1, s[4:7], s31 offen offset:1024
    buffer_load_dwordx4 a[40:43], v1, s[4:7], s31 offen offset:2048
    buffer_load_dwordx4 a[44:47], v1, s[4:7], s31 offen offset:3072
    s_add_u32 s31, s31, 4096
    buffer_load_dwordx4 a[48:51], v1, s[4:7], s31 offen offset:0
    buffer_load_dwordx4 a[52:55], v1, s[4:7], s31 offen offset:1024
    buffer_load_dwordx4 a[56:59], v1, s[4:7], s31 offen offset:2048
    buffer_load_dwordx4 a[60:63], v1, s[4:7], s31 offen offset:3072
    s_add_u32 s31, s31, 4096
    buffer_load_dwordx4 a[64:67], v1, s[4:7], s31 offen offset:0
    buffer_load_dwordx4 a[68:71], v1, s[4:7], s31 offen offset:1024
    buffer_load_dwordx4 a[72:75], v1, s[4:7], s31 offen offset:2048
    buffer_load_dwordx4 a[76:79], v1, s[4:7], s31 offen offset:3072
    s_add_u32 s31, s31, 4096
    buffer_load_dwordx4 a[80:83], v1, s[4:7], s31 offen offset:0
    buffer_load_dwordx4 a[84:87], v1, s[4:7], s31 offen offset:1024
    buffer_load_dwordx4 a[88:91], v1, s[4:7], s31 offen offset:2048
    buffer_load_dwordx4 a[92:95], v1, s[4:7], s31 offen offset:3072
    s_add_u32 s31, s31, 4096
    s_cmp_lt_u32 s21, 2
    s_cbranch_scc1 Lskip1125
    buffer_load_dwordx4 v[64:67], v1, s[4:7], s23 offen offset:0 sc1
    buffer_load_dwordx4 v[68:71], v1, s[4:7], s23 offen offset:1024 sc1
    buffer_load_dwordx4 v[72:75], v1, s[4:7], s23 offen offset:2048 sc1
    buffer_load_dwordx4 v[76:79], v1, s[4:7], s23 offen offset:3072 sc1
    buffer_load_dwordx4 v[80:83], v1, s[4:7], s24 offen offset:0 sc1
    buffer_load_dwordx4 v[84:87], v1, s[4:7], s24 offen offset:1024 sc1
    buffer_load_dwordx4 v[88:91], v1, s[4:7], s24 offen offset:2048 sc1
    buffer_load_dwordx4 v[92:95], v1, s[4:7], s24 offen offset:3072 sc1
Lskip1125:
    buffer_load_dwordx4 a[96:99], v1, s[4:7], s31 offen offset:0
    buffer_load_dwordx4 a[100:103], v1, s[4:7], s31 offen offset:1024
    buffer_load_dwordx4 a[104:107], v1, s[4:7], s31 offen offset:2048
    buffer_load_dwordx4 a[108:111], v1, s[4:7], s31 offen offset:3072
    v_mul_f32 v16, v16, v104
    v_mul_f32 v17, v17, v104
    v_mul_f32 v18, v18, v104
    v_mul_f32 v19, v19, v104
    v_mul_f32 v20, v20, v104
    v_mul_f32 v21, v21, v104
    v_mul_f32 v22, v22, v104
    v_mul_f32 v23, v23, v104
    v_mul_f32 v24, v24, v104
    v_mul_f32 v25, v25, v104
    v_mul_f32 v26, v26, v104
    v_mul_f32 v27, v27, v104
    v_mul_f32 v28, v28, v104
    v_mul_f32 v29, v29, v104
    v_mul_f32 v30, v30, v104
    v_mul_f32 v31, v31, v104
    s_mov_b32 s40, 0
    s_mov_b32 s41, -1
    s_mov_b64 exec, s[40:41]
    v_mov_b32 v28, 1.0
    s_mov_b64 exec, -1
    s_waitcnt lgkmcnt(0)
    s_cmp_ge_u32 s21, 2
    s_cbranch_scc1 Lnofill122
    s_waitcnt vmcnt(4)
    v_mov_b32 v64, 0
    v_mov_b32 v65, 0
    v_mov_b32 v66, 0
    v_mov_b32 v67, 0
    v_mov_b32 v68, 0
    v_mov_b32 v69, 0
    v_mov_b32 v70, 0
    v_mov_b32 v71, 0
    v_mov_b32 v72, 0
    v_mov_b32 v73, 0
    v_mov_b32 v74, 0
    v_mov_b32 v75, 0
    v_mov_b32 v76, 0
    v_mov_b32 v77, 0
    v_mov_b32 v78, 0
    v_mov_b32 v79, 0
    v_mov_b32 v80, 0
    v_mov_b32 v81, 0
    v_mov_b32 v82, 0
    v_mov_b32 v83, 0
    v_mov_b32 v84, 0
    v_mov_b32 v85, 0
    v_mov_b32 v86, 0
    v_mov_b32 v87, 0
    v_mov_b32 v88, 0
    v_mov_b32 v89, 0
    v_mov_b32 v90, 0
    v_mov_b32 v91, 0
    v_mov_b32 v92, 0
    v_mov_b32 v93, 0
    v_mov_b32 v94, 0
    v_mov_b32 v95, 0
    s_mov_b32 s40, 0
    s_mov_b32 s41, -1
    s_mov_b64 exec, s[40:41]
    v_mov_b32 v70, 0xce6e
    v_mov_b32 v86, 0xce6e
    s_mov_b64 exec, -1
    s_branch Lnbjoin123
Lnofill122:
    s_nop 2
    s_mov_b32 s25, 200000
    s_waitcnt vmcnt(4)
Lretry124:
    s_nop 0
    v_max3_u32 v4, v64, v65, v66
    v_max3_u32 v5, v67, v68, v69
    v_max3_u32 v4, v4, v70, v71
    v_max3_u32 v5, v5, v72, v73
    v_max3_u32 v4, v4, v74, v75
    v_max3_u32 v5, v5, v76, v77
    v_max3_u32 v4, v4, v78, v79
    v_max3_u32 v5, v5, v80, v81
    v_max3_u32 v4, v4, v82, v83
    v_max3_u32 v5, v5, v84, v85
    v_max3_u32 v4, v4, v86, v87
    v_max3_u32 v5, v5, v88, v89
    v_max3_u32 v4, v4, v90, v91
    v_max3_u32 v5, v5, v92, v93
    v_max3_u32 v4, v4, v94, v95
    v_max_u32 v4, v4, v5
    v_cmp_eq_u32 vcc, -1, v4
    s_nop 1
    s_cbranch_vccz Lnbjoin123
    s_sub_u32 s25, s25, 1
    s_cmp_eq_u32 s25, 0
    s_cbranch_scc1 Lnbjoin123
    buffer_load_dwordx4 v[64:67], v1, s[4:7], s23 offen offset:0 sc1
    buffer_load_dwordx4 v[68:71], v1, s[4:7], s23 offen offset:1024 sc1
    buffer_load_dwordx4 v[72:75], v1, s[4:7], s23 offen offset:2048 sc1
    buffer_load_dwordx4 v[76:79], v1, s[4:7], s23 offen offset:3072 sc1
    buffer_load_dwordx4 v[80:83], v1, s[4:7], s24 offen offset:0 sc1
    buffer_load_dwordx4 v[84:87], v1, s[4:7], s24 offen offset:1024 sc1
    buffer_load_dwordx4 v[88:91], v1, s[4:7], s24 offen offset:2048 sc1
    buffer_load_dwordx4 v[92:95], v1, s[4:7], s24 offen offset:3072 sc1
    s_waitcnt vmcnt(0)
    s_branch Lretry124
Lnbjoin123:
    s_nop 0
    s_lshl_b32 s22, s18, 13
    v_add_u32 v6, s22, v2
    ds_write_b128 v6, v[64:67] offset:23552
    ds_write_b128 v6, v[68:71] offset:24576
    ds_write_b128 v6, v[72:75] offset:25600
    ds_write_b128 v6, v[76:79] offset:26624
    ds_write_b128 v6, v[80:83] offset:27648
    ds_write_b128 v6, v[84:87] offset:28672
    ds_write_b128 v6, v[88:91] offset:29696
    ds_write_b128 v6, v[92:95] offset:30720
    v_mov_b32 v125, 28
    ds_write_b32 v126, v125
    s_lshl_b32 s21, s20, 2
    s_add_u32 s21, s21, s18
    s_mul_i32 s21, s21, 28672
    s_add_u32 s21, s21, 1425408
    v_cvt_pk_bf16_f32 v8, v16, v17
    v_cvt_pk_bf16_f32 v9, v18, v19
    v_cvt_pk_bf16_f32 v10, v20, v21
    v_cvt_pk_bf16_f32 v11, v22, v23
    v_cvt_pk_bf16_f32 v12, v24, v25
    v_cvt_pk_bf16_f32 v13, v26, v27
    v_cvt_pk_bf16_f32 v14, v28, v29
    v_cvt_pk_bf16_f32 v15, v30, v31
    v_and_b32 v4, 31, v0
    v_lshrrev_b32 v5, 5, v0
    v_lshlrev_b32 v5, 2, v5
    v_sub_u32 v4, v4, v5
    v_mov_b32 v5, 0
    v_mov_b32 v7, 0xce6e6b28
    v_cmp_gt_i32 vcc, 0, v4
    v_cmp_gt_i32 s[40:41], 1, v4
    s_nop 0
    v_cndmask_b32 v32, v7, v5, vcc
    v_cndmask_b32 v48, v5, v7, vcc
    v_cndmask_b32 v33, v7, v5, s[40:41]
    v_cndmask_b32 v49, v5, v7, s[40:41]
    v_cmp_gt_i32 vcc, 2, v4
    v_cmp_gt_i32 s[40:41], 3, v4
    s_nop 0
    v_cndmask_b32 v34, v7, v5, vcc
    v_cndmask_b32 v50, v5, v7, vcc
    v_cndmask_b32 v35, v7, v5, s[40:41]
    v_cndmask_b32 v51, v5, v7, s[40:41]
    v_cmp_gt_i32 vcc, 8, v4
    v_cmp_gt_i32 s[40:41], 9, v4
    s_nop 0
    v_cndmask_b32 v36, v7, v5, vcc
    v_cndmask_b32 v52, v5, v7, vcc
    v_cndmask_b32 v37, v7, v5, s[40:41]
    v_cndmask_b32 v53, v5, v7, s[40:41]
    v_cmp_gt_i32 vcc, 10, v4
    v_cmp_gt_i32 s[40:41], 11, v4
    s_nop 0
    v_cndmask_b32 v38, v7, v5, vcc
    v_cndmask_b32 v54, v5, v7, vcc
    v_cndmask_b32 v39, v7, v5, s[40:41]
    v_cndmask_b32 v55, v5, v7, s[40:41]
    v_cmp_gt_i32 vcc, 16, v4
    v_cmp_gt_i32 s[40:41], 17, v4
    s_nop 0
    v_cndmask_b32 v40, v7, v5, vcc
    v_cndmask_b32 v56, v5, v7, vcc
    v_cndmask_b32 v41, v7, v5, s[40:41]
    v_cndmask_b32 v57, v5, v7, s[40:41]
    v_cmp_gt_i32 vcc, 18, v4
    v_cmp_gt_i32 s[40:41], 19, v4
    s_nop 0
    v_cndmask_b32 v42, v7, v5, vcc
    v_cndmask_b32 v58, v5, v7, vcc
    v_cndmask_b32 v43, v7, v5, s[40:41]
    v_cndmask_b32 v59, v5, v7, s[40:41]
    v_cmp_gt_i32 vcc, 24, v4
    v_cmp_gt_i32 s[40:41], 25, v4
    s_nop 0
    v_cndmask_b32 v44, v7, v5, vcc
    v_cndmask_b32 v60, v5, v7, vcc
    v_cndmask_b32 v45, v7, v5, s[40:41]
    v_cndmask_b32 v61, v5, v7, s[40:41]
    v_cmp_gt_i32 vcc, 26, v4
    v_cmp_gt_i32 s[40:41], 27, v4
    s_nop 0
    v_cndmask_b32 v46, v7, v5, vcc
    v_cndmask_b32 v62, v5, v7, vcc
    v_cndmask_b32 v47, v7, v5, s[40:41]
    v_cndmask_b32 v63, v5, v7, s[40:41]
    s_lshl_b32 s22, s18, 12
    v_add_u32 v6, s22, v2
    v_mov_b32 v116, 148992
    ds_read_b128 v[116:119], v116
    s_waitcnt lgkmcnt(0)
    v_min3_u32 v116, v116, v117, v118
    v_min_u32 v116, v116, v119
    v_cmp_gt_u32 vcc, 28, v116
    s_nop 1
    s_cbranch_vccz Lc126d
    s_nop 1
    s_mov_b32 s25, 2000000
Lc126:
    s_nop 0
    s_sleep 1
    v_mov_b32 v116, 148992
    ds_read_b128 v[116:119], v116
    s_waitcnt lgkmcnt(0)
    v_min3_u32 v116, v116, v117, v118
    v_min_u32 v116, v116, v119
    v_cmp_gt_u32 vcc, 28, v116
    s_nop 1
    s_cbranch_vccz Lc126d
    s_sub_u32 s25, s25, 1
    s_cmp_lg_u32 s25, 0
    s_cbranch_scc1 Lc126
    s_nop 0
Lc126d:
    ds_read_b128 v[96:99], v6 offset:27648
    ds_read_b128 v[100:103], v6 offset:28672
    v_mov_b32 v4, 0xff61b1e6
    v_mov_b32 v5, 0xff61b1e6
    s_waitcnt lgkmcnt(1)
    v_mfma_f32_32x32x16_bf16 v[64:79], v[96:99], v[8:11], 0
    ds_read_b128 v[104:107], v6 offset:31744
    s_waitcnt lgkmcnt(1)
    v_mfma_f32_32x32x16_bf16 v[64:79], v[100:103], v[12:15], v[64:79]
    ds_read_b128 v[96:99], v6 offset:32768
    s_waitcnt lgkmcnt(1)
    v_mfma_f32_32x32x16_bf16 v[80:95], v[104:107], v[8:11], 0
    ds_read_b128 v[100:103], v6 offset:35840
    s_waitcnt lgkmcnt(1)
    v_mfma_f32_32x32x16_bf16 v[80:95], v[96:99], v[12:15], v[80:95]
    ds_read_b128 v[104:107], v6 offset:36864
    s_nop 4
    v_max3_f32 v4, v4, v64, v65
    v_max3_f32 v5, v5, v66, v67
    v_max3_f32 v4, v4, v68, v69
    v_max3_f32 v5, v5, v70, v71
    v_max3_f32 v4, v4, v72, v73
    v_max3_f32 v5, v5, v74, v75
    v_max3_f32 v4, v4, v76, v77
    v_max3_f32 v5, v5, v78, v79
    s_waitcnt lgkmcnt(1)
    v_mfma_f32_32x32x16_bf16 v[64:79], v[100:103], v[8:11], 0
    ds_read_b128 v[96:99], v6 offset:39936
    s_waitcnt lgkmcnt(1)
    v_mfma_f32_32x32x16_bf16 v[64:79], v[104:107], v[12:15], v[64:79]
    ds_read_b128 v[100:103], v6 offset:40960
    v_max3_f32 v4, v4, v80, v81
    v_max3_f32 v5, v5, v82, v83
    v_max3_f32 v4, v4, v84, v85
    v_max3_f32 v5, v5, v86, v87
    v_max3_f32 v4, v4, v88, v89
    v_max3_f32 v5, v5, v90, v91
    v_max3_f32 v4, v4, v92, v93
    v_max3_f32 v5, v5, v94, v95
    s_waitcnt lgkmcnt(1)
    v_mfma_f32_32x32x16_bf16 v[80:95], v[96:99], v[8:11], 0
    ds_read_b128 v[104:107], v6 offset:44032
    s_waitcnt lgkmcnt(1)
    v_mfma_f32_32x32x16_bf16 v[80:95], v[100:103], v[12:15], v[80:95]
    ds_read_b128 v[96:99], v6 offset:45056
    v_max3_f32 v4, v4, v64, v65
    v_max3_f32 v5, v5, v66, v67
    v_max3_f32 v4, v4, v68, v69
    v_max3_f32 v5, v5, v70, v71
    v_max3_f32 v4, v4, v72, v73
    v_max3_f32 v5, v5, v74, v75
    v_max3_f32 v4, v4, v76, v77
    v_max3_f32 v5, v5, v78, v79
    s_waitcnt lgkmcnt(1)
    v_mfma_f32_32x32x16_bf16 v[64:79], v[104:107], v[8:11], 0
    ds_read_b128 v[100:103], v6 offset:48128
    s_waitcnt lgkmcnt(1)
    v_mfma_f32_32x32x16_bf16 v[64:79], v[96:99], v[12:15], v[64:79]
    ds_read_b128 v[104:107], v6 offset:49152
    v_max3_f32 v4, v4, v80, v81
    v_max3_f32 v5, v5, v82, v83
    v_max3_f32 v4, v4, v84, v85
    v_max3_f32 v5, v5, v86, v87
    v_max3_f32 v4, v4, v88, v89
    v_max3_f32 v5, v5, v90, v91
    v_max3_f32 v4, v4, v92, v93
    v_max3_f32 v5, v5, v94, v95
    s_waitcnt lgkmcnt(1)
    v_mfma_f32_32x32x16_bf16 v[80:95], v[100:103], v[8:11], 0
    ds_read_b128 v[96:99], v6 offset:52224
    s_waitcnt lgkmcnt(1)
    v_mfma_f32_32x32x16_bf16 v[80:95], v[104:107], v[12:15], v[80:95]
    ds_read_b128 v[100:103], v6 offset:53248
    v_max3_f32 v4, v4, v64, v65
    v_max3_f32 v5, v5, v66, v67
    v_max3_f32 v4, v4, v68, v69
    v_max3_f32 v5, v5, v70, v71
    v_max3_f32 v4, v4, v72, v73
    v_max3_f32 v5, v5, v74, v75
    v_max3_f32 v4, v4, v76, v77
    v_max3_f32 v5, v5, v78, v79
    s_waitcnt lgkmcnt(1)
    v_mfma_f32_32x32x16_bf16 v[64:79], v[96:99], v[8:11], 0
    ds_read_b128 v[104:107], v6 offset:23552
    s_waitcnt lgkmcnt(1)
    v_mfma_f32_32x32x16_bf16 v[64:79], v[100:103], v[12:15], v[64:79]
    ds_read_b128 v[96:99], v6 offset:24576
    v_max3_f32 v4, v4, v80, v81
    v_max3_f32 v5, v5, v82, v83
    v_max3_f32 v4, v4, v84, v85
    v_max3_f32 v5, v5, v86, v87
    v_max3_f32 v4, v4, v88, v89
    v_max3_f32 v5, v5, v90, v91
    v_max3_f32 v4, v4, v92, v93
    v_max3_f32 v5, v5, v94, v95
    s_waitcnt lgkmcnt(1)
    v_mfma_f32_32x32x16_bf16 v[32:47], v[104:107], v[8:11], v[32:47]
    ds_read_b128 v[100:103], v6 offset:56320
    s_waitcnt lgkmcnt(1)
    v_mfma_f32_32x32x16_bf16 v[32:47], v[96:99], v[12:15], v[32:47]
    ds_read_b128 v[104:107], v6 offset:57344
    v_max3_f32 v4, v4, v64, v65
    v_max3_f32 v5, v5, v66, v67
    v_max3_f32 v4, v4, v68, v69
    v_max3_f32 v5, v5, v70, v71
    v_max3_f32 v4, v4, v72, v73
    v_max3_f32 v5, v5, v74, v75
    v_max3_f32 v4, v4, v76, v77
    v_max3_f32 v5, v5, v78, v79
    s_waitcnt lgkmcnt(1)
    v_mfma_f32_32x32x16_bf16 v[48:63], v[100:103], v[8:11], v[48:63]
    s_waitcnt lgkmcnt(0)
    v_mfma_f32_32x32x16_bf16 v[48:63], v[104:107], v[12:15], v[48:63]
    v_max3_f32 v4, v4, v32, v33
    v_max3_f32 v5, v5, v34, v35
    v_max3_f32 v4, v4, v36, v37
    v_max3_f32 v5, v5, v38, v39
    v_max3_f32 v4, v4, v40, v41
    v_max3_f32 v5, v5, v42, v43
    v_max3_f32 v4, v4, v44, v45
    v_max3_f32 v5, v5, v46, v47
    s_nop 3
    v_max3_f32 v4, v4, v48, v49
    v_max3_f32 v5, v5, v50, v51
    v_max3_f32 v4, v4, v52, v53
    v_max3_f32 v5, v5, v54, v55
    v_max3_f32 v4, v4, v56, v57
    v_max3_f32 v5, v5, v58, v59
    v_max3_f32 v4, v4, v60, v61
    v_max3_f32 v5, v5, v62, v63
    v_max_f32 v4, v4, v5
    v_mov_b32 v5, v4
    s_nop 1
    v_permlane32_swap_b32 v4, v5
    v_max_f32 v4, v4, v5
    s_mov_b32 s30, 0x3e8b97f6
    v_mul_f32 v4, s30, v4
    ds_read_b128 v[96:99], v6 offset:25600
    ds_read_b128 v[100:103], v6 offset:26624
    v_fma_f32 v32, v32, s30, -v4
    v_fma_f32 v33, v33, s30, -v4
    v_exp_f32 v32, v32
    v_fma_f32 v34, v34, s30, -v4
    v_exp_f32 v33, v33
    v_fma_f32 v35, v35, s30, -v4
    v_exp_f32 v34, v34
    v_fma_f32 v36, v36, s30, -v4
    v_exp_f32 v35, v35
    v_fma_f32 v37, v37, s30, -v4
    v_exp_f32 v36, v36
    v_fma_f32 v38, v38, s30, -v4
    v_exp_f32 v37, v37
    v_fma_f32 v39, v39, s30, -v4
    v_exp_f32 v38, v38
    v_fma_f32 v40, v40, s30, -v4
    v_exp_f32 v39, v39
    v_fma_f32 v41, v41, s30, -v4
    v_exp_f32 v40, v40
    v_fma_f32 v42, v42, s30, -v4
    v_exp_f32 v41, v41
    v_fma_f32 v43, v43, s30, -v4
    v_exp_f32 v42, v42
    v_fma_f32 v44, v44, s30, -v4
    v_exp_f32 v43, v43
    v_fma_f32 v45, v45, s30, -v4
    v_exp_f32 v44, v44
    v_fma_f32 v46, v46, s30, -v4
    v_exp_f32 v45, v45
    v_fma_f32 v47, v47, s30, -v4
    v_exp_f32 v46, v46
    v_exp_f32 v47, v47
    v_cvt_pk_bf16_f32 v32, v32, v33
    v_cvt_pk_bf16_f32 v33, v34, v35
    v_cvt_pk_bf16_f32 v34, v36, v37
    v_cvt_pk_bf16_f32 v35, v38, v39
    v_cvt_pk_bf16_f32 v36, v40, v41
    v_cvt_pk_bf16_f32 v37, v42, v43
    v_cvt_pk_bf16_f32 v38, v44, v45
    v_cvt_pk_bf16_f32 v39, v46, v47
    v_fma_f32 v48, v48, s30, -v4
    v_fma_f32 v49, v49, s30, -v4
    v_exp_f32 v48, v48
    v_fma_f32 v50, v50, s30, -v4
    v_exp_f32 v49, v49
    v_fma_f32 v51, v51, s30, -v4
    v_exp_f32 v50, v50
    v_fma_f32 v52, v52, s30, -v4
    s_waitcnt lgkmcnt(1)
    v_mfma_f32_32x32x16_bf16 v[16:31], v[96:99], v[32:35], 0
    ds_read_b128 v[104:107], v6 offset:27648
    v_exp_f32 v51, v51
    v_fma_f32 v53, v53, s30, -v4
    v_exp_f32 v52, v52
    v_fma_f32 v54, v54, s30, -v4
    v_exp_f32 v53, v53
    v_fma_f32 v55, v55, s30, -v4
    v_exp_f32 v54, v54
    v_fma_f32 v56, v56, s30, -v4
    s_waitcnt lgkmcnt(1)
    v_mfma_f32_32x32x16_bf16 v[16:31], v[100:103], v[36:39], v[16:31]
    ds_read_b128 v[96:99], v6 offset:28672
    v_exp_f32 v55, v55
    v_fma_f32 v57, v57, s30, -v4
    v_exp_f32 v56, v56
    v_fma_f32 v58, v58, s30, -v4
    v_exp_f32 v57, v57
    v_fma_f32 v59, v59, s30, -v4
    v_exp_f32 v58, v58
    v_fma_f32 v60, v60, s30, -v4
    s_waitcnt lgkmcnt(1)
    v_mfma_f32_32x32x16_bf16 v[32:47], v[104:107], v[8:11], 0
    ds_read_b128 v[100:103], v6 offset:58368
    v_exp_f32 v59, v59
    v_fma_f32 v61, v61, s30, -v4
    v_exp_f32 v60, v60
    v_fma_f32 v62, v62, s30, -v4
    v_exp_f32 v61, v61
    v_fma_f32 v63, v63, s30, -v4
    v_exp_f32 v62, v62
    v_exp_f32 v63, v63
    s_waitcnt lgkmcnt(1)
    v_mfma_f32_32x32x16_bf16 v[32:47], v[96:99], v[12:15], v[32:47]
    ds_read_b128 v[104:107], v6 offset:59392
    v_cvt_pk_bf16_f32 v48, v48, v49
    v_cvt_pk_bf16_f32 v49, v50, v51
    v_cvt_pk_bf16_f32 v50, v52, v53
    v_cvt_pk_bf16_f32 v51, v54, v55
    v_cvt_pk_bf16_f32 v52, v56, v57
    v_cvt_pk_bf16_f32 v53, v58, v59
    v_cvt_pk_bf16_f32 v54, v60, v61
    v_cvt_pk_bf16_f32 v55, v62, v63
    v_fma_f32 v64, v64, s30, -v4
    v_fma_f32 v65, v65, s30, -v4
    v_exp_f32 v64, v64
    v_fma_f32 v66, v66, s30, -v4
    v_exp_f32 v65, v65
    v_fma_f32 v67, v67, s30, -v4
    v_exp_f32 v66, v66
    v_fma_f32 v68, v68, s30, -v4
    s_waitcnt lgkmcnt(1)
    v_mfma_f32_32x32x16_bf16 v[16:31], v[100:103], v[48:51], v[16:31]
    ds_read_b128 v[96:99], v6 offset:31744
    v_exp_f32 v67, v67
    v_fma_f32 v69, v69, s30, -v4
    v_exp_f32 v68, v68
    v_fma_f32 v70, v70, s30, -v4
    v_exp_f32 v69, v69
    v_fma_f32 v71, v71, s30, -v4
    v_exp_f32 v70, v70
    v_fma_f32 v72, v72, s30, -v4
    s_waitcnt lgkmcnt(1)
    v_mfma_f32_32x32x16_bf16 v[16:31], v[104:107], v[52:55], v[16:31]
    ds_read_b128 v[100:103], v6 offset:32768
    v_exp_f32 v71, v71
    v_fma_f32 v73, v73, s30, -v4
    v_exp_f32 v72, v72
    v_fma_f32 v74, v74, s30, -v4
    v_exp_f32 v73, v73
    v_fma_f32 v75, v75, s30, -v4
    v_exp_f32 v74, v74
    v_fma_f32 v76, v76, s30, -v4
    s_waitcnt lgkmcnt(1)
    v_mfma_f32_32x32x16_bf16 v[48:63], v[96:99], v[8:11], 0
    ds_read_b128 v[104:107], v6 offset:54272
    v_exp_f32 v75, v75
    v_fma_f32 v77, v77, s30, -v4
    v_exp_f32 v76, v76
    v_fma_f32 v78, v78, s30, -v4
    v_exp_f32 v77, v77
    v_fma_f32 v79, v79, s30, -v4
    v_exp_f32 v78, v78
    v_exp_f32 v79, v79
    s_waitcnt lgkmcnt(1)
    v_mfma_f32_32x32x16_bf16 v[48:63], v[100:103], v[12:15], v[48:63]
    ds_read_b128 v[96:99], v6 offset:55296
    v_cvt_pk_bf16_f32 v64, v64, v65
    v_cvt_pk_bf16_f32 v65, v66, v67
    v_cvt_pk_bf16_f32 v66, v68, v69
    v_cvt_pk_bf16_f32 v67, v70, v71
    v_cvt_pk_bf16_f32 v68, v72, v73
    v_cvt_pk_bf16_f32 v69, v74, v75
    v_cvt_pk_bf16_f32 v70, v76, v77
    v_cvt_pk_bf16_f32 v71, v78, v79
    v_fma_f32 v80, v80, s30, -v4
    v_fma_f32 v81, v81, s30, -v4
    v_exp_f32 v80, v80
    v_fma_f32 v82, v82, s30, -v4
    v_exp_f32 v81, v81
    v_fma_f32 v83, v83, s30, -v4
    v_exp_f32 v82, v82
    v_fma_f32 v84, v84, s30, -v4
    s_waitcnt lgkmcnt(1)
    v_mfma_f32_32x32x16_bf16 v[16:31], v[104:107], v[64:67], v[16:31]
    ds_read_b128 v[100:103], v6 offset:35840
    v_exp_f32 v83, v83
    v_fma_f32 v85, v85, s30, -v4
    v_exp_f32 v84, v84
    v_fma_f32 v86, v86, s30, -v4
    v_exp_f32 v85, v85
    v_fma_f32 v87, v87, s30, -v4
    v_exp_f32 v86, v86
    v_fma_f32 v88, v88, s30, -v4
    s_waitcnt lgkmcnt(1)
    v_mfma_f32_32x32x16_bf16 v[16:31], v[96:99], v[68:71], v[16:31]
    ds_read_b128 v[104:107], v6 offset:36864
    v_exp_f32 v87, v87
    v_fma_f32 v89, v89, s30, -v4
    v_exp_f32 v88, v88
    v_fma_f32 v90, v90, s30, -v4
    v_exp_f32 v89, v89
    v_fma_f32 v91, v91, s30, -v4
    v_exp_f32 v90, v90
    v_fma_f32 v92, v92, s30, -v4
    s_waitcnt lgkmcnt(1)
    v_mfma_f32_32x32x16_bf16 v[64:79], v[100:103], v[8:11], 0
    ds_read_b128 v[96:99], v6 offset:50176
    v_exp_f32 v91, v91
    v_fma_f32 v93, v93, s30, -v4
    v_exp_f32 v92, v92
    v_fma_f32 v94, v94, s30, -v4
    v_exp_f32 v93, v93
    v_fma_f32 v95, v95, s30, -v4
    v_exp_f32 v94, v94
    v_exp_f32 v95, v95
    s_waitcnt lgkmcnt(1)
    v_mfma_f32_32x32x16_bf16 v[64:79], v[104:107], v[12:15], v[64:79]
    ds_read_b128 v[100:103], v6 offset:51200
    v_cvt_pk_bf16_f32 v80, v80, v81
    v_cvt_pk_bf16_f32 v81, v82, v83
    v_cvt_pk_bf16_f32 v82, v84, v85
    v_cvt_pk_bf16_f32 v83, v86, v87
    v_cvt_pk_bf16_f32 v84, v88, v89
    v_cvt_pk_bf16_f32 v85, v90, v91
    v_cvt_pk_bf16_f32 v86, v92, v93
    v_cvt_pk_bf16_f32 v87, v94, v95
    v_fma_f32 v32, v32, s30, -v4
    v_fma_f32 v33, v33, s30, -v4
    v_exp_f32 v32, v32
    v_fma_f32 v34, v34, s30, -v4
    v_exp_f32 v33, v33
    v_fma_f32 v35, v35, s30, -v4
    v_exp_f32 v34, v34
    v_fma_f32 v36, v36, s30, -v4
    s_waitcnt lgkmcnt(1)
    v_mfma_f32_32x32x16_bf16 v[16:31], v[96:99], v[80:83], v[16:31]
    ds_read_b128 v[104:107], v6 offset:39936
    v_exp_f32 v35, v35
    v_fma_f32 v37, v37, s30, -v4
    v_exp_f32 v36, v36
    v_fma_f32 v38, v38, s30, -v4
    v_exp_f32 v37, v37
    v_fma_f32 v39, v39, s30, -v4
    v_exp_f32 v38, v38
    v_fma_f32 v40, v40, s30, -v4
    s_waitcnt lgkmcnt(1)
    v_mfma_f32_32x32x16_bf16 v[16:31], v[100:103], v[84:87], v[16:31]
    ds_read_b128 v[96:99], v6 offset:40960
    v_exp_f32 v39, v39
    v_fma_f32 v41, v41, s30, -v4
    v_exp_f32 v40, v40
    v_fma_f32 v42, v42, s30, -v4
    v_exp_f32 v41, v41
    v_fma_f32 v43, v43, s30, -v4
    v_exp_f32 v42, v42
    v_fma_f32 v44, v44, s30, -v4
    s_waitcnt lgkmcnt(1)
    v_mfma_f32_32x32x16_bf16 v[80:95], v[104:107], v[8:11], 0
    ds_read_b128 v[100:103], v6 offset:29696
    v_exp_f32 v43, v43
    v_fma_f32 v45, v45, s30, -v4
    v_exp_f32 v44, v44
    v_fma_f32 v46, v46, s30, -v4
    v_exp_f32 v45, v45
    v_fma_f32 v47, v47, s30, -v4
    v_exp_f32 v46, v46
    v_exp_f32 v47, v47
    s_waitcnt lgkmcnt(1)
    v_mfma_f32_32x32x16_bf16 v[80:95], v[96:99], v[12:15], v[80:95]
    ds_read_b128 v[104:107], v6 offset:30720
    v_cvt_pk_bf16_f32 v32, v32, v33
    v_cvt_pk_bf16_f32 v33, v34, v35
    v_cvt_pk_bf16_f32 v34, v36, v37
    v_cvt_pk_bf16_f32 v35, v38, v39
    v_cvt_pk_bf16_f32 v36, v40, v41
    v_cvt_pk_bf16_f32 v37, v42, v43
    v_cvt_pk_bf16_f32 v38, v44, v45
    v_cvt_pk_bf16_f32 v39, v46, v47
    v_fma_f32 v48, v48, s30, -v4
    v_fma_f32 v49, v49, s30, -v4
    v_exp_f32 v48, v48
    v_fma_f32 v50, v50, s30, -v4
    v_exp_f32 v49, v49
    v_fma_f32 v51, v51, s30, -v4
    v_exp_f32 v50, v50
    v_fma_f32 v52, v52, s30, -v4
    s_waitcnt lgkmcnt(1)
    v_mfma_f32_32x32x16_bf16 v[16:31], v[100:103], v[32:35], v[16:31]
    ds_read_b128 v[96:99], v6 offset:44032
    v_exp_f32 v51, v51
    v_fma_f32 v53, v53, s30, -v4
    v_exp_f32 v52, v52
    v_fma_f32 v54, v54, s30, -v4
    v_exp_f32 v53, v53
    v_fma_f32 v55, v55, s30, -v4
    v_exp_f32 v54, v54
    v_fma_f32 v56, v56, s30, -v4
    s_waitcnt lgkmcnt(1)
    v_mfma_f32_32x32x16_bf16 v[16:31], v[104:107], v[36:39], v[16:31]
    ds_read_b128 v[100:103], v6 offset:45056
    v_exp_f32 v55, v55
    v_fma_f32 v57, v57, s30, -v4
    v_exp_f32 v56, v56
    v_fma_f32 v58, v58, s30, -v4
    v_exp_f32 v57, v57
    v_fma_f32 v59, v59, s30, -v4
    v_exp_f32 v58, v58
    v_fma_f32 v60, v60, s30, -v4
    s_waitcnt lgkmcnt(1)
    v_mfma_f32_32x32x16_bf16 v[32:47], v[96:99], v[8:11], 0
    ds_read_b128 v[104:107], v6 offset:33792
    v_exp_f32 v59, v59
    v_fma_f32 v61, v61, s30, -v4
    v_exp_f32 v60, v60
    v_fma_f32 v62, v62, s30, -v4
    v_exp_f32 v61, v61
    v_fma_f32 v63, v63, s30, -v4
    v_exp_f32 v62, v62
    v_exp_f32 v63, v63
    s_waitcnt lgkmcnt(1)
    v_mfma_f32_32x32x16_bf16 v[32:47], v[100:103], v[12:15], v[32:47]
    ds_read_b128 v[96:99], v6 offset:34816
    v_cvt_pk_bf16_f32 v48, v48, v49
    v_cvt_pk_bf16_f32 v49, v50, v51
    v_cvt_pk_bf16_f32 v50, v52, v53
    v_cvt_pk_bf16_f32 v51, v54, v55
    v_cvt_pk_bf16_f32 v52, v56, v57
    v_cvt_pk_bf16_f32 v53, v58, v59
    v_cvt_pk_bf16_f32 v54, v60, v61
    v_cvt_pk_bf16_f32 v55, v62, v63
    v_fma_f32 v64, v64, s30, -v4
    v_fma_f32 v65, v65, s30, -v4
    v_exp_f32 v64, v64
    v_fma_f32 v66, v66, s30, -v4
    v_exp_f32 v65, v65
    v_fma_f32 v67, v67, s30, -v4
    v_exp_f32 v66, v66
    v_fma_f32 v68, v68, s30, -v4
    v_exp_f32 v67, v67
    v_fma_f32 v69, v69, s30, -v4
    v_exp_f32 v68, v68
    v_fma_f32 v70, v70, s30, -v4
    v_exp_f32 v69, v69
    s_waitcnt lgkmcnt(1)
    v_mfma_f32_32x32x16_bf16 v[16:31], v[104:107], v[48:51], v[16:31]
    ds_read_b128 v[100:103], v6 offset:37888
    v_fma_f32 v71, v71, s30, -v4
    v_exp_f32 v70, v70
    v_fma_f32 v72, v72, s30, -v4
    v_exp_f32 v71, v71
    v_fma_f32 v73, v73, s30, -v4
    v_exp_f32 v72, v72
    v_fma_f32 v74, v74, s30, -v4
    v_exp_f32 v73, v73
    v_fma_f32 v75, v75, s30, -v4
    v_exp_f32 v74, v74
    v_fma_f32 v76, v76, s30, -v4
    v_exp_f32 v75, v75
    v_fma_f32 v77, v77, s30, -v4
    s_waitcnt lgkmcnt(1)
    v_mfma_f32_32x32x16_bf16 v[16:31], v[96:99], v[52:55], v[16:31]
    ds_read_b128 v[104:107], v6 offset:38912
    v_exp_f32 v76, v76
    v_fma_f32 v78, v78, s30, -v4
    v_exp_f32 v77, v77
    v_fma_f32 v79, v79, s30, -v4
    v_exp_f32 v78, v78
    v_exp_f32 v79, v79
    v_cvt_pk_bf16_f32 v64, v64, v65
    v_cvt_pk_bf16_f32 v65, v66, v67
    v_cvt_pk_bf16_f32 v66, v68, v69
    v_cvt_pk_bf16_f32 v67, v70, v71
    v_cvt_pk_bf16_f32 v68, v72, v73
    v_cvt_pk_bf16_f32 v69, v74, v75
    v_cvt_pk_bf16_f32 v70, v76, v77
    v_cvt_pk_bf16_f32 v71, v78, v79
    v_fma_f32 v80, v80, s30, -v4
    v_fma_f32 v81, v81, s30, -v4
    v_exp_f32 v80, v80
    v_fma_f32 v82, v82, s30, -v4
    v_exp_f32 v81, v81
    v_fma_f32 v83, v83, s30, -v4
    v_exp_f32 v82, v82
    v_fma_f32 v84, v84, s30, -v4
    v_exp_f32 v83, v83
    v_fma_f32 v85, v85, s30, -v4
    v_exp_f32 v84, v84
    v_fma_f32 v86, v86, s30, -v4
    v_exp_f32 v85, v85
    s_waitcnt lgkmcnt(1)
    v_mfma_f32_32x32x16_bf16 v[16:31], v[100:103], v[64:67], v[16:31]
    ds_read_b128 v[96:99], v6 offset:41984
    v_fma_f32 v87, v87, s30, -v4
    v_exp_f32 v86, v86
    v_fma_f32 v88, v88, s30, -v4
    v_exp_f32 v87, v87
    v_fma_f32 v89, v89, s30, -v4
    v_exp_f32 v88, v88
    v_fma_f32 v90, v90, s30, -v4
    v_exp_f32 v89, v89
    v_fma_f32 v91, v91, s30, -v4
    v_exp_f32 v90, v90
    v_fma_f32 v92, v92, s30, -v4
    v_exp_f32 v91, v91
    v_fma_f32 v93, v93, s30, -v4
    s_waitcnt lgkmcnt(1)
    v_mfma_f32_32x32x16_bf16 v[16:31], v[104:107], v[68:71], v[16:31]
    ds_read_b128 v[100:103], v6 offset:43008
    v_exp_f32 v92, v92
    v_fma_f32 v94, v94, s30, -v4
    v_exp_f32 v93, v93
    v_fma_f32 v95, v95, s30, -v4
    v_exp_f32 v94, v94
    v_exp_f32 v95, v95
    v_cvt_pk_bf16_f32 v80, v80, v81
    v_cvt_pk_bf16_f32 v81, v82, v83
    v_cvt_pk_bf16_f32 v82, v84, v85
    v_cvt_pk_bf16_f32 v83, v86, v87
    v_cvt_pk_bf16_f32 v84, v88, v89
    v_cvt_pk_bf16_f32 v85, v90, v91
    v_cvt_pk_bf16_f32 v86, v92, v93
    v_cvt_pk_bf16_f32 v87, v94, v95
    v_fma_f32 v32, v32, s30, -v4
    v_fma_f32 v33, v33, s30, -v4
    v_exp_f32 v32, v32
    v_fma_f32 v34, v34, s30, -v4
    v_exp_f32 v33, v33
    v_fma_f32 v35, v35, s30, -v4
    v_exp_f32 v34, v34
    v_fma_f32 v36, v36, s30, -v4
    v_exp_f32 v35, v35
    v_fma_f32 v37, v37, s30, -v4
    v_exp_f32 v36, v36
    v_fma_f32 v38, v38, s30, -v4
    v_exp_f32 v37, v37
    s_waitcnt lgkmcnt(1)
    v_mfma_f32_32x32x16_bf16 v[16:31], v[96:99], v[80:83], v[16:31]
    ds_read_b128 v[104:107], v6 offset:46080
    v_fma_f32 v39, v39, s30, -v4
    v_exp_f32 v38, v38
    v_fma_f32 v40, v40, s30, -v4
    v_exp_f32 v39, v39
    v_fma_f32 v41, v41, s30, -v4
    v_exp_f32 v40, v40
    v_fma_f32 v42, v42, s30, -v4
    v_exp_f32 v41, v41
    v_fma_f32 v43, v43, s30, -v4
    v_exp_f32 v42, v42
    v_fma_f32 v44, v44, s30, -v4
    v_exp_f32 v43, v43
    v_fma_f32 v45, v45, s30, -v4
    s_waitcnt lgkmcnt(1)
    v_mfma_f32_32x32x16_bf16 v[16:31], v[100:103], v[84:87], v[16:31]
    ds_read_b128 v[96:99], v6 offset:47104
    v_exp_f32 v44, v44
    v_fma_f32 v46, v46, s30, -v4
    v_exp_f32 v45, v45
    v_fma_f32 v47, v47, s30, -v4
    v_exp_f32 v46, v46
    v_exp_f32 v47, v47
    v_cvt_pk_bf16_f32 v32, v32, v33
    v_cvt_pk_bf16_f32 v33, v34, v35
    v_cvt_pk_bf16_f32 v34, v36, v37
    v_cvt_pk_bf16_f32 v35, v38, v39
    v_cvt_pk_bf16_f32 v36, v40, v41
    v_cvt_pk_bf16_f32 v37, v42, v43
    v_cvt_pk_bf16_f32 v38, v44, v45
    v_cvt_pk_bf16_f32 v39, v46, v47
    s_waitcnt lgkmcnt(1)
    v_mfma_f32_32x32x16_bf16 v[16:31], v[104:107], v[32:35], v[16:31]
    s_waitcnt lgkmcnt(0)
    v_mfma_f32_32x32x16_bf16 v[16:31], v[96:99], v[36:39], v[16:31]
    v_mov_b32 v125, 29
    ds_write_b32 v126, v125
    s_lshl_b32 s21, s26, 5
    s_add_u32 s21, s21, s17
    s_lshl_b32 s21, s21, 10
    s_add_u32 s21, s21, 19218432
    s_nop 5
    v_mov_b32 v4, v28
    v_mov_b32 v5, v28
    s_nop 1
    v_permlane32_swap_b32 v4, v5
    v_rcp_f32 v5, v5
    s_nop 0
    v_mul_f32 v16, v16, v5
    v_mul_f32 v17, v17, v5
    v_mul_f32 v18, v18, v5
    v_mul_f32 v19, v19, v5
    v_mul_f32 v20, v20, v5
    v_mul_f32 v21, v21, v5
    v_mul_f32 v22, v22, v5
    v_mul_f32 v23, v23, v5
    v_mul_f32 v24, v24, v5
    v_mul_f32 v25, v25, v5
    v_mul_f32 v26, v26, v5
    v_mul_f32 v27, v27, v5
    v_mul_f32 v28, v28, v5
    v_mul_f32 v29, v29, v5
    v_mul_f32 v30, v30, v5
    v_mul_f32 v31, v31, v5
    v_cvt_pk_bf16_f32 v16, v16, v17
    v_cvt_pk_bf16_f32 v17, v18, v19
    v_cvt_pk_bf16_f32 v18, v20, v21
    v_cvt_pk_bf16_f32 v19, v22, v23
    v_cvt_pk_bf16_f32 v20, v24, v25
    v_cvt_pk_bf16_f32 v21, v26, v27
    v_cvt_pk_bf16_f32 v22, v28, v29
    v_cvt_pk_bf16_f32 v23, v30, v31
    buffer_store_dwordx4 v[16:19], v127, s[4:7], s21 offen offset:0 sc1
    buffer_store_dwordx4 v[20:23], v127, s[4:7], s21 offen offset:512 sc1
    v_mov_b32 v4, 7
    v_mov_b32 v5, 0
    s_waitcnt vmcnt(0)
    s_mov_b64 exec, 1
    s_cmp_lg_u32 s45, 0
    s_cbranch_scc1 Ltw127p
    buffer_store_dword v4, v5, s[4:7], s28 offen sc1
    s_branch Ltw127d
Ltw127p:
    buffer_store_dword v4, v5, s[4:7], s28 offen
Ltw127d:
    s_mov_b64 exec, -1
    s_lshl_b32 s21, s27, 5
    s_lshl_b32 s22, s18, 2
    s_add_u32 s21, s21, s22
    s_lshl_b32 s21, s21, 10
    s_add_u32 s21, s21, 19218432
    s_add_u32 s22, s21, 16384
    v_accvgpr_read_b32 v7, a125
    s_mov_b32 s25, 200000
Lpoll128:
    s_nop 3
    buffer_load_dword v4, v7, s[4:7], 0 offen sc1
    s_waitcnt vmcnt(0)
    v_cmp_gt_u32 vcc, 7, v4
    s_nop 1
    s_cbranch_vccz Lpoll128d
    s_sub_u32 s25, s25, 1
    s_cmp_lg_u32 s25, 0
    s_cbranch_scc1 Lpoll128
Lpoll128d:
    s_nop 0
    buffer_load_dwordx4 v[72:75], v1, s[4:7], s21 offen offset:0
    buffer_load_dwordx4 v[88:91], v1, s[4:7], s22 offen offset:0
    buffer_load_dwordx4 v[76:79], v1, s[4:7], s21 offen offset:1024
    buffer_load_dwordx4 v[92:95], v1, s[4:7], s22 offen offset:1024
    buffer_load_dwordx4 v[80:83], v1, s[4:7], s21 offen offset:2048
    buffer_load_dwordx4 v[96:99], v1, s[4:7], s22 offen offset:2048
    buffer_load_dwordx4 v[84:87], v1, s[4:7], s21 offen offset:3072
    buffer_load_dwordx4 v[100:103], v1, s[4:7], s22 offen offset:3072
    v_mov_b32 v116, 148992
    ds_read_b128 v[116:119], v116
    s_waitcnt lgkmcnt(0)
    v_min3_u32 v116, v116, v117, v118
    v_min_u32 v116, v116, v119
    v_cmp_gt_u32 vcc, 29, v116
    s_nop 1
    s_cbranch_vccz Lc129d
    s_nop 1
    s_mov_b32 s25, 2000000
Lc129:
    s_nop 0
    s_sleep 1
    v_mov_b32 v116, 148992
    ds_read_b128 v[116:119], v116
    s_waitcnt lgkmcnt(0)
    v_min3_u32 v116, v116, v117, v118
    v_min_u32 v116, v116, v119
    v_cmp_gt_u32 vcc, 29, v116
    s_nop 1
    s_cbranch_vccz Lc129d
    s_sub_u32 s25, s25, 1
    s_cmp_lg_u32 s25, 0
    s_cbranch_scc1 Lc129
    s_nop 0
Lc129d:
    s_waitcnt vmcnt(7)
    v_mfma_f32_16x16x32_bf16 v[16:19], a[0:3], v[72:75], 0
    v_mfma_f32_16x16x32_bf16 v[20:23], a[4:7], v[72:75], 0
    v_mfma_f32_16x16x32_bf16 v[24:27], a[8:11], v[72:75], 0
    v_mfma_f32_16x16x32_bf16 v[28:31], a[12:15], v[72:75], 0
    v_mfma_f32_16x16x32_bf16 v[32:35], a[16:19], v[72:75], 0
    v_mfma_f32_16x16x32_bf16 v[36:39], a[20:23], v[72:75], 0
    v_mfma_f32_16x16x32_bf16 v[40:43], a[24:27], v[72:75], 0
    s_waitcnt vmcnt(6)
    v_mfma_f32_16x16x32_bf16 v[44:47], a[0:3], v[88:91], 0
    v_mfma_f32_16x16x32_bf16 v[48:51], a[4:7], v[88:91], 0
    v_mfma_f32_16x16x32_bf16 v[52:55], a[8:11], v[88:91], 0
    v_mfma_f32_16x16x32_bf16 v[56:59], a[12:15], v[88:91], 0
    v_mfma_f32_16x16x32_bf16 v[60:63], a[16:19], v[88:91], 0
    v_mfma_f32_16x16x32_bf16 v[64:67], a[20:23], v[88:91], 0
    v_mfma_f32_16x16x32_bf16 v[68:71], a[24:27], v[88:91], 0
    s_waitcnt vmcnt(5)
    v_mfma_f32_16x16x32_bf16 v[16:19], a[28:31], v[76:79], v[16:19]
    v_mfma_f32_16x16x32_bf16 v[20:23], a[32:35], v[76:79], v[20:23]
    v_mfma_f32_16x16x32_bf16 v[24:27], a[36:39], v[76:79], v[24:27]
    v_mfma_f32_16x16x32_bf16 v[28:31], a[40:43], v[76:79], v[28:31]
    v_mfma_f32_16x16x32_bf16 v[32:35], a[44:47], v[76:79], v[32:35]
    v_mfma_f32_16x16x32_bf16 v[36:39], a[48:51], v[76:79], v[36:39]
    v_mfma_f32_16x16x32_bf16 v[40:43], a[52:55], v[76:79], v[40:43]
    s_waitcnt vmcnt(4)
    v_mfma_f32_16x16x32_bf16 v[44:47], a[28:31], v[92:95], v[44:47]
    v_mfma_f32_16x16x32_bf16 v[48:51], a[32:35], v[92:95], v[48:51]
    v_mfma_f32_16x16x32_bf16 v[52:55], a[36:39], v[92:95], v[52:55]
    v_mfma_f32_16x16x32_bf16 v[56:59], a[40:43], v[92:95], v[56:59]
    v_mfma_f32_16x16x32_bf16 v[60:63], a[44:47], v[92:95], v[60:63]
    v_mfma_f32_16x16x32_bf16 v[64:67], a[48:51], v[92:95], v[64:67]
    v_mfma_f32_16x16x32_bf16 v[68:71], a[52:55], v[92:95], v[68:71]
    s_waitcnt vmcnt(3)
    v_mfma_f32_16x16x32_bf16 v[16:19], a[56:59], v[80:83], v[16:19]
    v_mfma_f32_16x16x32_bf16 v[20:23], a[60:63], v[80:83], v[20:23]
    v_mfma_f32_16x16x32_bf16 v[24:27], a[64:67], v[80:83], v[24:27]
    v_mfma_f32_16x16x32_bf16 v[28:31], a[68:71], v[80:83], v[28:31]
    v_mfma_f32_16x16x32_bf16 v[32:35], a[72:75], v[80:83], v[32:35]
    v_mfma_f32_16x16x32_bf16 v[36:39], a[76:79], v[80:83], v[36:39]
    v_mfma_f32_16x16x32_bf16 v[40:43], a[80:83], v[80:83], v[40:43]
    s_waitcnt vmcnt(2)
    v_mfma_f32_16x16x32_bf16 v[44:47], a[56:59], v[96:99], v[44:47]
    v_mfma_f32_16x16x32_bf16 v[48:51], a[60:63], v[96:99], v[48:51]
    v_mfma_f32_16x16x32_bf16 v[52:55], a[64:67], v[96:99], v[52:55]
    v_mfma_f32_16x16x32_bf16 v[56:59], a[68:71], v[96:99], v[56:59]
    v_mfma_f32_16x16x32_bf16 v[60:63], a[72:75], v[96:99], v[60:63]
    v_mfma_f32_16x16x32_bf16 v[64:67], a[76:79], v[96:99], v[64:67]
    v_mfma_f32_16x16x32_bf16 v[68:71], a[80:83], v[96:99], v[68:71]
    s_waitcnt vmcnt(1)
    v_mfma_f32_16x16x32_bf16 v[16:19], a[84:87], v[84:87], v[16:19]
    v_mfma_f32_16x16x32_bf16 v[20:23], a[88:91], v[84:87], v[20:23]
    v_mfma_f32_16x16x32_bf16 v[24:27], a[92:95], v[84:87], v[24:27]
    v_mfma_f32_16x16x32_bf16 v[28:31], a[96:99], v[84:87], v[28:31]
    v_mfma_f32_16x16x32_bf16 v[32:35], a[100:103], v[84:87], v[32:35]
    v_mfma_f32_16x16x32_bf16 v[36:39], a[104:107], v[84:87], v[36:39]
    s_nop 2
    ds_write_b128 v121, v[16:19] offset:0
    v_mfma_f32_16x16x32_bf16 v[40:43], a[108:111], v[84:87], v[40:43]
    ds_write_b128 v121, v[20:23] offset:64
    s_waitcnt vmcnt(0)
    v_mfma_f32_16x16x32_bf16 v[44:47], a[84:87], v[100:103], v[44:47]
    ds_write_b128 v121, v[24:27] offset:128
    v_mfma_f32_16x16x32_bf16 v[48:51], a[88:91], v[100:103], v[48:51]
    ds_write_b128 v121, v[28:31] offset:192
    v_mfma_f32_16x16x32_bf16 v[52:55], a[92:95], v[100:103], v[52:55]
    ds_write_b128 v121, v[32:35] offset:256
    v_mfma_f32_16x16x32_bf16 v[56:59], a[96:99], v[100:103], v[56:59]
    ds_write_b128 v121, v[36:39] offset:320
    v_mfma_f32_16x16x32_bf16 v[60:63], a[100:103], v[100:103], v[60:63]
    ds_write_b128 v121, v[40:43] offset:384
    v_mfma_f32_16x16x32_bf16 v[64:67], a[104:107], v[100:103], v[64:67]
    ds_write_b128 v121, v[44:47] offset:7424
    v_mfma_f32_16x16x32_bf16 v[68:71], a[108:111], v[100:103], v[68:71]
    ds_write_b128 v121, v[48:51] offset:7488
    ds_write_b128 v121, v[52:55] offset:7552
    ds_write_b128 v121, v[56:59] offset:7616
    s_nop 0
    ds_write_b128 v121, v[60:63] offset:7680
    s_nop 0
    ds_write_b128 v121, v[64:67] offset:7744
    s_nop 0
    ds_write_b128 v121, v[68:71] offset:7808
    v_mov_b32 v125, 30
    ds_write_b32 v126, v125
    v_lshlrev_b32 v80, 16, v108
    v_and_b32 v81, 0xffff0000, v108
    v_lshlrev_b32 v82, 16, v109
    v_and_b32 v83, 0xffff0000, v109
    v_lshlrev_b32 v84, 16, v110
    v_and_b32 v85, 0xffff0000, v110
    v_lshlrev_b32 v86, 16, v111
    v_and_b32 v87, 0xffff0000, v111
    v_lshlrev_b32 v88, 16, v112
    v_and_b32 v89, 0xffff0000, v112
    v_lshlrev_b32 v90, 16, v113
    v_and_b32 v91, 0xffff0000, v113
    v_lshlrev_b32 v92, 16, v114
    v_and_b32 v93, 0xffff0000, v114
    v_lshlrev_b32 v94, 16, v115
    v_and_b32 v95, 0xffff0000, v115
    v_mov_b32 v116, 148992
    ds_read_b128 v[116:119], v116
    s_waitcnt lgkmcnt(0)
    v_min3_u32 v116, v116, v117, v118
    v_min_u32 v116, v116, v119
    v_cmp_gt_u32 vcc, 30, v116
    s_nop 1
    s_cbranch_vccz Lc130d
    s_nop 1
    s_mov_b32 s25, 2000000
Lc130:
    s_nop 0
    s_sleep 1
    v_mov_b32 v116, 148992
    ds_read_b128 v[116:119], v116
    s_waitcnt lgkmcnt(0)
    v_min3_u32 v116, v116, v117, v118
    v_min_u32 v116, v116, v119
    v_cmp_gt_u32 vcc, 30, v116
    s_nop 1
    s_cbranch_vccz Lc130d
    s_sub_u32 s25, s25, 1
    s_cmp_lg_u32 s25, 0
    s_cbranch_scc1 Lc130
    s_nop 0
Lc130d:
    ds_read_b128 v[16:19], v120 offset:0
    ds_read_b128 v[20:23], v120 offset:16
    ds_read_b128 v[24:27], v120 offset:32
    ds_read_b128 v[28:31], v120 offset:48
    ds_read_b128 v[32:35], v120 offset:14848
    ds_read_b128 v[36:39], v120 offset:14864
    ds_read_b128 v[40:43], v120 offset:14880
    ds_read_b128 v[44:47], v120 offset:14896
    ds_read_b128 v[48:51], v120 offset:29696
    ds_read_b128 v[52:55], v120 offset:29712
    ds_read_b128 v[56:59], v120 offset:29728
    ds_read_b128 v[60:63], v120 offset:29744
    ds_read_b128 v[64:67], v120 offset:44544
    ds_read_b128 v[68:71], v120 offset:44560
    ds_read_b128 v[72:75], v120 offset:44576
    ds_read_b128 v[76:79], v120 offset:44592
    s_mov_b32 s40, 0x7f7f7f7f
    s_mov_b32 s41, 0x7f7f7f7f
    s_mov_b32 s21, 6832128
    s_mov_b32 s22, 8667136
    s_waitcnt lgkmcnt(8)
    v_pk_add_f32 v[16:17], v[16:17], v[32:33]
    v_pk_add_f32 v[18:19], v[18:19], v[34:35]
    v_pk_add_f32 v[20:21], v[20:21], v[36:37]
    v_pk_add_f32 v[22:23], v[22:23], v[38:39]
    v_pk_add_f32 v[24:25], v[24:25], v[40:41]
    v_pk_add_f32 v[26:27], v[26:27], v[42:43]
    v_pk_add_f32 v[28:29], v[28:29], v[44:45]
    v_pk_add_f32 v[30:31], v[30:31], v[46:47]
    s_waitcnt lgkmcnt(0)
    v_mov_b32 v125, 31
    ds_write_b32 v126, v125
    v_pk_add_f32 v[48:49], v[48:49], v[64:65]
    v_pk_add_f32 v[50:51], v[50:51], v[66:67]
    v_pk_add_f32 v[52:53], v[52:53], v[68:69]
    v_pk_add_f32 v[54:55], v[54:55], v[70:71]
    v_pk_add_f32 v[56:57], v[56:57], v[72:73]
    v_pk_add_f32 v[58:59], v[58:59], v[74:75]
    v_pk_add_f32 v[60:61], v[60:61], v[76:77]
    v_pk_add_f32 v[62:63], v[62:63], v[78:79]
    v_pk_add_f32 v[16:17], v[16:17], v[48:49]
    v_pk_add_f32 v[18:19], v[18:19], v[50:51]
    v_pk_add_f32 v[20:21], v[20:21], v[52:53]
    v_pk_add_f32 v[22:23], v[22:23], v[54:55]
    v_pk_add_f32 v[24:25], v[24:25], v[56:57]
    v_pk_add_f32 v[26:27], v[26:27], v[58:59]
    v_pk_add_f32 v[28:29], v[28:29], v[60:61]
    v_pk_add_f32 v[30:31], v[30:31], v[62:63]
    v_cvt_pk_bf16_f32 v32, v16, v17
    v_cvt_pk_bf16_f32 v33, v18, v19
    v_cvt_pk_bf16_f32 v34, v20, v21
    v_cvt_pk_bf16_f32 v35, v22, v23
    v_cvt_pk_bf16_f32 v36, v24, v25
    v_cvt_pk_bf16_f32 v37, v26, v27
    v_cvt_pk_bf16_f32 v38, v28, v29
    v_cvt_pk_bf16_f32 v39, v30, v31
    v_lshlrev_b32 v16, 16, v32
    v_and_b32 v17, 0xffff0000, v32
    v_lshlrev_b32 v18, 16, v33
    v_and_b32 v19, 0xffff0000, v33
    v_lshlrev_b32 v20, 16, v34
    v_and_b32 v21, 0xffff0000, v34
    v_lshlrev_b32 v22, 16, v35
    v_and_b32 v23, 0xffff0000, v35
    v_lshlrev_b32 v24, 16, v36
    v_and_b32 v25, 0xffff0000, v36
    v_lshlrev_b32 v26, 16, v37
    v_and_b32 v27, 0xffff0000, v37
    v_lshlrev_b32 v28, 16, v38
    v_and_b32 v29, 0xffff0000, v38
    v_lshlrev_b32 v30, 16, v39
    v_and_b32 v31, 0xffff0000, v39
    v_pk_add_f32 v[16:17], v[16:17], v[80:81]
    v_pk_add_f32 v[18:19], v[18:19], v[82:83]
    v_pk_add_f32 v[20:21], v[20:21], v[84:85]
    v_pk_add_f32 v[22:23], v[22:23], v[86:87]
    v_pk_add_f32 v[24:25], v[24:25], v[88:89]
    v_pk_add_f32 v[26:27], v[26:27], v[90:91]
    v_pk_add_f32 v[28:29], v[28:29], v[92:93]
    v_pk_add_f32 v[30:31], v[30:31], v[94:95]
    v_cvt_pk_bf16_f32 v108, v16, v17
    v_cvt_pk_bf16_f32 v109, v18, v19
    v_cvt_pk_bf16_f32 v110, v20, v21
    v_cvt_pk_bf16_f32 v111, v22, v23
    v_cvt_pk_bf16_f32 v112, v24, v25
    v_cvt_pk_bf16_f32 v113, v26, v27
    v_cvt_pk_bf16_f32 v114, v28, v29
    v_cvt_pk_bf16_f32 v115, v30, v31
    v_mov_b32 v64, 0
    v_mov_b32 v65, 0
    v_mov_b32 v66, 0
    v_mov_b32 v67, 0
    v_mov_b32 v68, 0x3f803f80
    s_mov_b64 exec, s[40:41]
    s_cmp_lg_u32 s45, 0
    s_cbranch_scc1 Ltw131p
    buffer_store_dwordx4 v[108:111], v122, s[4:7], s21 offen offset:0 sc1
    buffer_store_dwordx4 v[112:115], v122, s[4:7], s21 offen offset:512 sc1
    s_branch Ltw131d
Ltw131p:
    buffer_store_dwordx4 v[108:111], v122, s[4:7], s21 offen offset:0
    buffer_store_dwordx4 v[112:115], v122, s[4:7], s21 offen offset:512
Ltw131d:
    v_dot2c_f32_bf16 v64, v108, v68
    v_dot2c_f32_bf16 v65, v108, v108
    v_dot2c_f32_bf16 v66, v109, v68
    v_dot2c_f32_bf16 v67, v109, v109
    v_dot2c_f32_bf16 v64, v110, v68
    v_dot2c_f32_bf16 v65, v110, v110
    v_dot2c_f32_bf16 v66, v111, v68
    v_dot2c_f32_bf16 v67, v111, v111
    v_dot2c_f32_bf16 v64, v112, v68
    v_dot2c_f32_bf16 v65, v112, v112
    v_dot2c_f32_bf16 v66, v113, v68
    v_dot2c_f32_bf16 v67, v113, v113
    v_dot2c_f32_bf16 v64, v114, v68
    v_dot2c_f32_bf16 v65, v114, v114
    v_dot2c_f32_bf16 v66, v115, v68
    v_dot2c_f32_bf16 v67, v115, v115
    s_mov_b64 exec, -1
    s_mov_b32 s40, 0x01010101
    s_mov_b32 s41, 0x01010101
    s_nop 1
    v_add_f32 v64, v64, v66
    v_add_f32 v65, v65, v67
    s_nop 0
    v_add_f32_dpp v66, v64, v64 quad_perm:[1,0,3,2] row_mask:0xf bank_mask:0xf
    v_add_f32_dpp v67, v65, v65 quad_perm:[1,0,3,2] row_mask:0xf bank_mask:0xf
    s_nop 0
    v_add_f32_dpp v64, v66, v66 quad_perm:[2,3,0,1] row_mask:0xf bank_mask:0xf
    v_add_f32_dpp v65, v67, v67 quad_perm:[2,3,0,1] row_mask:0xf bank_mask:0xf
    s_nop 0
    v_add_f32_dpp v66, v64, v64 row_half_mirror row_mask:0xf bank_mask:0xf
    v_add_f32_dpp v67, v65, v65 row_half_mirror row_mask:0xf bank_mask:0xf
    s_mov_b64 exec, s[40:41]
    s_cmp_lg_u32 s45, 0
    s_cbranch_scc1 Ltw132p
    buffer_store_dwordx2 v[66:67], v124, s[4:7], s22 offen sc1
    s_branch Ltw132d
Ltw132p:
    buffer_store_dwordx2 v[66:67], v124, s[4:7], s22 offen
Ltw132d:
    s_mov_b64 exec, -1
    v_mov_b32 v4, 8
    v_mov_b32 v5, 0
    s_waitcnt vmcnt(0)
    s_mov_b64 exec, 1
    s_cmp_lg_u32 s45, 0
    s_cbranch_scc1 Ltw133p
    buffer_store_dword v4, v5, s[4:7], s28 offen sc1
    s_branch Ltw133d
Ltw133p:
    buffer_store_dword v4, v5, s[4:7], s28 offen
Ltw133d:
    s_mov_b64 exec, -1
    s_mul_i32 s24, s26, 112
    s_mul_i32 s23, s17, 7
    s_add_u32 s24, s24, s23
    s_lshl_b32 s24, s24, 10
    s_add_u32 s24, s24, 28655616
    s_add_u32 s22, s24, 4096
    v_accvgpr_read_b32 v7, a124
    s_mov_b32 s25, 200000
Lpoll134:
    s_nop 3
    buffer_load_dword v4, v7, s[4:7], 0 offen sc1
    s_waitcnt vmcnt(0)
    v_cmp_gt_u32 vcc, 8, v4
    s_nop 1
    s_cbranch_vccz Lpoll134d
    s_sub_u32 s25, s25, 1
    s_cmp_lg_u32 s25, 0
    s_cbranch_scc1 Lpoll134
Lpoll134d:
    s_nop 0
    s_mul_i32 s47, s26, 28672
    s_add_u32 s47, s47, 6832128
    s_lshl_b32 s23, s26, 10
    s_add_u32 s23, s23, 8667136
    v_and_b32 v4, 31, v0
    v_lshlrev_b32 v4, 5, v4
    buffer_load_dwordx4 a[0:3], v1, s[4:7], s47 offen offset:0 sc1
    buffer_load_dwordx4 a[4:7], v1, s[4:7], s47 offen offset:1024 sc1
    buffer_load_dwordx4 a[8:11], v1, s[4:7], s47 offen offset:2048 sc1
    buffer_load_dwordx4 a[12:15], v1, s[4:7], s47 offen offset:3072 sc1
    s_add_u32 s47, s47, 4096
    buffer_load_dwordx4 a[16:19], v1, s[4:7], s47 offen offset:0 sc1
    buffer_load_dwordx4 a[20:23], v1, s[4:7], s47 offen offset:1024 sc1
    buffer_load_dwordx4 v[96:99], v4, s[4:7], s23 offen sc1
    buffer_load_dwordx4 v[100:103], v4, s[4:7], s23 offen offset:16 sc1
    buffer_load_dwordx4 a[24:27], v1, s[4:7], s47 offen offset:2048 sc1
    buffer_load_dwordx4 a[28:31], v1, s[4:7], s47 offen offset:3072 sc1
    s_add_u32 s47, s47, 4096
    buffer_load_dwordx4 a[32:35], v1, s[4:7], s47 offen offset:0 sc1
    buffer_load_dwordx4 a[36:39], v1, s[4:7], s47 offen offset:1024 sc1
    buffer_load_dwordx4 a[40:43], v1, s[4:7], s47 offen offset:2048 sc1
    buffer_load_dwordx4 a[44:47], v1, s[4:7], s47 offen offset:3072 sc1
    s_add_u32 s47, s47, 4096
    buffer_load_dwordx4 a[48:51], v1, s[4:7], s47 offen offset:0 sc1
    buffer_load_dwordx4 a[52:55], v1, s[4:7], s47 offen offset:1024 sc1
    v_mov_b32 v116, 149008
    ds_read_b128 v[116:119], v116
    s_waitcnt lgkmcnt(0)
    v_min3_u32 v116, v116, v117, v118
    v_min_u32 v116, v116, v119
    v_cmp_gt_u32 vcc, 15, v116
    s_nop 1
    s_cbranch_vccz Lc135d
    s_nop 1
    s_mov_b32 s25, 2000000
Lc135:
    s_nop 0
    s_sleep 1
    v_mov_b32 v116, 149008
    ds_read_b128 v[116:119], v116
    s_waitcnt lgkmcnt(0)
    v_min3_u32 v116, v116, v117, v118
    v_min_u32 v116, v116, v119
    v_cmp_gt_u32 vcc, 15, v116
    s_nop 1
    s_cbranch_vccz Lc135d
    s_sub_u32 s25, s25, 1
    s_cmp_lg_u32 s25, 0
    s_cbranch_scc1 Lc135
    s_nop 0
Lc135d:
    ds_read_b128 v[80:83], v1 offset:0
    ds_read_b128 v[84:87], v1 offset:29696
    ds_read_b128 v[88:91], v1 offset:59392
    ds_read_b128 v[92:95], v1 offset:1024
    ds_read_b128 a[116:119], v1 offset:30720
    s_waitcnt vmcnt(15)
    s_waitcnt lgkmcnt(4)
    v_mfma_f32_32x32x16_bf16 v[16:31], v[80:83], a[0:3], 0
    ds_read_b128 a[120:123], v1 offset:60416
    buffer_load_dwordx4 a[56:59], v1, s[4:7], s47 offen offset:2048 sc1
    s_waitcnt lgkmcnt(4)
    v_mfma_f32_32x32x16_bf16 v[32:47], v[84:87], a[0:3], 0
    ds_read_b128 v[80:83], v1 offset:2048
    s_waitcnt lgkmcnt(4)
    v_mfma_f32_32x32x16_bf16 v[48:63], v[88:91], a[0:3], 0
    ds_read_b128 v[84:87], v1 offset:31744
    buffer_load_dwordx4 a[60:63], v1, s[4:7], s47 offen offset:3072 sc1
    s_add_u32 s47, s47, 4096
    s_waitcnt vmcnt(16)
    s_waitcnt lgkmcnt(4)
    v_mfma_f32_32x32x16_bf16 v[16:31], v[92:95], a[4:7], v[16:31]
    ds_read_b128 v[88:91], v1 offset:61440
    s_waitcnt lgkmcnt(4)
    v_mfma_f32_32x32x16_bf16 v[32:47], a[116:119], a[4:7], v[32:47]
    ds_read_b128 v[92:95], v1 offset:3072
    buffer_load_dwordx4 a[64:67], v1, s[4:7], s47 offen offset:0 sc1
    s_waitcnt lgkmcnt(4)
    v_mfma_f32_32x32x16_bf16 v[48:63], a[120:123], a[4:7], v[48:63]
    ds_read_b128 a[116:119], v1 offset:32768
    s_waitcnt vmcnt(16)
    s_waitcnt lgkmcnt(4)
    v_mfma_f32_32x32x16_bf16 v[16:31], v[80:83], a[8:11], v[16:31]
    ds_read_b128 a[120:123], v1 offset:62464
    buffer_load_dwordx4 a[68:71], v1, s[4:7], s47 offen offset:1024 sc1
    s_waitcnt lgkmcnt(4)
    v_mfma_f32_32x32x16_bf16 v[32:47], v[84:87], a[8:11], v[32:47]
    ds_read_b128 v[80:83], v1 offset:4096
    s_waitcnt lgkmcnt(4)
    v_mfma_f32_32x32x16_bf16 v[48:63], v[88:91], a[8:11], v[48:63]
    ds_read_b128 v[84:87], v1 offset:33792
    buffer_load_dwordx4 a[72:75], v1, s[4:7], s47 offen offset:2048 sc1
    s_waitcnt vmcnt(17)
    s_waitcnt lgkmcnt(4)
    v_mfma_f32_32x32x16_bf16 v[16:31], v[92:95], a[12:15], v[16:31]
    ds_read_b128 v[88:91], v1 offset:63488
    s_waitcnt lgkmcnt(4)
    v_mfma_f32_32x32x16_bf16 v[32:47], a[116:119], a[12:15], v[32:47]
    ds_read_b128 v[92:95], v1 offset:5120
    buffer_load_dwordx4 a[76:79], v1, s[4:7], s47 offen offset:3072 sc1
    s_add_u32 s47, s47, 4096
    s_waitcnt lgkmcnt(4)
    v_mfma_f32_32x32x16_bf16 v[48:63], a[120:123], a[12:15], v[48:63]
    ds_read_b128 a[116:119], v1 offset:34816
    s_waitcnt vmcnt(17)
    s_waitcnt lgkmcnt(4)
    v_mfma_f32_32x32x16_bf16 v[16:31], v[80:83], a[16:19], v[16:31]
    ds_read_b128 a[120:123], v1 offset:64512
    buffer_load_dwordx4 a[80:83], v1, s[4:7], s47 offen offset:0 sc1
    s_waitcnt lgkmcnt(4)
    v_mfma_f32_32x32x16_bf16 v[32:47], v[84:87], a[16:19], v[32:47]
    ds_read_b128 v[80:83], v1 offset:6144
    s_waitcnt lgkmcnt(4)
    v_mfma_f32_32x32x16_bf16 v[48:63], v[88:91], a[16:19], v[48:63]
    ds_read_b128 v[84:87], v1 offset:35840
    buffer_load_dwordx4 a[84:87], v1, s[4:7], s47 offen offset:1024 sc1
    s_waitcnt vmcnt(18)
    s_waitcnt lgkmcnt(4)
    v_mfma_f32_32x32x16_bf16 v[16:31], v[92:95], a[20:23], v[16:31]
    ds_read_b128 v[88:91], v2 offset:0
    s_waitcnt lgkmcnt(4)
    v_mfma_f32_32x32x16_bf16 v[32:47], a[116:119], a[20:23], v[32:47]
    ds_read_b128 v[92:95], v1 offset:7168
    buffer_load_dwordx4 a[88:91], v1, s[4:7], s47 offen offset:2048 sc1
    s_waitcnt lgkmcnt(4)
    v_mfma_f32_32x32x16_bf16 v[48:63], a[120:123], a[20:23], v[48:63]
    ds_read_b128 a[116:119], v1 offset:36864
    s_waitcnt vmcnt(16)
    s_waitcnt lgkmcnt(4)
    v_mfma_f32_32x32x16_bf16 v[16:31], v[80:83], a[24:27], v[16:31]
    ds_read_b128 a[120:123], v2 offset:1024
    buffer_load_dwordx4 a[92:95], v1, s[4:7], s47 offen offset:3072 sc1
    s_add_u32 s47, s47, 4096
    s_waitcnt lgkmcnt(4)
    v_mfma_f32_32x32x16_bf16 v[32:47], v[84:87], a[24:27], v[32:47]
    ds_read_b128 v[80:83], v1 offset:8192
    s_waitcnt lgkmcnt(4)
    v_mfma_f32_32x32x16_bf16 v[48:63], v[88:91], a[24:27], v[48:63]
    ds_read_b128 v[84:87], v1 offset:37888
    buffer_load_dwordx4 a[96:99], v1, s[4:7], s47 offen offset:0 sc1
    s_waitcnt vmcnt(17)
    s_waitcnt lgkmcnt(4)
    v_mfma_f32_32x32x16_bf16 v[16:31], v[92:95], a[28:31], v[16:31]
    ds_read_b128 v[88:91], v2 offset:2048
    s_waitcnt lgkmcnt(4)
    v_mfma_f32_32x32x16_bf16 v[32:47], a[116:119], a[28:31], v[32:47]
    ds_read_b128 v[92:95], v1 offset:9216
    buffer_load_dwordx4 a[100:103], v1, s[4:7], s47 offen offset:1024 sc1
    s_waitcnt lgkmcnt(4)
    v_mfma_f32_32x32x16_bf16 v[48:63], a[120:123], a[28:31], v[48:63]
    ds_read_b128 a[116:119], v1 offset:38912
    s_waitcnt vmcnt(17)
    s_waitcnt lgkmcnt(4)
    v_mfma_f32_32x32x16_bf16 v[16:31], v[80:83], a[32:35], v[16:31]
    ds_read_b128 a[120:123], v2 offset:3072
    buffer_load_dwordx4 a[104:107], v1, s[4:7], s47 offen offset:2048 sc1
    s_waitcnt lgkmcnt(4)
    v_mfma_f32_32x32x16_bf16 v[32:47], v[84:87], a[32:35], v[32:47]
    ds_read_b128 v[80:83], v1 offset:10240
    s_waitcnt lgkmcnt(4)
    v_mfma_f32_32x32x16_bf16 v[48:63], v[88:91], a[32:35], v[48:63]
    ds_read_b128 v[84:87], v1 offset:39936
    buffer_load_dwordx4 a[108:111], v1, s[4:7], s47 offen offset:3072 sc1
    v_mov_b32 v125, 32
    ds_write_b32 v126, v125
    s_waitcnt vmcnt(18)
    s_waitcnt lgkmcnt(5)
    v_mfma_f32_32x32x16_bf16 v[16:31], v[92:95], a[36:39], v[16:31]
    ds_read_b128 v[88:91], v2 offset:4096
    s_waitcnt lgkmcnt(5)
    v_mfma_f32_32x32x16_bf16 v[32:47], a[116:119], a[36:39], v[32:47]
    ds_read_b128 v[92:95], v1 offset:11264
    s_waitcnt lgkmcnt(5)
    v_mfma_f32_32x32x16_bf16 v[48:63], a[120:123], a[36:39], v[48:63]
    ds_read_b128 a[116:119], v1 offset:40960
    s_waitcnt vmcnt(17)
    s_waitcnt lgkmcnt(5)
    v_mfma_f32_32x32x16_bf16 v[16:31], v[80:83], a[40:43], v[16:31]
    ds_read_b128 a[120:123], v2 offset:5120
    s_waitcnt lgkmcnt(5)
    v_mfma_f32_32x32x16_bf16 v[32:47], v[84:87], a[40:43], v[32:47]
    ds_read_b128 v[80:83], v1 offset:12288
    s_waitcnt lgkmcnt(4)
    v_mfma_f32_32x32x16_bf16 v[48:63], v[88:91], a[40:43], v[48:63]
    ds_read_b128 v[84:87], v1 offset:41984
    s_waitcnt vmcnt(16)
    s_waitcnt lgkmcnt(4)
    v_mfma_f32_32x32x16_bf16 v[16:31], v[92:95], a[44:47], v[16:31]
    ds_read_b128 v[88:91], v2 offset:6144
    s_waitcnt lgkmcnt(4)
    v_mfma_f32_32x32x16_bf16 v[32:47], a[116:119], a[44:47], v[32:47]
    ds_read_b128 v[92:95], v1 offset:13312
    s_waitcnt lgkmcnt(4)
    v_mfma_f32_32x32x16_bf16 v[48:63], a[120:123], a[44:47], v[48:63]
    ds_read_b128 a[116:119], v1 offset:43008
    s_waitcnt vmcnt(15)
    s_waitcnt lgkmcnt(4)
    v_mfma_f32_32x32x16_bf16 v[16:31], v[80:83], a[48:51], v[16:31]
    ds_read_b128 a[120:123], v2 offset:7168
    v_add_f32 v96, v96, v98
    v_add_f32 v100, v100, v102
    v_add_f32 v97, v97, v99
    v_add_f32 v101, v101, v103
    s_waitcnt lgkmcnt(4)
    v_mfma_f32_32x32x16_bf16 v[32:47], v[84:87], a[48:51], v[32:47]
    ds_read_b128 v[80:83], v1 offset:14336
    v_add_f32 v96, v96, v100
    v_add_f32 v97, v97, v101
    v_mul_f32 v96, 0x3b124925, v96
    v_mul_f32 v97, 0x3b124925, v97
    s_waitcnt lgkmcnt(4)
    v_mfma_f32_32x32x16_bf16 v[48:63], v[88:91], a[48:51], v[48:63]
    ds_read_b128 v[84:87], v1 offset:44032
    v_fma_f32 v97, -v96, v96, v97
    v_max_f32 v97, 0, v97
    v_cvt_pk_bf16_f32 v97, v97, v97
    v_lshlrev_b32 v97, 16, v97
    s_waitcnt vmcnt(14)
    s_waitcnt lgkmcnt(4)
    v_mfma_f32_32x32x16_bf16 v[16:31], v[92:95], a[52:55], v[16:31]
    ds_read_b128 v[88:91], v2 offset:8192
    v_add_f32 v97, 0x3727c5ac, v97
    v_cvt_pk_bf16_f32 v97, v97, v97
    v_lshlrev_b32 v97, 16, v97
    v_sqrt_f32 v97, v97
    s_waitcnt lgkmcnt(4)
    v_mfma_f32_32x32x16_bf16 v[32:47], a[116:119], a[52:55], v[32:47]
    ds_read_b128 v[92:95], v1 offset:15360
    v_sub_f32 v96, 0, v96
    v_cvt_pk_bf16_f32 v105, v97, v97
    v_lshlrev_b32 v105, 16, v105
    v_rcp_f32 v104, v105
    s_waitcnt lgkmcnt(4)
    v_mfma_f32_32x32x16_bf16 v[48:63], a[120:123], a[52:55], v[48:63]
    ds_read_b128 a[116:119], v1 offset:45056
    v_cvt_pk_bf16_f32 v98, v96, v96
    v_and_b32 v99, 0xffff, v98
    v_accvgpr_write_b32 a112, v98
    v_accvgpr_write_b32 a113, v99
    s_waitcnt vmcnt(13)
    s_waitcnt lgkmcnt(4)
    v_mfma_f32_32x32x16_bf16 v[16:31], v[80:83], a[56:59], v[16:31]
    ds_read_b128 a[120:123], v2 offset:9216
    v_accvgpr_write_b32 a114, v98
    v_accvgpr_write_b32 a115, v99
    v_mul_f32 v13, 0xc0135761, v104
    v_mul_f32 v14, v104, v104
    s_waitcnt lgkmcnt(4)
    v_mfma_f32_32x32x16_bf16 v[32:47], v[84:87], a[56:59], v[32:47]
    ds_read_b128 v[80:83], v1 offset:16384
    v_mul_f32 v14, v14, v13
    v_mul_f32 v14, 0x3d372713, v14
    v_mul_f32 v12, v105, v105
    s_waitcnt lgkmcnt(4)
    v_mfma_f32_32x32x16_bf16 v[48:63], v[88:91], a[56:59], v[48:63]
    ds_read_b128 v[84:87], v1 offset:46080
    s_waitcnt vmcnt(12)
    s_waitcnt lgkmcnt(4)
    v_mfma_f32_32x32x16_bf16 v[16:31], v[92:95], a[60:63], v[16:31]
    ds_read_b128 v[88:91], v2 offset:10240
    s_waitcnt lgkmcnt(4)
    v_mfma_f32_32x32x16_bf16 v[32:47], a[116:119], a[60:63], v[32:47]
    ds_read_b128 v[92:95], v1 offset:17408
    s_waitcnt lgkmcnt(4)
    v_mfma_f32_32x32x16_bf16 v[48:63], a[120:123], a[60:63], v[48:63]
    ds_read_b128 a[116:119], v1 offset:47104
    s_waitcnt vmcnt(11)
    s_waitcnt lgkmcnt(4)
    v_mfma_f32_32x32x16_bf16 v[16:31], v[80:83], a[64:67], v[16:31]
    ds_read_b128 a[120:123], v2 offset:11264
    s_waitcnt lgkmcnt(4)
    v_mfma_f32_32x32x16_bf16 v[32:47], v[84:87], a[64:67], v[32:47]
    ds_read_b128 v[80:83], v1 offset:18432
    s_waitcnt lgkmcnt(4)
    v_mfma_f32_32x32x16_bf16 v[48:63], v[88:91], a[64:67], v[48:63]
    ds_read_b128 v[84:87], v1 offset:48128
    s_waitcnt vmcnt(10)
    s_waitcnt lgkmcnt(4)
    v_mfma_f32_32x32x16_bf16 v[16:31], v[92:95], a[68:71], v[16:31]
    ds_read_b128 v[88:91], v2 offset:12288
    s_waitcnt lgkmcnt(4)
    v_mfma_f32_32x32x16_bf16 v[32:47], a[116:119], a[68:71], v[32:47]
    ds_read_b128 v[92:95], v1 offset:19456
    s_waitcnt lgkmcnt(4)
    v_mfma_f32_32x32x16_bf16 v[48:63], a[120:123], a[68:71], v[48:63]
    ds_read_b128 a[116:119], v1 offset:49152
    s_waitcnt vmcnt(9)
    s_waitcnt lgkmcnt(4)
    v_mfma_f32_32x32x16_bf16 v[16:31], v[80:83], a[72:75], v[16:31]
    ds_read_b128 a[120:123], v2 offset:13312
    s_waitcnt lgkmcnt(4)
    v_mfma_f32_32x32x16_bf16 v[32:47], v[84:87], a[72:75], v[32:47]
    ds_read_b128 v[80:83], v1 offset:20480
    s_waitcnt lgkmcnt(4)
    v_mfma_f32_32x32x16_bf16 v[48:63], v[88:91], a[72:75], v[48:63]
    ds_read_b128 v[84:87], v1 offset:50176
    s_waitcnt vmcnt(8)
    s_waitcnt lgkmcnt(4)
    v_mfma_f32_32x32x16_bf16 v[16:31], v[92:95], a[76:79], v[16:31]
    ds_read_b128 v[88:91], v2 offset:14336
    s_waitcnt lgkmcnt(4)
    v_mfma_f32_32x32x16_bf16 v[32:47], a[116:119], a[76:79], v[32:47]
    ds_read_b128 v[92:95], v1 offset:21504
    s_waitcnt lgkmcnt(4)
    v_mfma_f32_32x32x16_bf16 v[48:63], a[120:123], a[76:79], v[48:63]
    ds_read_b128 a[116:119], v1 offset:51200
    s_waitcnt vmcnt(7)
    s_waitcnt lgkmcnt(4)
    v_mfma_f32_32x32x16_bf16 v[16:31], v[80:83], a[80:83], v[16:31]
    ds_read_b128 a[120:123], v2 offset:15360
    s_waitcnt lgkmcnt(4)
    v_mfma_f32_32x32x16_bf16 v[32:47], v[84:87], a[80:83], v[32:47]
    ds_read_b128 v[80:83], v1 offset:22528
    s_waitcnt lgkmcnt(4)
    v_mfma_f32_32x32x16_bf16 v[48:63], v[88:91], a[80:83], v[48:63]
    ds_read_b128 v[84:87], v1 offset:52224
    s_waitcnt vmcnt(6)
    s_waitcnt lgkmcnt(4)
    v_mfma_f32_32x32x16_bf16 v[16:31], v[92:95], a[84:87], v[16:31]
    ds_read_b128 v[88:91], v2 offset:16384
    s_waitcnt lgkmcnt(4)
    v_mfma_f32_32x32x16_bf16 v[32:47], a[116:119], a[84:87], v[32:47]
    ds_read_b128 v[92:95], v1 offset:23552
    s_waitcnt lgkmcnt(4)
    v_mfma_f32_32x32x16_bf16 v[48:63], a[120:123], a[84:87], v[48:63]
    ds_read_b128 a[116:119], v1 offset:53248
    s_waitcnt vmcnt(5)
    s_waitcnt lgkmcnt(4)
    v_mfma_f32_32x32x16_bf16 v[16:31], v[80:83], a[88:91], v[16:31]
    ds_read_b128 a[120:123], v2 offset:17408
    s_waitcnt lgkmcnt(4)
    v_mfma_f32_32x32x16_bf16 v[32:47], v[84:87], a[88:91], v[32:47]
    ds_read_b128 v[80:83], v1 offset:24576
    s_waitcnt lgkmcnt(4)
    v_mfma_f32_32x32x16_bf16 v[48:63], v[88:91], a[88:91], v[48:63]
    ds_read_b128 v[84:87], v1 offset:54272
    s_waitcnt vmcnt(4)
    s_waitcnt lgkmcnt(4)
    v_mfma_f32_32x32x16_bf16 v[16:31], v[92:95], a[92:95], v[16:31]
    ds_read_b128 v[88:91], v2 offset:18432
    s_waitcnt lgkmcnt(4)
    v_mfma_f32_32x32x16_bf16 v[32:47], a[116:119], a[92:95], v[32:47]
    ds_read_b128 v[92:95], v1 offset:25600
    s_waitcnt lgkmcnt(4)
    v_mfma_f32_32x32x16_bf16 v[48:63], a[120:123], a[92:95], v[48:63]
    ds_read_b128 a[116:119], v1 offset:55296
    s_waitcnt vmcnt(3)
    s_waitcnt lgkmcnt(4)
    v_mfma_f32_32x32x16_bf16 v[16:31], v[80:83], a[96:99], v[16:31]
    ds_read_b128 a[120:123], v2 offset:19456
    s_waitcnt lgkmcnt(4)
    v_mfma_f32_32x32x16_bf16 v[32:47], v[84:87], a[96:99], v[32:47]
    ds_read_b128 v[80:83], v1 offset:26624
    s_waitcnt lgkmcnt(4)
    v_mfma_f32_32x32x16_bf16 v[48:63], v[88:91], a[96:99], v[48:63]
    ds_read_b128 v[84:87], v1 offset:56320
    s_waitcnt vmcnt(2)
    s_waitcnt lgkmcnt(4)
    v_mfma_f32_32x32x16_bf16 v[16:31], v[92:95], a[100:103], v[16:31]
    ds_read_b128 v[88:91], v2 offset:20480
    s_waitcnt lgkmcnt(4)
    v_mfma_f32_32x32x16_bf16 v[32:47], a[116:119], a[100:103], v[32:47]
    ds_read_b128 v[92:95], v1 offset:27648
    s_waitcnt lgkmcnt(4)
    v_mfma_f32_32x32x16_bf16 v[48:63], a[120:123], a[100:103], v[48:63]
    ds_read_b128 a[116:119], v1 offset:57344
    v_mov_b32 v116, 149008
    ds_read_b128 v[116:119], v116
    s_waitcnt vmcnt(1)
    s_waitcnt lgkmcnt(5)
    v_mfma_f32_32x32x16_bf16 v[16:31], v[80:83], a[104:107], v[16:31]
    ds_read_b128 a[120:123], v2 offset:21504
    s_waitcnt lgkmcnt(5)
    v_mfma_f32_32x32x16_bf16 v[32:47], v[84:87], a[104:107], v[32:47]
    ds_read_b128 v[80:83], v1 offset:28672
    s_waitcnt lgkmcnt(5)
    v_mfma_f32_32x32x16_bf16 v[48:63], v[88:91], a[104:107], v[48:63]
    ds_read_b128 v[84:87], v1 offset:58368
    s_waitcnt vmcnt(0)
    s_waitcnt lgkmcnt(5)
    v_mfma_f32_32x32x16_bf16 v[16:31], v[92:95], a[108:111], v[16:31]
    ds_read_b128 v[88:91], v2 offset:22528
    s_waitcnt lgkmcnt(5)
    v_mfma_f32_32x32x16_bf16 v[32:47], a[116:119], a[108:111], v[32:47]
    s_waitcnt lgkmcnt(4)
    v_min3_u32 v116, v116, v117, v118
    v_min_u32 v116, v116, v119
    v_cmp_gt_u32 vcc, 16, v116
    s_nop 1
    s_cbranch_vccz Lc136d
    s_nop 4
    s_mov_b32 s25, 2000000
Lc136:
    s_nop 0
    s_sleep 1
    v_mov_b32 v116, 149008
    ds_read_b128 v[116:119], v116
    s_waitcnt lgkmcnt(0)
    v_min3_u32 v116, v116, v117, v118
    v_min_u32 v116, v116, v119
    v_cmp_gt_u32 vcc, 16, v116
    s_nop 1
    s_cbranch_vccz Lc136d
    s_sub_u32 s25, s25, 1
    s_cmp_lg_u32 s25, 0
    s_cbranch_scc1 Lc136
    s_nop 0
Lc136d:
    ds_read_b128 v[92:95], v2 offset:23552
    s_waitcnt lgkmcnt(4)
    v_mfma_f32_32x32x16_bf16 v[48:63], a[120:123], a[108:111], v[48:63]
    ds_read_b128 a[116:119], v2 offset:24576
    s_waitcnt lgkmcnt(4)
    v_mfma_f32_32x32x16_bf16 v[16:31], v[80:83], a[112:115], v[16:31]
    ds_read_b128 a[120:123], v2 offset:25600
    s_waitcnt lgkmcnt(4)
    v_mfma_f32_32x32x16_bf16 v[32:47], v[84:87], a[112:115], v[32:47]
    ds_read_b128 v[80:83], v2 offset:26624
    s_waitcnt lgkmcnt(4)
    v_mfma_f32_32x32x16_bf16 v[48:63], v[88:91], a[112:115], v[48:63]
    ds_read_b128 v[84:87], v2 offset:27648
    s_waitcnt lgkmcnt(4)
    v_mfma_f32_32x32x16_bf16 v[64:79], v[92:95], a[0:3], 0
    ds_read_b128 v[88:91], v2 offset:28672
    v_mov_b32 v125, 33
    ds_write_b32 v126, v125
    s_waitcnt lgkmcnt(5)
    v_mfma_f32_32x32x16_bf16 v[64:79], a[116:119], a[4:7], v[64:79]
    ds_read_b128 v[92:95], v2 offset:29696
    v_mul_f32 v96, v16, v16
    v_mul_f32 v97, v17, v17
    v_mul_f32 v98, v18, v18
    v_mul_f32 v99, v19, v19
    v_mul_f32 v100, v20, v20
    s_waitcnt lgkmcnt(5)
    v_mfma_f32_32x32x16_bf16 v[64:79], a[120:123], a[8:11], v[64:79]
    ds_read_b128 a[116:119], v2 offset:30720
    v_mul_f32 v101, v21, v21
    v_mul_f32 v102, v22, v22
    v_mul_f32 v103, v23, v23
    v_fma_f32 v96, v96, v14, v13
    v_fma_f32 v97, v97, v14, v13
    s_waitcnt lgkmcnt(5)
    v_mfma_f32_32x32x16_bf16 v[64:79], v[80:83], a[12:15], v[64:79]
    ds_read_b128 a[120:123], v2 offset:31744
    v_fma_f32 v98, v98, v14, v13
    v_fma_f32 v99, v99, v14, v13
    v_fma_f32 v100, v100, v14, v13
    v_fma_f32 v101, v101, v14, v13
    v_fma_f32 v102, v102, v14, v13
    s_waitcnt lgkmcnt(5)
    v_mfma_f32_32x32x16_bf16 v[64:79], v[84:87], a[16:19], v[64:79]
    ds_read_b128 v[80:83], v2 offset:32768
    v_fma_f32 v103, v103, v14, v13
    v_mul_f32 v96, v96, v16
    v_mul_f32 v97, v97, v17
    v_mul_f32 v98, v98, v18
    v_mul_f32 v99, v99, v19
    s_waitcnt lgkmcnt(5)
    v_mfma_f32_32x32x16_bf16 v[64:79], v[88:91], a[20:23], v[64:79]
    ds_read_b128 v[84:87], v2 offset:33792
    v_mul_f32 v100, v100, v20
    v_mul_f32 v101, v101, v21
    v_mul_f32 v102, v102, v22
    v_mul_f32 v103, v103, v23
    v_exp_f32 v96, v96
    s_waitcnt lgkmcnt(4)
    v_mfma_f32_32x32x16_bf16 v[64:79], v[92:95], a[24:27], v[64:79]
    ds_read_b128 v[88:91], v2 offset:34816
    v_mul_f32 v16, v16, v24
    v_exp_f32 v97, v97
    v_mul_f32 v17, v17, v25
    v_exp_f32 v98, v98
    s_waitcnt lgkmcnt(4)
    v_mfma_f32_32x32x16_bf16 v[64:79], a[116:119], a[28:31], v[64:79]
    ds_read_b128 v[92:95], v2 offset:35840
    v_mul_f32 v18, v18, v26
    v_exp_f32 v99, v99
    v_mul_f32 v19, v19, v27
    v_exp_f32 v100, v100
    s_waitcnt lgkmcnt(4)
    v_mfma_f32_32x32x16_bf16 v[64:79], a[120:123], a[32:35], v[64:79]
    ds_read_b128 a[116:119], v2 offset:36864
    v_mul_f32 v20, v20, v28
    v_exp_f32 v101, v101
    v_mul_f32 v21, v21, v29
    v_exp_f32 v102, v102
    s_waitcnt lgkmcnt(4)
    v_mfma_f32_32x32x16_bf16 v[64:79], v[80:83], a[36:39], v[64:79]
    ds_read_b128 a[120:123], v2 offset:37888
    v_mul_f32 v22, v22, v30
    v_exp_f32 v103, v103
    v_mul_f32 v23, v23, v31
    v_fma_f32 v96, v96, v12, v12
    s_waitcnt lgkmcnt(4)
    v_mfma_f32_32x32x16_bf16 v[64:79], v[84:87], a[40:43], v[64:79]
    ds_read_b128 v[80:83], v2 offset:38912
    v_fma_f32 v97, v97, v12, v12
    v_fma_f32 v98, v98, v12, v12
    v_fma_f32 v99, v99, v12, v12
    v_fma_f32 v100, v100, v12, v12
    v_fma_f32 v101, v101, v12, v12
    s_waitcnt lgkmcnt(4)
    v_mfma_f32_32x32x16_bf16 v[64:79], v[88:91], a[44:47], v[64:79]
    ds_read_b128 v[84:87], v2 offset:39936
    v_fma_f32 v102, v102, v12, v12
    v_fma_f32 v103, v103, v12, v12
    v_rcp_f32 v96, v96
    v_rcp_f32 v97, v97
    s_waitcnt lgkmcnt(4)
    v_mfma_f32_32x32x16_bf16 v[64:79], v[92:95], a[48:51], v[64:79]
    ds_read_b128 v[88:91], v2 offset:40960
    v_rcp_f32 v98, v98
    v_rcp_f32 v99, v99
    v_rcp_f32 v100, v100
    s_waitcnt lgkmcnt(4)
    v_mfma_f32_32x32x16_bf16 v[64:79], a[116:119], a[52:55], v[64:79]
    ds_read_b128 v[92:95], v2 offset:41984
    v_rcp_f32 v101, v101
    v_rcp_f32 v102, v102
    v_rcp_f32 v103, v103
    s_waitcnt lgkmcnt(4)
    v_mfma_f32_32x32x16_bf16 v[64:79], a[120:123], a[56:59], v[64:79]
    ds_read_b128 a[116:119], v2 offset:43008
    v_mul_f32 v96, v16, v96
    v_mul_f32 v97, v17, v97
    v_mul_f32 v98, v18, v98
    v_mul_f32 v99, v19, v99
    v_mul_f32 v100, v20, v100
    s_waitcnt lgkmcnt(4)
    v_mfma_f32_32x32x16_bf16 v[64:79], v[80:83], a[60:63], v[64:79]
    ds_read_b128 a[120:123], v2 offset:44032
    v_mul_f32 v101, v21, v101
    v_mul_f32 v102, v22, v102
    v_mul_f32 v103, v23, v103
    v_cvt_pk_bf16_f32 v104, v96, v97
    v_cvt_pk_bf16_f32 v105, v98, v99
    s_waitcnt lgkmcnt(4)
    v_mfma_f32_32x32x16_bf16 v[64:79], v[84:87], a[64:67], v[64:79]
    ds_read_b128 v[80:83], v2 offset:45056
    v_cvt_pk_bf16_f32 v106, v100, v101
    v_cvt_pk_bf16_f32 v107, v102, v103
    buffer_store_dwordx4 v[104:107], v1, s[4:7], s24 offen offset:0 sc1
    v_mul_f32 v96, v32, v32
    v_mul_f32 v97, v33, v33
    s_waitcnt lgkmcnt(4)
    v_mfma_f32_32x32x16_bf16 v[64:79], v[88:91], a[68:71], v[64:79]
    ds_read_b128 v[84:87], v2 offset:46080
    v_mul_f32 v98, v34, v34
    v_mul_f32 v99, v35, v35
    v_mul_f32 v100, v36, v36
    v_mul_f32 v101, v37, v37
    v_mul_f32 v102, v38, v38
    s_waitcnt lgkmcnt(4)
    v_mfma_f32_32x32x16_bf16 v[64:79], v[92:95], a[72:75], v[64:79]
    ds_read_b128 v[88:91], v2 offset:47104
    v_mul_f32 v103, v39, v39
    v_fma_f32 v96, v96, v14, v13
    v_fma_f32 v97, v97, v14, v13
    v_fma_f32 v98, v98, v14, v13
    v_fma_f32 v99, v99, v14, v13
    s_waitcnt lgkmcnt(4)
    v_mfma_f32_32x32x16_bf16 v[64:79], a[116:119], a[76:79], v[64:79]
    ds_read_b128 v[92:95], v2 offset:48128
    v_mov_b32 v116, 149008
    ds_read_b128 v[116:119], v116
    v_fma_f32 v100, v100, v14, v13
    v_fma_f32 v101, v101, v14, v13
    v_fma_f32 v102, v102, v14, v13
    v_fma_f32 v103, v103, v14, v13
    v_mul_f32 v96, v96, v32
    s_waitcnt lgkmcnt(5)
    v_mfma_f32_32x32x16_bf16 v[64:79], a[120:123], a[80:83], v[64:79]
    ds_read_b128 a[116:119], v2 offset:49152
    v_mul_f32 v97, v97, v33
    v_mul_f32 v98, v98, v34
    v_mul_f32 v99, v99, v35
    v_mul_f32 v100, v100, v36
    v_mul_f32 v101, v101, v37
    s_waitcnt lgkmcnt(5)
    v_mfma_f32_32x32x16_bf16 v[64:79], v[80:83], a[84:87], v[64:79]
    ds_read_b128 a[120:123], v2 offset:50176
    v_mul_f32 v102, v102, v38
    v_mul_f32 v103, v103, v39
    v_exp_f32 v96, v96
    v_mul_f32 v32, v32, v40
    s_waitcnt lgkmcnt(5)
    v_mfma_f32_32x32x16_bf16 v[64:79], v[84:87], a[88:91], v[64:79]
    ds_read_b128 v[80:83], v2 offset:51200
    v_exp_f32 v97, v97
    v_mul_f32 v33, v33, v41
    v_exp_f32 v98, v98
    s_waitcnt lgkmcnt(5)
    v_mfma_f32_32x32x16_bf16 v[64:79], v[88:91], a[92:95], v[64:79]
    ds_read_b128 v[84:87], v2 offset:52224
    v_mul_f32 v34, v34, v42
    v_exp_f32 v99, v99
    v_mul_f32 v35, v35, v43
    v_exp_f32 v100, v100
    s_waitcnt lgkmcnt(5)
    v_mfma_f32_32x32x16_bf16 v[64:79], v[92:95], a[96:99], v[64:79]
    s_waitcnt lgkmcnt(4)
    v_min3_u32 v116, v116, v117, v118
    v_min_u32 v116, v116, v119
    v_cmp_gt_u32 vcc, 17, v116
    s_nop 1
    s_cbranch_vccz Lc137d
    s_nop 4
    s_mov_b32 s25, 2000000
Lc137:
    s_nop 0
    s_sleep 1
    v_mov_b32 v116, 149008
    ds_read_b128 v[116:119], v116
    s_waitcnt lgkmcnt(0)
    v_min3_u32 v116, v116, v117, v118
    v_min_u32 v116, v116, v119
    v_cmp_gt_u32 vcc, 17, v116
    s_nop 1
    s_cbranch_vccz Lc137d
    s_sub_u32 s25, s25, 1
    s_cmp_lg_u32 s25, 0
    s_cbranch_scc1 Lc137
    s_nop 0
Lc137d:
    ds_read_b128 v[88:91], v2 offset:53248
    v_mul_f32 v36, v36, v44
    v_exp_f32 v101, v101
    v_mul_f32 v37, v37, v45
    v_exp_f32 v102, v102
    s_waitcnt lgkmcnt(4)
    v_mfma_f32_32x32x16_bf16 v[64:79], a[116:119], a[100:103], v[64:79]
    ds_read_b128 v[92:95], v2 offset:54272
    v_mul_f32 v38, v38, v46
    v_exp_f32 v103, v103
    v_mul_f32 v39, v39, v47
    v_fma_f32 v96, v96, v12, v12
    s_waitcnt lgkmcnt(4)
    v_mfma_f32_32x32x16_bf16 v[64:79], a[120:123], a[104:107], v[64:79]
    ds_read_b128 a[116:119], v2 offset:55296
    v_fma_f32 v97, v97, v12, v12
    v_fma_f32 v98, v98, v12, v12
    v_fma_f32 v99, v99, v12, v12
    v_fma_f32 v100, v100, v12, v12
    v_fma_f32 v101, v101, v12, v12
    s_waitcnt lgkmcnt(4)
    v_mfma_f32_32x32x16_bf16 v[64:79], v[80:83], a[108:111], v[64:79]
    ds_read_b128 a[120:123], v2 offset:56320
    v_fma_f32 v102, v102, v12, v12
    v_fma_f32 v103, v103, v12, v12
    v_rcp_f32 v96, v96
    v_rcp_f32 v97, v97
    s_waitcnt lgkmcnt(4)
    v_mfma_f32_32x32x16_bf16 v[64:79], v[84:87], a[112:115], v[64:79]
    ds_read_b128 v[80:83], v2 offset:57344
    v_rcp_f32 v98, v98
    v_rcp_f32 v99, v99
    v_rcp_f32 v100, v100
    s_waitcnt lgkmcnt(4)
    v_mfma_f32_32x32x16_bf16 v[16:31], v[88:91], a[0:3], 0
    ds_read_b128 v[84:87], v2 offset:58368
    v_mov_b32 v125, 34
    ds_write_b32 v126, v125
    v_rcp_f32 v101, v101
    v_rcp_f32 v102, v102
    v_rcp_f32 v103, v103
    s_waitcnt lgkmcnt(5)
    v_mfma_f32_32x32x16_bf16 v[16:31], v[92:95], a[4:7], v[16:31]
    ds_read_b128 v[88:91], v2 offset:59392
    v_mul_f32 v96, v32, v96
    v_mul_f32 v97, v33, v97
    v_mul_f32 v98, v34, v98
    v_mul_f32 v99, v35, v99
    v_mul_f32 v100, v36, v100
    s_waitcnt lgkmcnt(5)
    v_mfma_f32_32x32x16_bf16 v[16:31], a[116:119], a[8:11], v[16:31]
    ds_read_b128 v[92:95], v2 offset:60416
    v_mul_f32 v101, v37, v101
    v_mul_f32 v102, v38, v102
    v_mul_f32 v103, v39, v103
    v_cvt_pk_bf16_f32 v8, v96, v97
    v_cvt_pk_bf16_f32 v9, v98, v99
    s_waitcnt lgkmcnt(5)
    v_mfma_f32_32x32x16_bf16 v[16:31], a[120:123], a[12:15], v[16:31]
    ds_read_b128 a[116:119], v2 offset:61440
    v_cvt_pk_bf16_f32 v10, v100, v101
    v_cvt_pk_bf16_f32 v11, v102, v103
    buffer_store_dwordx4 v[8:11], v1, s[4:7], s24 offen offset:1024 sc1
    v_mul_f32 v96, v48, v48
    v_mul_f32 v97, v49, v49
    s_waitcnt lgkmcnt(5)
    v_mfma_f32_32x32x16_bf16 v[16:31], v[80:83], a[16:19], v[16:31]
    ds_read_b128 a[120:123], v2 offset:62464
    v_mul_f32 v98, v50, v50
    v_mul_f32 v99, v51, v51
    v_mul_f32 v100, v52, v52
    v_mul_f32 v101, v53, v53
    v_mul_f32 v102, v54, v54
    s_waitcnt lgkmcnt(5)
    v_mfma_f32_32x32x16_bf16 v[16:31], v[84:87], a[20:23], v[16:31]
    ds_read_b128 v[80:83], v2 offset:63488
    v_mul_f32 v103, v55, v55
    v_fma_f32 v96, v96, v14, v13
    v_fma_f32 v97, v97, v14, v13
    v_fma_f32 v98, v98, v14, v13
    v_fma_f32 v99, v99, v14, v13
    s_waitcnt lgkmcnt(4)
    v_mfma_f32_32x32x16_bf16 v[16:31], v[88:91], a[24:27], v[16:31]
    ds_read_b128 v[84:87], v2 offset:64512
    v_fma_f32 v100, v100, v14, v13
    v_fma_f32 v101, v101, v14, v13
    v_fma_f32 v102, v102, v14, v13
    v_fma_f32 v103, v103, v14, v13
    v_mul_f32 v96, v96, v48
    s_waitcnt lgkmcnt(4)
    v_mfma_f32_32x32x16_bf16 v[16:31], v[92:95], a[28:31], v[16:31]
    ds_read_b128 v[88:91], v3 offset:0
    v_mul_f32 v97, v97, v49
    v_mul_f32 v98, v98, v50
    v_mul_f32 v99, v99, v51
    v_mul_f32 v100, v100, v52
    v_mul_f32 v101, v101, v53
    s_waitcnt lgkmcnt(4)
    v_mfma_f32_32x32x16_bf16 v[16:31], a[116:119], a[32:35], v[16:31]
    ds_read_b128 v[92:95], v3 offset:1024
    v_mul_f32 v102, v102, v54
    v_mul_f32 v103, v103, v55
    v_exp_f32 v96, v96
    v_mul_f32 v48, v48, v56
    s_waitcnt lgkmcnt(4)
    v_mfma_f32_32x32x16_bf16 v[16:31], a[120:123], a[36:39], v[16:31]
    ds_read_b128 a[116:119], v3 offset:2048
    v_exp_f32 v97, v97
    v_mul_f32 v49, v49, v57
    v_exp_f32 v98, v98
    s_waitcnt lgkmcnt(4)
    v_mfma_f32_32x32x16_bf16 v[16:31], v[80:83], a[40:43], v[16:31]
    ds_read_b128 a[120:123], v3 offset:3072
    v_mul_f32 v50, v50, v58
    v_exp_f32 v99, v99
    v_mul_f32 v51, v51, v59
    v_exp_f32 v100, v100
    s_waitcnt lgkmcnt(4)
    v_mfma_f32_32x32x16_bf16 v[16:31], v[84:87], a[44:47], v[16:31]
    ds_read_b128 v[80:83], v3 offset:4096
    v_mul_f32 v52, v52, v60
    v_exp_f32 v101, v101
    v_mul_f32 v53, v53, v61
    v_exp_f32 v102, v102
    s_waitcnt lgkmcnt(4)
    v_mfma_f32_32x32x16_bf16 v[16:31], v[88:91], a[48:51], v[16:31]
    ds_read_b128 v[84:87], v3 offset:5120
    v_mul_f32 v54, v54, v62
    v_exp_f32 v103, v103
    v_mul_f32 v55, v55, v63
    v_fma_f32 v96, v96, v12, v12
    s_waitcnt lgkmcnt(4)
    v_mfma_f32_32x32x16_bf16 v[16:31], v[92:95], a[52:55], v[16:31]
    ds_read_b128 v[88:91], v3 offset:6144
    v_fma_f32 v97, v97, v12, v12
    v_fma_f32 v98, v98, v12, v12
    v_fma_f32 v99, v99, v12, v12
    v_fma_f32 v100, v100, v12, v12
    v_fma_f32 v101, v101, v12, v12
    s_waitcnt lgkmcnt(4)
    v_mfma_f32_32x32x16_bf16 v[16:31], a[116:119], a[56:59], v[16:31]
    ds_read_b128 v[92:95], v3 offset:7168
    v_fma_f32 v102, v102, v12, v12
    v_fma_f32 v103, v103, v12, v12
    v_rcp_f32 v96, v96
    v_rcp_f32 v97, v97
    s_waitcnt lgkmcnt(4)
    v_mfma_f32_32x32x16_bf16 v[16:31], a[120:123], a[60:63], v[16:31]
    ds_read_b128 a[116:119], v3 offset:8192
    v_rcp_f32 v98, v98
    v_rcp_f32 v99, v99
    v_rcp_f32 v100, v100
    s_waitcnt lgkmcnt(4)
    v_mfma_f32_32x32x16_bf16 v[16:31], v[80:83], a[64:67], v[16:31]
    ds_read_b128 a[120:123], v3 offset:9216
    v_rcp_f32 v101, v101
    v_rcp_f32 v102, v102
    v_rcp_f32 v103, v103
    s_waitcnt lgkmcnt(4)
    v_mfma_f32_32x32x16_bf16 v[16:31], v[84:87], a[68:71], v[16:31]
    ds_read_b128 v[80:83], v3 offset:10240
    v_mul_f32 v96, v48, v96
    v_mul_f32 v97, v49, v97
    v_mul_f32 v98, v50, v98
    v_mul_f32 v99, v51, v99
    v_mul_f32 v100, v52, v100
    s_waitcnt lgkmcnt(4)
    v_mfma_f32_32x32x16_bf16 v[16:31], v[88:91], a[72:75], v[16:31]
    ds_read_b128 v[84:87], v3 offset:11264
    v_mul_f32 v101, v53, v101
    v_mul_f32 v102, v54, v102
    v_mul_f32 v103, v55, v103
    v_cvt_pk_bf16_f32 v104, v96, v97
    v_cvt_pk_bf16_f32 v105, v98, v99
    s_waitcnt lgkmcnt(4)
    v_mfma_f32_32x32x16_bf16 v[16:31], v[92:95], a[76:79], v[16:31]
    ds_read_b128 v[88:91], v3 offset:12288
    v_mov_b32 v116, 149008
    ds_read_b128 v[116:119], v116
    v_cvt_pk_bf16_f32 v106, v100, v101
    v_cvt_pk_bf16_f32 v107, v102, v103
    buffer_store_dwordx4 v[104:107], v1, s[4:7], s24 offen offset:2048 sc1
    v_mul_f32 v96, v64, v64
    v_mul_f32 v97, v65, v65
    s_waitcnt lgkmcnt(5)
    v_mfma_f32_32x32x16_bf16 v[16:31], a[116:119], a[80:83], v[16:31]
    ds_read_b128 v[92:95], v3 offset:13312
    v_mul_f32 v98, v66, v66
    v_mul_f32 v99, v67, v67
    v_mul_f32 v100, v68, v68
    v_mul_f32 v101, v69, v69
    v_mul_f32 v102, v70, v70
    s_waitcnt lgkmcnt(5)
    v_mfma_f32_32x32x16_bf16 v[16:31], a[120:123], a[84:87], v[16:31]
    ds_read_b128 a[116:119], v3 offset:14336
    v_mul_f32 v103, v71, v71
    v_fma_f32 v96, v96, v14, v13
    v_fma_f32 v97, v97, v14, v13
    v_fma_f32 v98, v98, v14, v13
    v_fma_f32 v99, v99, v14, v13
    s_waitcnt lgkmcnt(5)
    v_mfma_f32_32x32x16_bf16 v[16:31], v[80:83], a[88:91], v[16:31]
    ds_read_b128 a[120:123], v3 offset:15360
    v_fma_f32 v100, v100, v14, v13
    v_fma_f32 v101, v101, v14, v13
    v_fma_f32 v102, v102, v14, v13
    v_fma_f32 v103, v103, v14, v13
    v_mul_f32 v96, v96, v64
    s_waitcnt lgkmcnt(5)
    v_mfma_f32_32x32x16_bf16 v[16:31], v[84:87], a[92:95], v[16:31]
    ds_read_b128 v[80:83], v3 offset:16384
    v_mul_f32 v97, v97, v65
    v_mul_f32 v98, v98, v66
    v_mul_f32 v99, v99, v67
    v_mul_f32 v100, v100, v68
    v_mul_f32 v101, v101, v69
    s_waitcnt lgkmcnt(5)
    v_mfma_f32_32x32x16_bf16 v[16:31], v[88:91], a[96:99], v[16:31]
    s_waitcnt lgkmcnt(4)
    v_min3_u32 v116, v116, v117, v118
    v_min_u32 v116, v116, v119
    v_cmp_gt_u32 vcc, 18, v116
    s_nop 1
    s_cbranch_vccz Lc138d
    s_nop 4
    s_mov_b32 s25, 2000000
Lc138:
    s_nop 0
    s_sleep 1
    v_mov_b32 v116, 149008
    ds_read_b128 v[116:119], v116
    s_waitcnt lgkmcnt(0)
    v_min3_u32 v116, v116, v117, v118
    v_min_u32 v116, v116, v119
    v_cmp_gt_u32 vcc, 18, v116
    s_nop 1
    s_cbranch_vccz Lc138d
    s_sub_u32 s25, s25, 1
    s_cmp_lg_u32 s25, 0
    s_cbranch_scc1 Lc138
    s_nop 0
Lc138d:
    ds_read_b128 v[84:87], v1 offset:0
    v_mul_f32 v102, v102, v70
    v_mul_f32 v103, v103, v71
    v_exp_f32 v96, v96
    v_mul_f32 v64, v64, v72
    s_waitcnt lgkmcnt(4)
    v_mfma_f32_32x32x16_bf16 v[16:31], v[92:95], a[100:103], v[16:31]
    ds_read_b128 v[88:91], v1 offset:1024
    v_exp_f32 v97, v97
    v_mul_f32 v65, v65, v73
    v_exp_f32 v98, v98
    s_waitcnt lgkmcnt(4)
    v_mfma_f32_32x32x16_bf16 v[16:31], a[116:119], a[104:107], v[16:31]
    ds_read_b128 v[92:95], v1 offset:2048
    v_mul_f32 v66, v66, v74
    v_exp_f32 v99, v99
    v_mul_f32 v67, v67, v75
    v_exp_f32 v100, v100
    s_waitcnt lgkmcnt(4)
    v_mfma_f32_32x32x16_bf16 v[16:31], a[120:123], a[108:111], v[16:31]
    ds_read_b128 a[116:119], v1 offset:3072
    v_mul_f32 v68, v68, v76
    v_exp_f32 v101, v101
    v_mul_f32 v69, v69, v77
    v_exp_f32 v102, v102
    s_waitcnt lgkmcnt(4)
    v_mfma_f32_32x32x16_bf16 v[16:31], v[80:83], a[112:115], v[16:31]
    ds_read_b128 a[120:123], v1 offset:4096
    v_mul_f32 v70, v70, v78
    v_exp_f32 v103, v103
    v_mul_f32 v71, v71, v79
    v_fma_f32 v96, v96, v12, v12
    s_waitcnt lgkmcnt(4)
    v_mfma_f32_32x32x16_bf16 v[32:47], v[84:87], a[0:3], 0
    ds_read_b128 v[80:83], v1 offset:5120
    v_mov_b32 v125, 35
    ds_write_b32 v126, v125
    v_fma_f32 v97, v97, v12, v12
    v_fma_f32 v98, v98, v12, v12
    v_fma_f32 v99, v99, v12, v12
    v_fma_f32 v100, v100, v12, v12
    v_fma_f32 v101, v101, v12, v12
    s_waitcnt lgkmcnt(5)
    v_mfma_f32_32x32x16_bf16 v[32:47], v[88:91], a[4:7], v[32:47]
    ds_read_b128 v[84:87], v1 offset:6144
    v_fma_f32 v102, v102, v12, v12
    v_fma_f32 v103, v103, v12, v12
    v_rcp_f32 v96, v96
    v_rcp_f32 v97, v97
    s_waitcnt lgkmcnt(5)
    v_mfma_f32_32x32x16_bf16 v[32:47], v[92:95], a[8:11], v[32:47]
    ds_read_b128 v[88:91], v1 offset:7168
    v_rcp_f32 v98, v98
    v_rcp_f32 v99, v99
    v_rcp_f32 v100, v100
    s_waitcnt lgkmcnt(5)
    v_mfma_f32_32x32x16_bf16 v[32:47], a[116:119], a[12:15], v[32:47]
    ds_read_b128 v[92:95], v1 offset:8192
    v_rcp_f32 v101, v101
    v_rcp_f32 v102, v102
    v_rcp_f32 v103, v103
    s_waitcnt lgkmcnt(5)
    v_mfma_f32_32x32x16_bf16 v[32:47], a[120:123], a[16:19], v[32:47]
    ds_read_b128 a[116:119], v1 offset:9216
    v_mul_f32 v96, v64, v96
    v_mul_f32 v97, v65, v97
    v_mul_f32 v98, v66, v98
    v_mul_f32 v99, v67, v99
    v_mul_f32 v100, v68, v100
    s_waitcnt lgkmcnt(5)
    v_mfma_f32_32x32x16_bf16 v[32:47], v[80:83], a[20:23], v[32:47]
    ds_read_b128 a[120:123], v1 offset:10240
    v_mul_f32 v101, v69, v101
    v_mul_f32 v102, v70, v102
    v_mul_f32 v103, v71, v103
    v_cvt_pk_bf16_f32 v8, v96, v97
    v_cvt_pk_bf16_f32 v9, v98, v99
    s_waitcnt lgkmcnt(4)
    v_mfma_f32_32x32x16_bf16 v[32:47], v[84:87], a[24:27], v[32:47]
    ds_read_b128 v[80:83], v1 offset:11264
    v_cvt_pk_bf16_f32 v10, v100, v101
    v_cvt_pk_bf16_f32 v11, v102, v103
    buffer_store_dwordx4 v[8:11], v1, s[4:7], s24 offen offset:3072 sc1
    v_mul_f32 v96, v16, v16
    v_mul_f32 v97, v17, v17
    s_waitcnt lgkmcnt(4)
    v_mfma_f32_32x32x16_bf16 v[32:47], v[88:91], a[28:31], v[32:47]
    ds_read_b128 v[84:87], v1 offset:12288
    v_mul_f32 v98, v18, v18
    v_mul_f32 v99, v19, v19
    v_mul_f32 v100, v20, v20
    v_mul_f32 v101, v21, v21
    v_mul_f32 v102, v22, v22
    s_waitcnt lgkmcnt(4)
    v_mfma_f32_32x32x16_bf16 v[32:47], v[92:95], a[32:35], v[32:47]
    ds_read_b128 v[88:91], v1 offset:13312
    v_mul_f32 v103, v23, v23
    v_fma_f32 v96, v96, v14, v13
    v_fma_f32 v97, v97, v14, v13
    v_fma_f32 v98, v98, v14, v13
    v_fma_f32 v99, v99, v14, v13
    s_waitcnt lgkmcnt(4)
    v_mfma_f32_32x32x16_bf16 v[32:47], a[116:119], a[36:39], v[32:47]
    ds_read_b128 v[92:95], v1 offset:14336
    v_fma_f32 v100, v100, v14, v13
    v_fma_f32 v101, v101, v14, v13
    v_fma_f32 v102, v102, v14, v13
    v_fma_f32 v103, v103, v14, v13
    v_mul_f32 v96, v96, v16
    s_waitcnt lgkmcnt(4)
    v_mfma_f32_32x32x16_bf16 v[32:47], a[120:123], a[40:43], v[32:47]
    ds_read_b128 a[116:119], v1 offset:15360
    v_mul_f32 v97, v97, v17
    v_mul_f32 v98, v98, v18
    v_mul_f32 v99, v99, v19
    v_mul_f32 v100, v100, v20
    v_mul_f32 v101, v101, v21
    s_waitcnt lgkmcnt(4)
    v_mfma_f32_32x32x16_bf16 v[32:47], v[80:83], a[44:47], v[32:47]
    ds_read_b128 a[120:123], v1 offset:16384
    v_mul_f32 v102, v102, v22
    v_mul_f32 v103, v103, v23
    v_exp_f32 v96, v96
    v_mul_f32 v16, v16, v24
    s_waitcnt lgkmcnt(4)
    v_mfma_f32_32x32x16_bf16 v[32:47], v[84:87], a[48:51], v[32:47]
    ds_read_b128 v[80:83], v1 offset:17408
    v_exp_f32 v97, v97
    v_mul_f32 v17, v17, v25
    v_exp_f32 v98, v98
    s_waitcnt lgkmcnt(4)
    v_mfma_f32_32x32x16_bf16 v[32:47], v[88:91], a[52:55], v[32:47]
    ds_read_b128 v[84:87], v1 offset:18432
    v_mul_f32 v18, v18, v26
    v_exp_f32 v99, v99
    v_mul_f32 v19, v19, v27
    v_exp_f32 v100, v100
    s_waitcnt lgkmcnt(4)
    v_mfma_f32_32x32x16_bf16 v[32:47], v[92:95], a[56:59], v[32:47]
    ds_read_b128 v[88:91], v1 offset:19456
    v_mul_f32 v20, v20, v28
    v_exp_f32 v101, v101
    v_mul_f32 v21, v21, v29
    v_exp_f32 v102, v102
    s_waitcnt lgkmcnt(4)
    v_mfma_f32_32x32x16_bf16 v[32:47], a[116:119], a[60:63], v[32:47]
    ds_read_b128 v[92:95], v1 offset:20480
    v_mul_f32 v22, v22, v30
    v_exp_f32 v103, v103
    v_mul_f32 v23, v23, v31
    v_fma_f32 v96, v96, v12, v12
    s_waitcnt lgkmcnt(4)
    v_mfma_f32_32x32x16_bf16 v[32:47], a[120:123], a[64:67], v[32:47]
    ds_read_b128 a[116:119], v1 offset:21504
    v_fma_f32 v97, v97, v12, v12
    v_fma_f32 v98, v98, v12, v12
    v_fma_f32 v99, v99, v12, v12
    v_fma_f32 v100, v100, v12, v12
    v_fma_f32 v101, v101, v12, v12
    s_waitcnt lgkmcnt(4)
    v_mfma_f32_32x32x16_bf16 v[32:47], v[80:83], a[68:71], v[32:47]
    ds_read_b128 a[120:123], v1 offset:22528
    v_fma_f32 v102, v102, v12, v12
    v_fma_f32 v103, v103, v12, v12
    v_rcp_f32 v96, v96
    v_rcp_f32 v97, v97
    s_waitcnt lgkmcnt(4)
    v_mfma_f32_32x32x16_bf16 v[32:47], v[84:87], a[72:75], v[32:47]
    ds_read_b128 v[80:83], v1 offset:23552
    v_rcp_f32 v98, v98
    v_rcp_f32 v99, v99
    v_rcp_f32 v100, v100
    s_waitcnt lgkmcnt(4)
    v_mfma_f32_32x32x16_bf16 v[32:47], v[88:91], a[76:79], v[32:47]
    ds_read_b128 v[84:87], v1 offset:24576
    v_mov_b32 v116, 149008
    ds_read_b128 v[116:119], v116
    v_rcp_f32 v101, v101
    v_rcp_f32 v102, v102
    v_rcp_f32 v103, v103
    s_waitcnt lgkmcnt(5)
    v_mfma_f32_32x32x16_bf16 v[32:47], v[92:95], a[80:83], v[32:47]
    ds_read_b128 v[88:91], v1 offset:25600
    v_mul_f32 v96, v16, v96
    v_mul_f32 v97, v17, v97
    v_mul_f32 v98, v18, v98
    v_mul_f32 v99, v19, v99
    v_mul_f32 v100, v20, v100
    s_waitcnt lgkmcnt(5)
    v_mfma_f32_32x32x16_bf16 v[32:47], a[116:119], a[84:87], v[32:47]
    ds_read_b128 v[92:95], v1 offset:26624
    v_mul_f32 v101, v21, v101
    v_mul_f32 v102, v22, v102
    v_mul_f32 v103, v23, v103
    v_cvt_pk_bf16_f32 v104, v96, v97
    v_cvt_pk_bf16_f32 v105, v98, v99
    s_waitcnt lgkmcnt(5)
    v_mfma_f32_32x32x16_bf16 v[32:47], a[120:123], a[88:91], v[32:47]
    ds_read_b128 a[116:119], v1 offset:27648
    v_cvt_pk_bf16_f32 v106, v100, v101
    v_cvt_pk_bf16_f32 v107, v102, v103
    buffer_store_dwordx4 v[104:107], v1, s[4:7], s22 offen offset:0 sc1
    s_waitcnt lgkmcnt(5)
    v_mfma_f32_32x32x16_bf16 v[32:47], v[80:83], a[92:95], v[32:47]
    ds_read_b128 a[120:123], v1 offset:28672
    s_waitcnt lgkmcnt(5)
    v_mfma_f32_32x32x16_bf16 v[32:47], v[84:87], a[96:99], v[32:47]
    s_waitcnt lgkmcnt(4)
    v_min3_u32 v116, v116, v117, v118
    v_min_u32 v116, v116, v119
    v_cmp_gt_u32 vcc, 19, v116
    s_nop 1
    s_cbranch_vccz Lc139d
    s_nop 4
    s_mov_b32 s25, 2000000
Lc139:
    s_nop 0
    s_sleep 1
    v_mov_b32 v116, 149008
    ds_read_b128 v[116:119], v116
    s_waitcnt lgkmcnt(0)
    v_min3_u32 v116, v116, v117, v118
    v_min_u32 v116, v116, v119
    v_cmp_gt_u32 vcc, 19, v116
    s_nop 1
    s_cbranch_vccz Lc139d
    s_sub_u32 s25, s25, 1
    s_cmp_lg_u32 s25, 0
    s_cbranch_scc1 Lc139
    s_nop 0
Lc139d:
    ds_read_b128 v[80:83], v1 offset:29696
    s_waitcnt lgkmcnt(4)
    v_mfma_f32_32x32x16_bf16 v[32:47], v[88:91], a[100:103], v[32:47]
    ds_read_b128 v[84:87], v1 offset:30720
    s_waitcnt lgkmcnt(4)
    v_mfma_f32_32x32x16_bf16 v[32:47], v[92:95], a[104:107], v[32:47]
    ds_read_b128 v[88:91], v1 offset:31744
    s_waitcnt lgkmcnt(4)
    v_mfma_f32_32x32x16_bf16 v[32:47], a[116:119], a[108:111], v[32:47]
    ds_read_b128 v[92:95], v1 offset:32768
    s_waitcnt lgkmcnt(4)
    v_mfma_f32_32x32x16_bf16 v[32:47], a[120:123], a[112:115], v[32:47]
    ds_read_b128 a[116:119], v1 offset:33792
    s_waitcnt lgkmcnt(4)
    v_mfma_f32_32x32x16_bf16 v[48:63], v[80:83], a[0:3], 0
    ds_read_b128 a[120:123], v1 offset:34816
    v_mov_b32 v125, 36
    ds_write_b32 v126, v125
    s_waitcnt lgkmcnt(5)
    v_mfma_f32_32x32x16_bf16 v[48:63], v[84:87], a[4:7], v[48:63]
    ds_read_b128 v[80:83], v1 offset:35840
    s_nop 2
    v_mul_f32 v96, v32, v32
    v_mul_f32 v97, v33, v33
    v_mul_f32 v98, v34, v34
    v_mul_f32 v99, v35, v35
    v_mul_f32 v100, v36, v36
    s_waitcnt lgkmcnt(5)
    v_mfma_f32_32x32x16_bf16 v[48:63], v[88:91], a[8:11], v[48:63]
    ds_read_b128 v[84:87], v1 offset:36864
    v_mul_f32 v101, v37, v37
    v_mul_f32 v102, v38, v38
    v_mul_f32 v103, v39, v39
    v_fma_f32 v96, v96, v14, v13
    v_fma_f32 v97, v97, v14, v13
    s_waitcnt lgkmcnt(5)
    v_mfma_f32_32x32x16_bf16 v[48:63], v[92:95], a[12:15], v[48:63]
    ds_read_b128 v[88:91], v1 offset:37888
    v_fma_f32 v98, v98, v14, v13
    v_fma_f32 v99, v99, v14, v13
    v_fma_f32 v100, v100, v14, v13
    v_fma_f32 v101, v101, v14, v13
    v_fma_f32 v102, v102, v14, v13
    s_waitcnt lgkmcnt(5)
    v_mfma_f32_32x32x16_bf16 v[48:63], a[116:119], a[16:19], v[48:63]
    ds_read_b128 v[92:95], v1 offset:38912
    v_fma_f32 v103, v103, v14, v13
    v_mul_f32 v96, v96, v32
    v_mul_f32 v97, v97, v33
    v_mul_f32 v98, v98, v34
    v_mul_f32 v99, v99, v35
    s_waitcnt lgkmcnt(5)
    v_mfma_f32_32x32x16_bf16 v[48:63], a[120:123], a[20:23], v[48:63]
    ds_read_b128 a[116:119], v1 offset:39936
    v_mul_f32 v100, v100, v36
    v_mul_f32 v101, v101, v37
    v_mul_f32 v102, v102, v38
    v_mul_f32 v103, v103, v39
    v_exp_f32 v96, v96
    s_waitcnt lgkmcnt(4)
    v_mfma_f32_32x32x16_bf16 v[48:63], v[80:83], a[24:27], v[48:63]
    ds_read_b128 a[120:123], v1 offset:40960
    v_mul_f32 v32, v32, v40
    v_exp_f32 v97, v97
    v_mul_f32 v33, v33, v41
    v_exp_f32 v98, v98
    s_waitcnt lgkmcnt(4)
    v_mfma_f32_32x32x16_bf16 v[48:63], v[84:87], a[28:31], v[48:63]
    ds_read_b128 v[80:83], v1 offset:41984
    v_mul_f32 v34, v34, v42
    v_exp_f32 v99, v99
    v_mul_f32 v35, v35, v43
    v_exp_f32 v100, v100
    s_waitcnt lgkmcnt(4)
    v_mfma_f32_32x32x16_bf16 v[48:63], v[88:91], a[32:35], v[48:63]
    ds_read_b128 v[84:87], v1 offset:43008
    v_mul_f32 v36, v36, v44
    v_exp_f32 v101, v101
    v_mul_f32 v37, v37, v45
    v_exp_f32 v102, v102
    s_waitcnt lgkmcnt(4)
    v_mfma_f32_32x32x16_bf16 v[48:63], v[92:95], a[36:39], v[48:63]
    ds_read_b128 v[88:91], v1 offset:44032
    v_mul_f32 v38, v38, v46
    v_exp_f32 v103, v103
    v_mul_f32 v39, v39, v47
    v_fma_f32 v96, v96, v12, v12
    s_waitcnt lgkmcnt(4)
    v_mfma_f32_32x32x16_bf16 v[48:63], a[116:119], a[40:43], v[48:63]
    ds_read_b128 v[92:95], v1 offset:45056
    v_fma_f32 v97, v97, v12, v12
    v_fma_f32 v98, v98, v12, v12
    v_fma_f32 v99, v99, v12, v12
    v_fma_f32 v100, v100, v12, v12
    v_fma_f32 v101, v101, v12, v12
    s_waitcnt lgkmcnt(4)
    v_mfma_f32_32x32x16_bf16 v[48:63], a[120:123], a[44:47], v[48:63]
    ds_read_b128 a[116:119], v1 offset:46080
    v_fma_f32 v102, v102, v12, v12
    v_fma_f32 v103, v103, v12, v12
    v_rcp_f32 v96, v96
    v_rcp_f32 v97, v97
    s_waitcnt lgkmcnt(4)
    v_mfma_f32_32x32x16_bf16 v[48:63], v[80:83], a[48:51], v[48:63]
    ds_read_b128 a[120:123], v1 offset:47104
    v_rcp_f32 v98, v98
    v_rcp_f32 v99, v99
    v_rcp_f32 v100, v100
    s_waitcnt lgkmcnt(4)
    v_mfma_f32_32x32x16_bf16 v[48:63], v[84:87], a[52:55], v[48:63]
    ds_read_b128 v[80:83], v1 offset:48128
    v_rcp_f32 v101, v101
    v_rcp_f32 v102, v102
    v_rcp_f32 v103, v103
    s_waitcnt lgkmcnt(4)
    v_mfma_f32_32x32x16_bf16 v[48:63], v[88:91], a[56:59], v[48:63]
    ds_read_b128 v[84:87], v1 offset:49152
    v_mul_f32 v96, v32, v96
    v_mul_f32 v97, v33, v97
    v_mul_f32 v98, v34, v98
    v_mul_f32 v99, v35, v99
    v_mul_f32 v100, v36, v100
    s_waitcnt lgkmcnt(4)
    v_mfma_f32_32x32x16_bf16 v[48:63], v[92:95], a[60:63], v[48:63]
    ds_read_b128 v[88:91], v1 offset:50176
    v_mul_f32 v101, v37, v101
    v_mul_f32 v102, v38, v102
    v_mul_f32 v103, v39, v103
    v_cvt_pk_bf16_f32 v8, v96, v97
    v_cvt_pk_bf16_f32 v9, v98, v99
    s_waitcnt lgkmcnt(4)
    v_mfma_f32_32x32x16_bf16 v[48:63], a[116:119], a[64:67], v[48:63]
    ds_read_b128 v[92:95], v1 offset:51200
    v_cvt_pk_bf16_f32 v10, v100, v101
    v_cvt_pk_bf16_f32 v11, v102, v103
    buffer_store_dwordx4 v[8:11], v1, s[4:7], s22 offen offset:1024 sc1
    s_waitcnt lgkmcnt(4)
    v_mfma_f32_32x32x16_bf16 v[48:63], a[120:123], a[68:71], v[48:63]
    ds_read_b128 a[116:119], v1 offset:52224
    s_waitcnt lgkmcnt(4)
    v_mfma_f32_32x32x16_bf16 v[48:63], v[80:83], a[72:75], v[48:63]
    ds_read_b128 a[120:123], v1 offset:53248
    s_waitcnt lgkmcnt(4)
    v_mfma_f32_32x32x16_bf16 v[48:63], v[84:87], a[76:79], v[48:63]
    ds_read_b128 v[80:83], v1 offset:54272
    s_waitcnt lgkmcnt(4)
    v_mfma_f32_32x32x16_bf16 v[48:63], v[88:91], a[80:83], v[48:63]
    ds_read_b128 v[84:87], v1 offset:55296
    s_waitcnt lgkmcnt(4)
    v_mfma_f32_32x32x16_bf16 v[48:63], v[92:95], a[84:87], v[48:63]
    ds_read_b128 v[88:91], v1 offset:56320
    s_waitcnt lgkmcnt(4)
    v_mfma_f32_32x32x16_bf16 v[48:63], a[116:119], a[88:91], v[48:63]
    ds_read_b128 v[92:95], v1 offset:57344
    s_waitcnt lgkmcnt(4)
    v_mfma_f32_32x32x16_bf16 v[48:63], a[120:123], a[92:95], v[48:63]
    ds_read_b128 a[116:119], v1 offset:58368
    s_waitcnt lgkmcnt(4)
    v_mfma_f32_32x32x16_bf16 v[48:63], v[80:83], a[96:99], v[48:63]
    s_waitcnt lgkmcnt(3)
    v_mfma_f32_32x32x16_bf16 v[48:63], v[84:87], a[100:103], v[48:63]
    s_waitcnt lgkmcnt(2)
    v_mfma_f32_32x32x16_bf16 v[48:63], v[88:91], a[104:107], v[48:63]
    s_waitcnt lgkmcnt(1)
    v_mfma_f32_32x32x16_bf16 v[48:63], v[92:95], a[108:111], v[48:63]
    s_waitcnt lgkmcnt(0)
    v_mfma_f32_32x32x16_bf16 v[48:63], a[116:119], a[112:115], v[48:63]
    v_mov_b32 v125, 37
    ds_write_b32 v126, v125
    s_nop 9
    v_mul_f32 v96, v48, v48
    v_mul_f32 v97, v49, v49
    v_mul_f32 v98, v50, v50
    v_mul_f32 v99, v51, v51
    v_mul_f32 v100, v52, v52
    v_mul_f32 v101, v53, v53
    v_mul_f32 v102, v54, v54
    v_mul_f32 v103, v55, v55
    v_fma_f32 v96, v96, v14, v13
    v_fma_f32 v97, v97, v14, v13
    v_fma_f32 v98, v98, v14, v13
    v_fma_f32 v99, v99, v14, v13
    v_fma_f32 v100, v100, v14, v13
    v_fma_f32 v101, v101, v14, v13
    v_fma_f32 v102, v102, v14, v13
    v_fma_f32 v103, v103, v14, v13
    v_mul_f32 v96, v96, v48
    v_mul_f32 v97, v97, v49
    v_mul_f32 v98, v98, v50
    v_mul_f32 v99, v99, v51
    v_mul_f32 v100, v100, v52
    v_mul_f32 v101, v101, v53
    v_mul_f32 v102, v102, v54
    v_mul_f32 v103, v103, v55
    v_exp_f32 v96, v96
    v_mul_f32 v48, v48, v56
    v_exp_f32 v97, v97
    v_mul_f32 v49, v49, v57
    v_exp_f32 v98, v98
    v_mul_f32 v50, v50, v58
    v_exp_f32 v99, v99
    v_mul_f32 v51, v51, v59
    v_exp_f32 v100, v100
    v_mul_f32 v52, v52, v60
    v_exp_f32 v101, v101
    v_mul_f32 v53, v53, v61
    v_exp_f32 v102, v102
    v_mul_f32 v54, v54, v62
    v_exp_f32 v103, v103
    v_mul_f32 v55, v55, v63
    v_fma_f32 v96, v96, v12, v12
    v_fma_f32 v97, v97, v12, v12
    v_fma_f32 v98, v98, v12, v12
    v_fma_f32 v99, v99, v12, v12
    v_fma_f32 v100, v100, v12, v12
    v_fma_f32 v101, v101, v12, v12
    v_fma_f32 v102, v102, v12, v12
    v_fma_f32 v103, v103, v12, v12
    v_rcp_f32 v96, v96
    v_rcp_f32 v97, v97
    v_rcp_f32 v98, v98
    v_rcp_f32 v99, v99
    v_rcp_f32 v100, v100
    v_rcp_f32 v101, v101
    v_rcp_f32 v102, v102
    v_rcp_f32 v103, v103
    v_mul_f32 v96, v48, v96
    v_mul_f32 v97, v49, v97
    v_mul_f32 v98, v50, v98
    v_mul_f32 v99, v51, v99
    v_mul_f32 v100, v52, v100
    v_mul_f32 v101, v53, v101
    v_mul_f32 v102, v54, v102
    v_mul_f32 v103, v55, v103
    v_cvt_pk_bf16_f32 v104, v96, v97
    v_cvt_pk_bf16_f32 v105, v98, v99
    v_cvt_pk_bf16_f32 v106, v100, v101
    v_cvt_pk_bf16_f32 v107, v102, v103
    buffer_store_dwordx4 v[104:107], v1, s[4:7], s22 offen offset:2048 sc1
    v_mov_b32 v4, 9
    v_mov_b32 v5, 0
    s_waitcnt vmcnt(0)
    s_mov_b64 exec, 1
    s_cmp_lg_u32 s45, 0
    s_cbranch_scc1 Ltw140p
    buffer_store_dword v4, v5, s[4:7], s28 offen sc1
    s_branch Ltw140d
Ltw140p:
    buffer_store_dword v4, v5, s[4:7], s28 offen
Ltw140d:
    s_mov_b64 exec, -1
    v_and_b32 v96, 15, v0
    v_lshlrev_b32 v96, 4, v96
    v_lshrrev_b32 v4, 4, v0
    v_lshl_add_u32 v96, v4, 9, v96
    s_mul_i32 s23, s18, 7168
    v_add_u32 v97, s23, v1
    v_add_u32 v98, s23, v2
    v_add_u32 v99, s23, v3
    s_mul_i32 s21, s27, 112
    s_mul_i32 s22, s18, 28
    s_add_u32 s21, s21, s22
    s_lshl_b32 s21, s21, 10
    s_add_u32 s21, s21, 28655616
    v_accvgpr_read_b32 v7, a125
    s_mov_b32 s25, 200000
Lpoll141:
    s_nop 3
    buffer_load_dword v4, v7, s[4:7], 0 offen sc1
    s_waitcnt vmcnt(0)
    v_cmp_gt_u32 vcc, 9, v4
    s_nop 1
    s_cbranch_vccz Lpoll141d
    s_sub_u32 s25, s25, 1
    s_cmp_lg_u32 s25, 0
    s_cbranch_scc1 Lpoll141
Lpoll141d:
    s_nop 0
    s_setprio 0
    buffer_load_dwordx4 a[0:3], v96, s[4:7], s21 offen offset:0
    buffer_load_dwordx4 a[4:7], v96, s[4:7], s21 offen offset:256
    buffer_load_dwordx4 a[8:11], v96, s[4:7], s21 offen offset:2048
    buffer_load_dwordx4 a[12:15], v96, s[4:7], s21 offen offset:2304
    s_add_u32 s21, s21, 4096
    v_mov_b32 v125, 38
    ds_write_b32 v126, v125
    buffer_load_dwordx4 a[16:19], v96, s[4:7], s21 offen offset:0
    buffer_load_dwordx4 a[20:23], v96, s[4:7], s21 offen offset:256
    buffer_load_dwordx4 a[24:27], v96, s[4:7], s21 offen offset:2048
    buffer_load_dwordx4 a[28:31], v96, s[4:7], s21 offen offset:2304
    s_add_u32 s21, s21, 4096
    buffer_load_dwordx4 a[32:35], v96, s[4:7], s21 offen offset:0
    buffer_load_dwordx4 a[36:39], v96, s[4:7], s21 offen offset:256
    buffer_load_dwordx4 a[40:43], v96, s[4:7], s21 offen offset:2048
    buffer_load_dwordx4 a[44:47], v96, s[4:7], s21 offen offset:2304
    s_add_u32 s21, s21, 4096
    buffer_load_dwordx4 a[48:51], v96, s[4:7], s21 offen offset:0
    buffer_load_dwordx4 a[52:55], v96, s[4:7], s21 offen offset:256
    buffer_load_dwordx4 a[56:59], v96, s[4:7], s21 offen offset:2048
    buffer_load_dwordx4 a[60:63], v96, s[4:7], s21 offen offset:2304
    s_add_u32 s21, s21, 4096
    buffer_load_dwordx4 a[64:67], v96, s[4:7], s21 offen offset:0
    buffer_load_dwordx4 a[68:71], v96, s[4:7], s21 offen offset:256
    v_mov_b32 v116, s44
    ds_read_b32 v116, v116
    s_waitcnt lgkmcnt(0)
    v_cmp_gt_u32 vcc, 20, v116
    s_nop 1
    s_cbranch_vccz Lc142d
    s_nop 1
    s_mov_b32 s25, 2000000
Lc142:
    s_nop 0
    s_sleep 1
    v_mov_b32 v116, s44
    ds_read_b32 v116, v116
    s_waitcnt lgkmcnt(0)
    v_cmp_gt_u32 vcc, 20, v116
    s_nop 1
    s_cbranch_vccz Lc142d
    s_sub_u32 s25, s25, 1
    s_cmp_lg_u32 s25, 0
    s_cbranch_scc1 Lc142
    s_nop 0
Lc142d:
    ds_read_b128 v[72:75], v97 offset:59392
    ds_read_b128 v[76:79], v97 offset:60416
    ds_read_b128 v[80:83], v97 offset:61440
    ds_read_b128 v[84:87], v97 offset:62464
    ds_read_b128 v[88:91], v97 offset:63488
    s_waitcnt vmcnt(16)
    s_waitcnt lgkmcnt(4)
    v_mfma_f32_16x16x32_bf16 v[16:19], v[72:75], a[0:3], 0
    v_mfma_f32_16x16x32_bf16 v[44:47], v[72:75], a[4:7], 0
    ds_read_b128 v[92:95], v97 offset:64512
    s_waitcnt lgkmcnt(4)
    v_mfma_f32_16x16x32_bf16 v[20:23], v[76:79], a[0:3], 0
    v_mfma_f32_16x16x32_bf16 v[48:51], v[76:79], a[4:7], 0
    ds_read_b128 v[72:75], v98 offset:0
    s_waitcnt lgkmcnt(4)
    v_mfma_f32_16x16x32_bf16 v[24:27], v[80:83], a[0:3], 0
    v_mfma_f32_16x16x32_bf16 v[52:55], v[80:83], a[4:7], 0
    ds_read_b128 v[76:79], v98 offset:23552
    s_waitcnt lgkmcnt(4)
    v_mfma_f32_16x16x32_bf16 v[28:31], v[84:87], a[0:3], 0
    v_mfma_f32_16x16x32_bf16 v[56:59], v[84:87], a[4:7], 0
    ds_read_b128 v[80:83], v98 offset:24576
    s_waitcnt lgkmcnt(4)
    v_mfma_f32_16x16x32_bf16 v[32:35], v[88:91], a[0:3], 0
    v_mfma_f32_16x16x32_bf16 v[60:63], v[88:91], a[4:7], 0
    ds_read_b128 v[84:87], v98 offset:25600
    s_waitcnt lgkmcnt(4)
    v_mfma_f32_16x16x32_bf16 v[36:39], v[92:95], a[0:3], 0
    v_mfma_f32_16x16x32_bf16 v[64:67], v[92:95], a[4:7], 0
    ds_read_b128 v[88:91], v98 offset:26624
    s_waitcnt lgkmcnt(4)
    v_mfma_f32_16x16x32_bf16 v[40:43], v[72:75], a[0:3], 0
    v_mfma_f32_16x16x32_bf16 v[68:71], v[72:75], a[4:7], 0
    ds_read_b128 v[92:95], v98 offset:27648
    s_mul_i32 s21, s20, 401408
    s_add_u32 s21, s21, s23
    s_add_u32 s21, s21, 5353472
    s_add_u32 s22, s23, 59392
    s_mov_b32 m0, s22
    s_nop 0
    buffer_load_dwordx4 v1, s[4:7], s21 offen offset:0 lds
    buffer_load_dwordx4 v1, s[4:7], s21 offen offset:1024 lds
    buffer_load_dwordx4 v1, s[4:7], s21 offen offset:2048 lds
    buffer_load_dwordx4 v1, s[4:7], s21 offen offset:3072 lds
    s_add_u32 s21, s21, 4096
    s_add_u32 s22, s22, 4096
    s_mov_b32 m0, s22
    s_nop 0
    buffer_load_dwordx4 v1, s[4:7], s21 offen offset:0 lds
    buffer_load_dwordx4 v1, s[4:7], s21 offen offset:1024 lds
    buffer_load_dwordx4 v1, s[4:7], s21 offen offset:2048 lds
    s_waitcnt vmcnt(21)
    s_waitcnt lgkmcnt(4)
    v_mfma_f32_16x16x32_bf16 v[16:19], v[76:79], a[8:11], v[16:19]
    v_mfma_f32_16x16x32_bf16 v[44:47], v[76:79], a[12:15], v[44:47]
    ds_read_b128 v[72:75], v98 offset:28672
    v_mov_b32 v125, 39
    ds_write_b32 v126, v125
    s_waitcnt lgkmcnt(5)
    v_mfma_f32_16x16x32_bf16 v[20:23], v[80:83], a[8:11], v[20:23]
    v_mfma_f32_16x16x32_bf16 v[48:51], v[80:83], a[12:15], v[48:51]
    ds_read_b128 v[76:79], v98 offset:29696
    s_waitcnt lgkmcnt(5)
    v_mfma_f32_16x16x32_bf16 v[24:27], v[84:87], a[8:11], v[24:27]
    v_mfma_f32_16x16x32_bf16 v[52:55], v[84:87], a[12:15], v[52:55]
    ds_read_b128 v[80:83], v98 offset:53248
    s_waitcnt lgkmcnt(5)
    v_mfma_f32_16x16x32_bf16 v[28:31], v[88:91], a[8:11], v[28:31]
    v_mfma_f32_16x16x32_bf16 v[56:59], v[88:91], a[12:15], v[56:59]
    ds_read_b128 v[84:87], v98 offset:54272
    s_waitcnt lgkmcnt(5)
    v_mfma_f32_16x16x32_bf16 v[32:35], v[92:95], a[8:11], v[32:35]
    v_mfma_f32_16x16x32_bf16 v[60:63], v[92:95], a[12:15], v[60:63]
    ds_read_b128 v[88:91], v98 offset:55296
    s_waitcnt lgkmcnt(5)
    v_mfma_f32_16x16x32_bf16 v[36:39], v[72:75], a[8:11], v[36:39]
    v_mfma_f32_16x16x32_bf16 v[64:67], v[72:75], a[12:15], v[64:67]
    ds_read_b128 v[92:95], v98 offset:56320
    s_waitcnt lgkmcnt(4)
    v_mfma_f32_16x16x32_bf16 v[40:43], v[76:79], a[8:11], v[40:43]
    v_mfma_f32_16x16x32_bf16 v[68:71], v[76:79], a[12:15], v[68:71]
    ds_read_b128 v[72:75], v98 offset:57344
    s_mul_i32 s21, s20, 401408
    s_add_u32 s21, s21, s23
    s_add_u32 s21, s21, 5382144
    s_add_u32 s22, s23, 89088
    s_mov_b32 m0, s22
    s_nop 0
    buffer_load_dwordx4 v1, s[4:7], s21 offen offset:0 lds
    buffer_load_dwordx4 v1, s[4:7], s21 offen offset:1024 lds
    buffer_load_dwordx4 v1, s[4:7], s21 offen offset:2048 lds
    buffer_load_dwordx4 v1, s[4:7], s21 offen offset:3072 lds
    s_add_u32 s21, s21, 4096
    s_add_u32 s22, s22, 4096
    s_mov_b32 m0, s22
    s_nop 0
    buffer_load_dwordx4 v1, s[4:7], s21 offen offset:0 lds
    buffer_load_dwordx4 v1, s[4:7], s21 offen offset:1024 lds
    buffer_load_dwordx4 v1, s[4:7], s21 offen offset:2048 lds
    s_waitcnt vmcnt(26)
    s_waitcnt lgkmcnt(4)
    v_mfma_f32_16x16x32_bf16 v[16:19], v[80:83], a[16:19], v[16:19]
    v_mfma_f32_16x16x32_bf16 v[44:47], v[80:83], a[20:23], v[44:47]
    ds_read_b128 v[76:79], v98 offset:58368
    v_mov_b32 v125, 40
    ds_write_b32 v126, v125
    s_waitcnt lgkmcnt(5)
    v_mfma_f32_16x16x32_bf16 v[20:23], v[84:87], a[16:19], v[20:23]
    v_mfma_f32_16x16x32_bf16 v[48:51], v[84:87], a[20:23], v[48:51]
    ds_read_b128 v[80:83], v98 offset:59392
    s_waitcnt lgkmcnt(5)
    v_mfma_f32_16x16x32_bf16 v[24:27], v[88:91], a[16:19], v[24:27]
    v_mfma_f32_16x16x32_bf16 v[52:55], v[88:91], a[20:23], v[52:55]
    ds_read_b128 v[84:87], v97 offset:0
    s_waitcnt lgkmcnt(5)
    v_mfma_f32_16x16x32_bf16 v[28:31], v[92:95], a[16:19], v[28:31]
    v_mfma_f32_16x16x32_bf16 v[56:59], v[92:95], a[20:23], v[56:59]
    ds_read_b128 v[88:91], v97 offset:1024
    s_waitcnt lgkmcnt(5)
    v_mfma_f32_16x16x32_bf16 v[32:35], v[72:75], a[16:19], v[32:35]
    v_mfma_f32_16x16x32_bf16 v[60:63], v[72:75], a[20:23], v[60:63]
    ds_read_b128 v[92:95], v97 offset:2048
    s_waitcnt lgkmcnt(5)
    v_mfma_f32_16x16x32_bf16 v[36:39], v[76:79], a[16:19], v[36:39]
    v_mfma_f32_16x16x32_bf16 v[64:67], v[76:79], a[20:23], v[64:67]
    ds_read_b128 v[72:75], v97 offset:3072
    s_waitcnt lgkmcnt(4)
    v_mfma_f32_16x16x32_bf16 v[40:43], v[80:83], a[16:19], v[40:43]
    v_mfma_f32_16x16x32_bf16 v[68:71], v[80:83], a[20:23], v[68:71]
    ds_read_b128 v[76:79], v97 offset:4096
    s_mul_i32 s21, s20, 401408
    s_add_u32 s21, s21, s23
    s_add_u32 s21, s21, 5410816
    s_add_u32 s22, s23, 118784
    s_mov_b32 m0, s22
    s_nop 0
    buffer_load_dwordx4 v1, s[4:7], s21 offen offset:0 lds
    buffer_load_dwordx4 v1, s[4:7], s21 offen offset:1024 lds
    buffer_load_dwordx4 v1, s[4:7], s21 offen offset:2048 lds
    buffer_load_dwordx4 v1, s[4:7], s21 offen offset:3072 lds
    s_add_u32 s21, s21, 4096
    s_add_u32 s22, s22, 4096
    s_mov_b32 m0, s22
    s_nop 0
    buffer_load_dwordx4 v1, s[4:7], s21 offen offset:0 lds
    buffer_load_dwordx4 v1, s[4:7], s21 offen offset:1024 lds
    buffer_load_dwordx4 v1, s[4:7], s21 offen offset:2048 lds
    s_waitcnt vmcnt(31)
    s_waitcnt lgkmcnt(4)
    v_mfma_f32_16x16x32_bf16 v[16:19], v[84:87], a[24:27], v[16:19]
    v_mfma_f32_16x16x32_bf16 v[44:47], v[84:87], a[28:31], v[44:47]
    ds_read_b128 v[80:83], v97 offset:5120
    v_mov_b32 v125, 41
    ds_write_b32 v126, v125
    s_waitcnt lgkmcnt(5)
    v_mfma_f32_16x16x32_bf16 v[20:23], v[88:91], a[24:27], v[20:23]
    v_mfma_f32_16x16x32_bf16 v[48:51], v[88:91], a[28:31], v[48:51]
    ds_read_b128 v[84:87], v97 offset:6144
    s_waitcnt lgkmcnt(5)
    v_mfma_f32_16x16x32_bf16 v[24:27], v[92:95], a[24:27], v[24:27]
    v_mfma_f32_16x16x32_bf16 v[52:55], v[92:95], a[28:31], v[52:55]
    ds_read_b128 v[88:91], v97 offset:29696
    s_waitcnt lgkmcnt(5)
    v_mfma_f32_16x16x32_bf16 v[28:31], v[72:75], a[24:27], v[28:31]
    v_mfma_f32_16x16x32_bf16 v[56:59], v[72:75], a[28:31], v[56:59]
    ds_read_b128 v[92:95], v97 offset:30720
    s_waitcnt lgkmcnt(5)
    v_mfma_f32_16x16x32_bf16 v[32:35], v[76:79], a[24:27], v[32:35]
    v_mfma_f32_16x16x32_bf16 v[60:63], v[76:79], a[28:31], v[60:63]
    ds_read_b128 v[72:75], v97 offset:31744
    s_waitcnt lgkmcnt(5)
    v_mfma_f32_16x16x32_bf16 v[36:39], v[80:83], a[24:27], v[36:39]
    v_mfma_f32_16x16x32_bf16 v[64:67], v[80:83], a[28:31], v[64:67]
    ds_read_b128 v[76:79], v97 offset:32768
    s_waitcnt lgkmcnt(4)
    v_mfma_f32_16x16x32_bf16 v[40:43], v[84:87], a[24:27], v[40:43]
    v_mfma_f32_16x16x32_bf16 v[68:71], v[84:87], a[28:31], v[68:71]
    ds_read_b128 v[80:83], v97 offset:33792
    s_mul_i32 s21, s20, 401408
    s_add_u32 s21, s21, s23
    s_add_u32 s21, s21, 5439488
    s_add_u32 s22, s23, 0
    s_mov_b32 m0, s22
    s_nop 0
    buffer_load_dwordx4 v1, s[4:7], s21 offen offset:0 lds
    buffer_load_dwordx4 v1, s[4:7], s21 offen offset:1024 lds
    buffer_load_dwordx4 v1, s[4:7], s21 offen offset:2048 lds
    buffer_load_dwordx4 v1, s[4:7], s21 offen offset:3072 lds
    s_add_u32 s21, s21, 4096
    s_add_u32 s22, s22, 4096
    s_mov_b32 m0, s22
    s_nop 0
    buffer_load_dwordx4 v1, s[4:7], s21 offen offset:0 lds
    buffer_load_dwordx4 v1, s[4:7], s21 offen offset:1024 lds
    buffer_load_dwordx4 v1, s[4:7], s21 offen offset:2048 lds
    s_waitcnt vmcnt(36)
    s_waitcnt lgkmcnt(4)
    v_mfma_f32_16x16x32_bf16 v[16:19], v[88:91], a[32:35], v[16:19]
    v_mfma_f32_16x16x32_bf16 v[44:47], v[88:91], a[36:39], v[44:47]
    ds_read_b128 v[84:87], v97 offset:34816
    v_mov_b32 v125, 42
    ds_write_b32 v126, v125
    s_waitcnt lgkmcnt(5)
    v_mfma_f32_16x16x32_bf16 v[20:23], v[92:95], a[32:35], v[20:23]
    v_mfma_f32_16x16x32_bf16 v[48:51], v[92:95], a[36:39], v[48:51]
    ds_read_b128 v[88:91], v97 offset:35840
    s_waitcnt lgkmcnt(5)
    v_mfma_f32_16x16x32_bf16 v[24:27], v[72:75], a[32:35], v[24:27]
    v_mfma_f32_16x16x32_bf16 v[52:55], v[72:75], a[36:39], v[52:55]
    s_waitcnt vmcnt(21)
    ds_read_b128 v[92:95], v97 offset:59392
    s_waitcnt lgkmcnt(5)
    v_mfma_f32_16x16x32_bf16 v[28:31], v[76:79], a[32:35], v[28:31]
    v_mfma_f32_16x16x32_bf16 v[56:59], v[76:79], a[36:39], v[56:59]
    ds_read_b128 v[72:75], v97 offset:60416
    s_waitcnt lgkmcnt(5)
    v_mfma_f32_16x16x32_bf16 v[32:35], v[80:83], a[32:35], v[32:35]
    v_mfma_f32_16x16x32_bf16 v[60:63], v[80:83], a[36:39], v[60:63]
    ds_read_b128 v[76:79], v97 offset:61440
    s_waitcnt lgkmcnt(5)
    v_mfma_f32_16x16x32_bf16 v[36:39], v[84:87], a[32:35], v[36:39]
    v_mfma_f32_16x16x32_bf16 v[64:67], v[84:87], a[36:39], v[64:67]
    ds_read_b128 v[80:83], v97 offset:62464
    s_waitcnt lgkmcnt(4)
    v_mfma_f32_16x16x32_bf16 v[40:43], v[88:91], a[32:35], v[40:43]
    v_mfma_f32_16x16x32_bf16 v[68:71], v[88:91], a[36:39], v[68:71]
    ds_read_b128 v[84:87], v97 offset:63488
    s_waitcnt lgkmcnt(4)
    v_mfma_f32_16x16x32_bf16 v[16:19], v[92:95], a[40:43], v[16:19]
    v_mfma_f32_16x16x32_bf16 v[44:47], v[92:95], a[44:47], v[44:47]
    ds_read_b128 v[88:91], v97 offset:64512
    v_mov_b32 v125, 43
    ds_write_b32 v126, v125
    s_waitcnt lgkmcnt(5)
    v_mfma_f32_16x16x32_bf16 v[20:23], v[72:75], a[40:43], v[20:23]
    v_mfma_f32_16x16x32_bf16 v[48:51], v[72:75], a[44:47], v[48:51]
    ds_read_b128 v[92:95], v98 offset:0
    s_waitcnt lgkmcnt(5)
    v_mfma_f32_16x16x32_bf16 v[24:27], v[76:79], a[40:43], v[24:27]
    v_mfma_f32_16x16x32_bf16 v[52:55], v[76:79], a[44:47], v[52:55]
    s_waitcnt vmcnt(14)
    ds_read_b128 v[72:75], v98 offset:23552
    s_waitcnt lgkmcnt(5)
    v_mfma_f32_16x16x32_bf16 v[28:31], v[80:83], a[40:43], v[28:31]
    v_mfma_f32_16x16x32_bf16 v[56:59], v[80:83], a[44:47], v[56:59]
    ds_read_b128 v[76:79], v98 offset:24576
    s_waitcnt lgkmcnt(5)
    v_mfma_f32_16x16x32_bf16 v[32:35], v[84:87], a[40:43], v[32:35]
    v_mfma_f32_16x16x32_bf16 v[60:63], v[84:87], a[44:47], v[60:63]
    ds_read_b128 v[80:83], v98 offset:25600
    s_waitcnt lgkmcnt(5)
    v_mfma_f32_16x16x32_bf16 v[36:39], v[88:91], a[40:43], v[36:39]
    v_mfma_f32_16x16x32_bf16 v[64:67], v[88:91], a[44:47], v[64:67]
    ds_read_b128 v[84:87], v98 offset:26624
    s_waitcnt lgkmcnt(4)
    v_mfma_f32_16x16x32_bf16 v[40:43], v[92:95], a[40:43], v[40:43]
    v_mfma_f32_16x16x32_bf16 v[68:71], v[92:95], a[44:47], v[68:71]
    ds_read_b128 v[88:91], v98 offset:27648
    s_waitcnt lgkmcnt(4)
    v_mfma_f32_16x16x32_bf16 v[16:19], v[72:75], a[48:51], v[16:19]
    v_mfma_f32_16x16x32_bf16 v[44:47], v[72:75], a[52:55], v[44:47]
    ds_read_b128 v[92:95], v98 offset:28672
    v_mov_b32 v125, 44
    ds_write_b32 v126, v125
    s_waitcnt lgkmcnt(5)
    v_mfma_f32_16x16x32_bf16 v[20:23], v[76:79], a[48:51], v[20:23]
    v_mfma_f32_16x16x32_bf16 v[48:51], v[76:79], a[52:55], v[48:51]
    ds_read_b128 v[72:75], v98 offset:29696
    s_waitcnt lgkmcnt(5)
    v_mfma_f32_16x16x32_bf16 v[24:27], v[80:83], a[48:51], v[24:27]
    v_mfma_f32_16x16x32_bf16 v[52:55], v[80:83], a[52:55], v[52:55]
    s_waitcnt vmcnt(7)
    ds_read_b128 v[76:79], v98 offset:53248
    s_waitcnt lgkmcnt(5)
    v_mfma_f32_16x16x32_bf16 v[28:31], v[84:87], a[48:51], v[28:31]
    v_mfma_f32_16x16x32_bf16 v[56:59], v[84:87], a[52:55], v[56:59]
    ds_read_b128 v[80:83], v98 offset:54272
    s_waitcnt lgkmcnt(5)
    v_mfma_f32_16x16x32_bf16 v[32:35], v[88:91], a[48:51], v[32:35]
    v_mfma_f32_16x16x32_bf16 v[60:63], v[88:91], a[52:55], v[60:63]
    ds_read_b128 v[84:87], v98 offset:55296
    s_waitcnt lgkmcnt(5)
    v_mfma_f32_16x16x32_bf16 v[36:39], v[92:95], a[48:51], v[36:39]
    v_mfma_f32_16x16x32_bf16 v[64:67], v[92:95], a[52:55], v[64:67]
    ds_read_b128 v[88:91], v98 offset:56320
    s_waitcnt lgkmcnt(4)
    v_mfma_f32_16x16x32_bf16 v[40:43], v[72:75], a[48:51], v[40:43]
    v_mfma_f32_16x16x32_bf16 v[68:71], v[72:75], a[52:55], v[68:71]
    ds_read_b128 v[92:95], v98 offset:57344
    s_waitcnt lgkmcnt(4)
    v_mfma_f32_16x16x32_bf16 v[16:19], v[76:79], a[56:59], v[16:19]
    v_mfma_f32_16x16x32_bf16 v[44:47], v[76:79], a[60:63], v[44:47]
    ds_read_b128 v[72:75], v98 offset:58368
    v_mov_b32 v125, 45
    ds_write_b32 v126, v125
    s_waitcnt lgkmcnt(5)
    v_mfma_f32_16x16x32_bf16 v[20:23], v[80:83], a[56:59], v[20:23]
    v_mfma_f32_16x16x32_bf16 v[48:51], v[80:83], a[60:63], v[48:51]
    ds_read_b128 v[76:79], v98 offset:59392
    s_waitcnt lgkmcnt(5)
    v_mfma_f32_16x16x32_bf16 v[24:27], v[84:87], a[56:59], v[24:27]
    v_mfma_f32_16x16x32_bf16 v[52:55], v[84:87], a[60:63], v[52:55]
    s_waitcnt vmcnt(0)
    ds_read_b128 v[80:83], v97 offset:0
    s_waitcnt lgkmcnt(5)
    v_mfma_f32_16x16x32_bf16 v[28:31], v[88:91], a[56:59], v[28:31]
    v_mfma_f32_16x16x32_bf16 v[56:59], v[88:91], a[60:63], v[56:59]
    ds_read_b128 v[84:87], v97 offset:1024
    s_waitcnt lgkmcnt(5)
    v_mfma_f32_16x16x32_bf16 v[32:35], v[92:95], a[56:59], v[32:35]
    v_mfma_f32_16x16x32_bf16 v[60:63], v[92:95], a[60:63], v[60:63]
    ds_read_b128 v[88:91], v97 offset:2048
    s_waitcnt lgkmcnt(5)
    v_mfma_f32_16x16x32_bf16 v[36:39], v[72:75], a[56:59], v[36:39]
    v_mfma_f32_16x16x32_bf16 v[64:67], v[72:75], a[60:63], v[64:67]
    ds_read_b128 v[92:95], v97 offset:3072
    s_waitcnt lgkmcnt(4)
    v_mfma_f32_16x16x32_bf16 v[40:43], v[76:79], a[56:59], v[40:43]
    v_mfma_f32_16x16x32_bf16 v[68:71], v[76:79], a[60:63], v[68:71]
    ds_read_b128 v[72:75], v97 offset:4096
    s_waitcnt lgkmcnt(4)
    v_mfma_f32_16x16x32_bf16 v[16:19], v[80:83], a[64:67], v[16:19]
    v_mfma_f32_16x16x32_bf16 v[44:47], v[80:83], a[68:71], v[44:47]
    ds_read_b128 v[76:79], v97 offset:5120
    v_mov_b32 v125, 46
    ds_write_b32 v126, v125
    s_waitcnt lgkmcnt(5)
    v_mfma_f32_16x16x32_bf16 v[20:23], v[84:87], a[64:67], v[20:23]
    v_mfma_f32_16x16x32_bf16 v[48:51], v[84:87], a[68:71], v[48:51]
    ds_read_b128 v[80:83], v97 offset:6144
    s_waitcnt lgkmcnt(5)
    v_mfma_f32_16x16x32_bf16 v[24:27], v[88:91], a[64:67], v[24:27]
    v_mfma_f32_16x16x32_bf16 v[52:55], v[88:91], a[68:71], v[52:55]
    s_waitcnt lgkmcnt(4)
    v_mfma_f32_16x16x32_bf16 v[28:31], v[92:95], a[64:67], v[28:31]
    v_mfma_f32_16x16x32_bf16 v[56:59], v[92:95], a[68:71], v[56:59]
    s_waitcnt lgkmcnt(3)
    v_mfma_f32_16x16x32_bf16 v[32:35], v[72:75], a[64:67], v[32:35]
    v_mfma_f32_16x16x32_bf16 v[60:63], v[72:75], a[68:71], v[60:63]
    s_waitcnt lgkmcnt(2)
    v_mfma_f32_16x16x32_bf16 v[36:39], v[76:79], a[64:67], v[36:39]
    v_mfma_f32_16x16x32_bf16 v[64:67], v[76:79], a[68:71], v[64:67]
    s_waitcnt lgkmcnt(0)
    v_mfma_f32_16x16x32_bf16 v[40:43], v[80:83], a[64:67], v[40:43]
    v_mfma_f32_16x16x32_bf16 v[68:71], v[80:83], a[68:71], v[68:71]
    v_mov_b32 v125, 47
    ds_write_b32 v126, v125
    s_setprio 3
    v_subrev_u32 v7, 59392, v120
    v_mov_b32 v116, 148992
    ds_read_b128 v[116:119], v116
    s_waitcnt lgkmcnt(0)
    v_min3_u32 v116, v116, v117, v118
    v_min_u32 v116, v116, v119
    v_cmp_gt_u32 vcc, 46, v116
    s_nop 1
    s_cbranch_vccz Lc143d
    s_nop 1
    s_mov_b32 s25, 2000000
Lc143:
    s_nop 0
    s_sleep 1
    v_mov_b32 v116, 148992
    ds_read_b128 v[116:119], v116
    s_waitcnt lgkmcnt(0)
    v_min3_u32 v116, v116, v117, v118
    v_min_u32 v116, v116, v119
    v_cmp_gt_u32 vcc, 46, v116
    s_nop 1
    s_cbranch_vccz Lc143d
    s_sub_u32 s25, s25, 1
    s_cmp_lg_u32 s25, 0
    s_cbranch_scc1 Lc143
    s_nop 0
Lc143d:
    ds_write_b128 v121, v[16:19] offset:0
    ds_write_b128 v121, v[20:23] offset:64
    ds_write_b128 v121, v[24:27] offset:128
    ds_write_b128 v121, v[28:31] offset:192
    ds_write_b128 v121, v[32:35] offset:256
    ds_write_b128 v121, v[36:39] offset:320
    ds_write_b128 v121, v[40:43] offset:384
    ds_write_b128 v121, v[44:47] offset:7424
    ds_write_b128 v121, v[48:51] offset:7488
    ds_write_b128 v121, v[52:55] offset:7552
    ds_write_b128 v121, v[56:59] offset:7616
    ds_write_b128 v121, v[60:63] offset:7680
    ds_write_b128 v121, v[64:67] offset:7744
    ds_write_b128 v121, v[68:71] offset:7808
    v_mov_b32 v125, 48
    ds_write_b32 v126, v125
    v_lshlrev_b32 v80, 16, v108
    v_and_b32 v81, 0xffff0000, v108
    v_lshlrev_b32 v82, 16, v109
    v_and_b32 v83, 0xffff0000, v109
    v_lshlrev_b32 v84, 16, v110
    v_and_b32 v85, 0xffff0000, v110
    v_lshlrev_b32 v86, 16, v111
    v_and_b32 v87, 0xffff0000, v111
    v_lshlrev_b32 v88, 16, v112
    v_and_b32 v89, 0xffff0000, v112
    v_lshlrev_b32 v90, 16, v113
    v_and_b32 v91, 0xffff0000, v113
    v_lshlrev_b32 v92, 16, v114
    v_and_b32 v93, 0xffff0000, v114
    v_lshlrev_b32 v94, 16, v115
    v_and_b32 v95, 0xffff0000, v115
    v_mov_b32 v116, 149008
    ds_read_b128 v[116:119], v116
    s_waitcnt lgkmcnt(0)
    v_min3_u32 v116, v116, v117, v118
    v_min_u32 v116, v116, v119
    v_cmp_gt_u32 vcc, 21, v116
    s_nop 1
    s_cbranch_vccz Lc144d
    s_nop 1
    s_mov_b32 s25, 2000000
Lc144:
    s_nop 0
    s_sleep 1
    v_mov_b32 v116, 149008
    ds_read_b128 v[116:119], v116
    s_waitcnt lgkmcnt(0)
    v_min3_u32 v116, v116, v117, v118
    v_min_u32 v116, v116, v119
    v_cmp_gt_u32 vcc, 21, v116
    s_nop 1
    s_cbranch_vccz Lc144d
    s_sub_u32 s25, s25, 1
    s_cmp_lg_u32 s25, 0
    s_cbranch_scc1 Lc144
    s_nop 0
Lc144d:
    ds_read_b128 v[16:19], v7 offset:0
    ds_read_b128 v[20:23], v7 offset:16
    ds_read_b128 v[24:27], v7 offset:32
    ds_read_b128 v[28:31], v7 offset:48
    ds_read_b128 v[32:35], v7 offset:14848
    ds_read_b128 v[36:39], v7 offset:14864
    ds_read_b128 v[40:43], v7 offset:14880
    ds_read_b128 v[44:47], v7 offset:14896
    ds_read_b128 v[48:51], v7 offset:29696
    ds_read_b128 v[52:55], v7 offset:29712
    ds_read_b128 v[56:59], v7 offset:29728
    ds_read_b128 v[60:63], v7 offset:29744
    ds_read_b128 v[64:67], v7 offset:44544
    ds_read_b128 v[68:71], v7 offset:44560
    ds_read_b128 v[72:75], v7 offset:44576
    ds_read_b128 v[76:79], v7 offset:44592
    s_waitcnt lgkmcnt(8)
    v_pk_add_f32 v[16:17], v[16:17], v[32:33]
    v_pk_add_f32 v[18:19], v[18:19], v[34:35]
    v_pk_add_f32 v[20:21], v[20:21], v[36:37]
    v_pk_add_f32 v[22:23], v[22:23], v[38:39]
    v_pk_add_f32 v[24:25], v[24:25], v[40:41]
    v_pk_add_f32 v[26:27], v[26:27], v[42:43]
    v_pk_add_f32 v[28:29], v[28:29], v[44:45]
    v_pk_add_f32 v[30:31], v[30:31], v[46:47]
    s_waitcnt lgkmcnt(0)
    v_mov_b32 v125, 49
    ds_write_b32 v126, v125
    v_pk_add_f32 v[48:49], v[48:49], v[64:65]
    v_pk_add_f32 v[50:51], v[50:51], v[66:67]
    v_pk_add_f32 v[52:53], v[52:53], v[68:69]
    v_pk_add_f32 v[54:55], v[54:55], v[70:71]
    v_pk_add_f32 v[56:57], v[56:57], v[72:73]
    v_pk_add_f32 v[58:59], v[58:59], v[74:75]
    v_pk_add_f32 v[60:61], v[60:61], v[76:77]
    v_pk_add_f32 v[62:63], v[62:63], v[78:79]
    v_pk_add_f32 v[96:97], v[16:17], v[48:49]
    v_pk_add_f32 v[98:99], v[18:19], v[50:51]
    v_pk_add_f32 v[100:101], v[20:21], v[52:53]
    v_pk_add_f32 v[102:103], v[22:23], v[54:55]
    v_pk_add_f32 v[104:105], v[24:25], v[56:57]
    v_pk_add_f32 v[106:107], v[26:27], v[58:59]
    v_pk_add_f32 v[8:9], v[28:29], v[60:61]
    v_pk_add_f32 v[10:11], v[30:31], v[62:63]
    v_mov_b32 v116, 148992
    ds_read_b128 v[116:119], v116
    s_waitcnt lgkmcnt(0)
    v_min3_u32 v116, v116, v117, v118
    v_min_u32 v116, v116, v119
    v_cmp_gt_u32 vcc, 48, v116
    s_nop 1
    s_cbranch_vccz Lc145d
    s_nop 1
    s_mov_b32 s25, 2000000
Lc145:
    s_nop 0
    s_sleep 1
    v_mov_b32 v116, 148992
    ds_read_b128 v[116:119], v116
    s_waitcnt lgkmcnt(0)
    v_min3_u32 v116, v116, v117, v118
    v_min_u32 v116, v116, v119
    v_cmp_gt_u32 vcc, 48, v116
    s_nop 1
    s_cbranch_vccz Lc145d
    s_sub_u32 s25, s25, 1
    s_cmp_lg_u32 s25, 0
    s_cbranch_scc1 Lc145
    s_nop 0
Lc145d:
    ds_read_b128 v[16:19], v120 offset:0
    ds_read_b128 v[20:23], v120 offset:16
    ds_read_b128 v[24:27], v120 offset:32
    ds_read_b128 v[28:31], v120 offset:48
    ds_read_b128 v[32:35], v120 offset:14848
    ds_read_b128 v[36:39], v120 offset:14864
    ds_read_b128 v[40:43], v120 offset:14880
    ds_read_b128 v[44:47], v120 offset:14896
    ds_read_b128 v[48:51], v120 offset:29696
    ds_read_b128 v[52:55], v120 offset:29712
    ds_read_b128 v[56:59], v120 offset:29728
    ds_read_b128 v[60:63], v120 offset:29744
    ds_read_b128 v[64:67], v120 offset:44544
    ds_read_b128 v[68:71], v120 offset:44560
    ds_read_b128 v[72:75], v120 offset:44576
    ds_read_b128 v[76:79], v120 offset:44592
    s_mov_b32 s40, 0x7f7f7f7f
    s_mov_b32 s41, 0x7f7f7f7f
    s_mov_b32 s21, 6832128
    s_mov_b32 s22, 8667136
    s_waitcnt lgkmcnt(8)
    v_pk_add_f32 v[16:17], v[16:17], v[32:33]
    v_pk_add_f32 v[18:19], v[18:19], v[34:35]
    v_pk_add_f32 v[20:21], v[20:21], v[36:37]
    v_pk_add_f32 v[22:23], v[22:23], v[38:39]
    v_pk_add_f32 v[24:25], v[24:25], v[40:41]
    v_pk_add_f32 v[26:27], v[26:27], v[42:43]
    v_pk_add_f32 v[28:29], v[28:29], v[44:45]
    v_pk_add_f32 v[30:31], v[30:31], v[46:47]
    v_pk_add_f32 v[16:17], v[16:17], v[96:97]
    v_pk_add_f32 v[18:19], v[18:19], v[98:99]
    v_pk_add_f32 v[20:21], v[20:21], v[100:101]
    v_pk_add_f32 v[22:23], v[22:23], v[102:103]
    v_pk_add_f32 v[24:25], v[24:25], v[104:105]
    v_pk_add_f32 v[26:27], v[26:27], v[106:107]
    v_pk_add_f32 v[28:29], v[28:29], v[8:9]
    v_pk_add_f32 v[30:31], v[30:31], v[10:11]
    s_waitcnt lgkmcnt(0)
    v_mov_b32 v125, 50
    ds_write_b32 v126, v125
    v_pk_add_f32 v[48:49], v[48:49], v[64:65]
    v_pk_add_f32 v[50:51], v[50:51], v[66:67]
    v_pk_add_f32 v[52:53], v[52:53], v[68:69]
    v_pk_add_f32 v[54:55], v[54:55], v[70:71]
    v_pk_add_f32 v[56:57], v[56:57], v[72:73]
    v_pk_add_f32 v[58:59], v[58:59], v[74:75]
    v_pk_add_f32 v[60:61], v[60:61], v[76:77]
    v_pk_add_f32 v[62:63], v[62:63], v[78:79]
    v_pk_add_f32 v[16:17], v[16:17], v[48:49]
    v_pk_add_f32 v[18:19], v[18:19], v[50:51]
    v_pk_add_f32 v[20:21], v[20:21], v[52:53]
    v_pk_add_f32 v[22:23], v[22:23], v[54:55]
    v_pk_add_f32 v[24:25], v[24:25], v[56:57]
    v_pk_add_f32 v[26:27], v[26:27], v[58:59]
    v_pk_add_f32 v[28:29], v[28:29], v[60:61]
    v_pk_add_f32 v[30:31], v[30:31], v[62:63]
    v_cvt_pk_bf16_f32 v32, v16, v17
    v_cvt_pk_bf16_f32 v33, v18, v19
    v_cvt_pk_bf16_f32 v34, v20, v21
    v_cvt_pk_bf16_f32 v35, v22, v23
    v_cvt_pk_bf16_f32 v36, v24, v25
    v_cvt_pk_bf16_f32 v37, v26, v27
    v_cvt_pk_bf16_f32 v38, v28, v29
    v_cvt_pk_bf16_f32 v39, v30, v31
    v_lshlrev_b32 v16, 16, v32
    v_and_b32 v17, 0xffff0000, v32
    v_lshlrev_b32 v18, 16, v33
    v_and_b32 v19, 0xffff0000, v33
    v_lshlrev_b32 v20, 16, v34
    v_and_b32 v21, 0xffff0000, v34
    v_lshlrev_b32 v22, 16, v35
    v_and_b32 v23, 0xffff0000, v35
    v_lshlrev_b32 v24, 16, v36
    v_and_b32 v25, 0xffff0000, v36
    v_lshlrev_b32 v26, 16, v37
    v_and_b32 v27, 0xffff0000, v37
    v_lshlrev_b32 v28, 16, v38
    v_and_b32 v29, 0xffff0000, v38
    v_lshlrev_b32 v30, 16, v39
    v_and_b32 v31, 0xffff0000, v39
    v_pk_add_f32 v[16:17], v[16:17], v[80:81]
    v_pk_add_f32 v[18:19], v[18:19], v[82:83]
    v_pk_add_f32 v[20:21], v[20:21], v[84:85]
    v_pk_add_f32 v[22:23], v[22:23], v[86:87]
    v_pk_add_f32 v[24:25], v[24:25], v[88:89]
    v_pk_add_f32 v[26:27], v[26:27], v[90:91]
    v_pk_add_f32 v[28:29], v[28:29], v[92:93]
    v_pk_add_f32 v[30:31], v[30:31], v[94:95]
    v_cvt_pk_bf16_f32 v108, v16, v17
    v_cvt_pk_bf16_f32 v109, v18, v19
    v_cvt_pk_bf16_f32 v110, v20, v21
    v_cvt_pk_bf16_f32 v111, v22, v23
    v_cvt_pk_bf16_f32 v112, v24, v25
    v_cvt_pk_bf16_f32 v113, v26, v27
    v_cvt_pk_bf16_f32 v114, v28, v29
    v_cvt_pk_bf16_f32 v115, v30, v31
    s_mov_b64 exec, s[40:41]
    buffer_store_dwordx4 v[108:111], v123, s[12:15], 0 offen offset:0
    buffer_store_dwordx4 v[112:115], v123, s[12:15], 0 offen offset:16
    s_mov_b64 exec, -1
    s_endpgm
Lhelper:
    v_add_u32 v2, 0x10000, v1
    v_add_u32 v3, 0x20000, v1
    s_mul_i32 s24, s29, 7168
    v_lshlrev_b32 v123, 7, v0
    s_lshl_b32 s21, s16, 2
    s_add_u32 s26, s21, s29
    v_and_b32 v120, 15, v0
    v_lshlrev_b32 v120, 4, v120
    v_lshrrev_b32 v121, 4, v0
    v_lshl_add_u32 v120, v121, 9, v120
    v_and_b32 v122, 15, v0
    v_mul_u32_u24 v122, 464, v122
    v_lshl_add_u32 v122, v121, 4, v122
    s_mul_i32 s21, s29, 14848
    s_add_u32 s21, s21, 29696
    v_add_u32 v121, s21, v122
    s_lshl_b32 s21, s16, 2
    s_add_u32 s27, s21, s19
    s_lshl_b32 s30, s42, 2
    s_add_u32 s30, s30, s19
    s_mul_i32 s21, s17, 89088
    s_add_u32 s21, s21, 0
    s_add_u32 s22, s29, 0
    s_lshl_b32 s22, s22, 10
    s_add_u32 s23, s22, 29696
    s_mov_b32 m0, s23
    s_add_u32 s31, s21, s22
    s_add_u32 s31, s31, 29696
    buffer_load_dwordx4 v1, s[4:7], s31 offen lds
    s_add_u32 s23, s22, 59392
    s_mov_b32 m0, s23
    s_add_u32 s31, s21, s22
    s_add_u32 s31, s31, 59392
    buffer_load_dwordx4 v1, s[4:7], s31 offen lds
    s_add_u32 s22, s29, 4
    s_lshl_b32 s22, s22, 10
    s_add_u32 s23, s22, 29696
    s_mov_b32 m0, s23
    s_add_u32 s31, s21, s22
    s_add_u32 s31, s31, 29696
    buffer_load_dwordx4 v1, s[4:7], s31 offen lds
    s_add_u32 s23, s22, 59392
    s_mov_b32 m0, s23
    s_add_u32 s31, s21, s22
    s_add_u32 s31, s31, 59392
    buffer_load_dwordx4 v1, s[4:7], s31 offen lds
    s_add_u32 s22, s29, 8
    s_lshl_b32 s22, s22, 10
    s_add_u32 s23, s22, 29696
    s_mov_b32 m0, s23
    s_add_u32 s31, s21, s22
    s_add_u32 s31, s31, 29696
    buffer_load_dwordx4 v1, s[4:7], s31 offen lds
    s_add_u32 s23, s22, 59392
    s_mov_b32 m0, s23
    s_add_u32 s31, s21, s22
    s_add_u32 s31, s31, 59392
    buffer_load_dwordx4 v1, s[4:7], s31 offen lds
    s_add_u32 s22, s29, 12
    s_lshl_b32 s22, s22, 10
    s_add_u32 s23, s22, 29696
    s_mov_b32 m0, s23
    s_add_u32 s31, s21, s22
    s_add_u32 s31, s31, 29696
    buffer_load_dwordx4 v1, s[4:7], s31 offen lds
    s_add_u32 s23, s22, 59392
    s_mov_b32 m0, s23
    s_add_u32 s31, s21, s22
    s_add_u32 s31, s31, 59392
    buffer_load_dwordx4 v1, s[4:7], s31 offen lds
    s_add_u32 s22, s29, 16
    s_lshl_b32 s22, s22, 10
    s_add_u32 s23, s22, 29696
    s_mov_b32 m0, s23
    s_add_u32 s31, s21, s22
    s_add_u32 s31, s31, 29696
    buffer_load_dwordx4 v1, s[4:7], s31 offen lds
    s_add_u32 s23, s22, 59392
    s_mov_b32 m0, s23
    s_add_u32 s31, s21, s22
    s_add_u32 s31, s31, 59392
    buffer_load_dwordx4 v1, s[4:7], s31 offen lds
    s_add_u32 s22, s29, 20
    s_lshl_b32 s22, s22, 10
    s_add_u32 s23, s22, 29696
    s_mov_b32 m0, s23
    s_add_u32 s31, s21, s22
    s_add_u32 s31, s31, 29696
    buffer_load_dwordx4 v1, s[4:7], s31 offen lds
    s_add_u32 s23, s22, 59392
    s_mov_b32 m0, s23
    s_add_u32 s31, s21, s22
    s_add_u32 s31, s31, 59392
    buffer_load_dwordx4 v1, s[4:7], s31 offen lds
    s_add_u32 s22, s29, 24
    s_lshl_b32 s22, s22, 10
    s_add_u32 s23, s22, 29696
    s_mov_b32 m0, s23
    s_add_u32 s31, s21, s22
    s_add_u32 s31, s31, 29696
    buffer_load_dwordx4 v1, s[4:7], s31 offen lds
    s_add_u32 s23, s22, 59392
    s_mov_b32 m0, s23
    s_add_u32 s31, s21, s22
    s_add_u32 s31, s31, 59392
    buffer_load_dwordx4 v1, s[4:7], s31 offen lds
    s_add_u32 s22, s29, 28
    s_min_u32 s22, s22, 28
    s_lshl_b32 s22, s22, 10
    s_add_u32 s23, s22, 29696
    s_mov_b32 m0, s23
    s_add_u32 s31, s21, s22
    s_add_u32 s31, s31, 29696
    buffer_load_dwordx4 v1, s[4:7], s31 offen lds
    s_add_u32 s23, s22, 59392
    s_mov_b32 m0, s23
    s_add_u32 s31, s21, s22
    s_add_u32 s31, s31, 59392
    buffer_load_dwordx4 v1, s[4:7], s31 offen lds
    v_mov_b32 v116, 148992
    ds_read_b128 v[116:119], v116
    s_waitcnt lgkmcnt(0)
    v_min3_u32 v116, v116, v117, v118
    v_min_u32 v116, v116, v119
    v_cmp_gt_u32 vcc, 1, v116
    s_nop 1
    s_cbranch_vccz Lc146d
    s_nop 1
    s_mov_b32 s25, 2000000
Lc146:
    s_nop 0
    s_sleep 1
    v_mov_b32 v116, 148992
    ds_read_b128 v[116:119], v116
    s_waitcnt lgkmcnt(0)
    v_min3_u32 v116, v116, v117, v118
    v_min_u32 v116, v116, v119
    v_cmp_gt_u32 vcc, 1, v116
    s_nop 1
    s_cbranch_vccz Lc146d
    s_sub_u32 s25, s25, 1
    s_cmp_lg_u32 s25, 0
    s_cbranch_scc1 Lc146
    s_nop 0
Lc146d:
    s_mul_i32 s21, s17, 89088
    s_add_u32 s21, s21, s24
    s_add_u32 s21, s21, 0
    s_add_u32 s22, s24, 0
    s_mov_b32 m0, s22
    s_nop 0
    buffer_load_dwordx4 v1, s[4:7], s21 offen offset:0 lds
    buffer_load_dwordx4 v1, s[4:7], s21 offen offset:1024 lds
    buffer_load_dwordx4 v1, s[4:7], s21 offen offset:2048 lds
    buffer_load_dwordx4 v1, s[4:7], s21 offen offset:3072 lds
    s_add_u32 s21, s21, 4096
    s_add_u32 s22, s22, 4096
    s_mov_b32 m0, s22
    s_nop 0
    buffer_load_dwordx4 v1, s[4:7], s21 offen offset:0 lds
    buffer_load_dwordx4 v1, s[4:7], s21 offen offset:1024 lds
    buffer_load_dwordx4 v1, s[4:7], s21 offen offset:2048 lds
    buffer_load_dwordx4 v1, s[4:7], s21 offen offset:3072 lds
    s_waitcnt vmcnt(20)
    v_mov_b32 v125, 1
    ds_write_b32 v126, v125
    s_waitcnt vmcnt(16)
    v_mov_b32 v125, 2
    ds_write_b32 v126, v125
    s_waitcnt vmcnt(12)
    v_mov_b32 v125, 3
    ds_write_b32 v126, v125
    s_waitcnt vmcnt(8)
    v_mov_b32 v125, 4
    ds_write_b32 v126, v125
    s_lshl_b32 s21, s16, 7
    s_lshl_b32 s22, s17, 2
    s_add_u32 s21, s21, s22
    s_add_u32 s21, s21, 35999744
    v_mov_b32 v124, s45
    v_mov_b32 v127, 0
    s_cmp_lg_u32 s29, 0
    s_cbranch_scc1 Lxcc147
    s_mov_b64 exec, 1
    buffer_store_dword v124, v127, s[4:7], s21 offen sc1
    s_mov_b64 exec, -1
Lxcc147:
    s_nop 0
    s_lshl_b32 s21, s16, 4
    s_add_u32 s21, s21, s17
    s_lshl_b32 s21, s21, 2
    s_add_u32 s21, s21, s29
    s_lshl_b32 s21, s21, 12
    s_add_u32 s21, s21, 12926976
    v_mov_b32 v76, -1
    v_mov_b32 v77, -1
    v_mov_b32 v78, -1
    v_mov_b32 v79, -1
    buffer_store_dwordx4 v[76:79], v1, s[4:7], s21 offen offset:0 sc1
    buffer_store_dwordx4 v[76:79], v1, s[4:7], s21 offen offset:1024 sc1
    buffer_store_dwordx4 v[76:79], v1, s[4:7], s21 offen offset:2048 sc1
    buffer_store_dwordx4 v[76:79], v1, s[4:7], s21 offen offset:3072 sc1
    s_waitcnt vmcnt(5)
    s_waitcnt vmcnt(0)
    v_mov_b32 v125, 5
    ds_write_b32 v126, v125
    v_mov_b32 v116, 148992
    ds_read_b128 v[116:119], v116
    s_waitcnt lgkmcnt(0)
    v_min3_u32 v116, v116, v117, v118
    v_min_u32 v116, v116, v119
    v_cmp_gt_u32 vcc, 3, v116
    s_nop 1
    s_cbranch_vccz Lc148d
    s_nop 1
    s_mov_b32 s25, 2000000
Lc148:
    s_nop 0
    s_sleep 1
    v_mov_b32 v116, 148992
    ds_read_b128 v[116:119], v116
    s_waitcnt lgkmcnt(0)
    v_min3_u32 v116, v116, v117, v118
    v_min_u32 v116, v116, v119
    v_cmp_gt_u32 vcc, 3, v116
    s_nop 1
    s_cbranch_vccz Lc148d
    s_sub_u32 s25, s25, 1
    s_cmp_lg_u32 s25, 0
    s_cbranch_scc1 Lc148
    s_nop 0
Lc148d:
    s_mul_i32 s21, s17, 207872
    s_add_u32 s21, s21, s24
    s_add_u32 s21, s21, 1884160
    s_add_u32 s22, s24, 0
    s_mov_b32 m0, s22
    s_nop 0
    buffer_load_dwordx4 v1, s[4:7], s21 offen offset:0 lds
    buffer_load_dwordx4 v1, s[4:7], s21 offen offset:1024 lds
    buffer_load_dwordx4 v1, s[4:7], s21 offen offset:2048 lds
    buffer_load_dwordx4 v1, s[4:7], s21 offen offset:3072 lds
    s_add_u32 s21, s21, 4096
    s_add_u32 s22, s22, 4096
    s_mov_b32 m0, s22
    s_nop 0
    buffer_load_dwordx4 v1, s[4:7], s21 offen offset:0 lds
    buffer_load_dwordx4 v1, s[4:7], s21 offen offset:1024 lds
    buffer_load_dwordx4 v1, s[4:7], s21 offen offset:2048 lds
    buffer_load_dwordx4 v1, s[4:7], s21 offen offset:3072 lds
    s_mul_i32 s21, s17, 207872
    s_add_u32 s21, s21, s24
    s_add_u32 s21, s21, 1913856
    s_add_u32 s22, s24, 29696
    s_mov_b32 m0, s22
    s_nop 0
    buffer_load_dwordx4 v1, s[4:7], s21 offen offset:0 lds
    buffer_load_dwordx4 v1, s[4:7], s21 offen offset:1024 lds
    buffer_load_dwordx4 v1, s[4:7], s21 offen offset:2048 lds
    buffer_load_dwordx4 v1, s[4:7], s21 offen offset:3072 lds
    s_add_u32 s21, s21, 4096
    s_add_u32 s22, s22, 4096
    s_mov_b32 m0, s22
    s_nop 0
    buffer_load_dwordx4 v1, s[4:7], s21 offen offset:0 lds
    buffer_load_dwordx4 v1, s[4:7], s21 offen offset:1024 lds
    buffer_load_dwordx4 v1, s[4:7], s21 offen offset:2048 lds
    buffer_load_dwordx4 v1, s[4:7], s21 offen offset:3072 lds
    s_mul_i32 s21, s17, 207872
    s_add_u32 s21, s21, s24
    s_add_u32 s21, s21, 1943552
    s_add_u32 s22, s24, 59392
    s_mov_b32 m0, s22
    s_nop 0
    buffer_load_dwordx4 v1, s[4:7], s21 offen offset:0 lds
    buffer_load_dwordx4 v1, s[4:7], s21 offen offset:1024 lds
    buffer_load_dwordx4 v1, s[4:7], s21 offen offset:2048 lds
    buffer_load_dwordx4 v1, s[4:7], s21 offen offset:3072 lds
    s_add_u32 s21, s21, 4096
    s_add_u32 s22, s22, 4096
    s_mov_b32 m0, s22
    s_nop 0
    buffer_load_dwordx4 v1, s[4:7], s21 offen offset:0 lds
    buffer_load_dwordx4 v1, s[4:7], s21 offen offset:1024 lds
    buffer_load_dwordx4 v1, s[4:7], s21 offen offset:2048 lds
    buffer_load_dwordx4 v1, s[4:7], s21 offen offset:3072 lds
    s_waitcnt vmcnt(16)
    s_waitcnt vmcnt(8)
    s_waitcnt vmcnt(0)
    v_mov_b32 v125, 6
    ds_write_b32 v126, v125
    v_mov_b32 v116, 148992
    ds_read_b128 v[116:119], v116
    s_waitcnt lgkmcnt(0)
    v_min3_u32 v116, v116, v117, v118
    v_min_u32 v116, v116, v119
    v_cmp_gt_u32 vcc, 7, v116
    s_nop 1
    s_cbranch_vccz Lc149d
    s_nop 1
    s_mov_b32 s25, 2000000
Lc149:
    s_nop 0
    s_sleep 1
    v_mov_b32 v116, 148992
    ds_read_b128 v[116:119], v116
    s_waitcnt lgkmcnt(0)
    v_min3_u32 v116, v116, v117, v118
    v_min_u32 v116, v116, v119
    v_cmp_gt_u32 vcc, 7, v116
    s_nop 1
    s_cbranch_vccz Lc149d
    s_sub_u32 s25, s25, 1
    s_cmp_lg_u32 s25, 0
    s_cbranch_scc1 Lc149
    s_nop 0
Lc149d:
    s_mul_i32 s21, s17, 207872
    s_add_u32 s21, s21, s24
    s_add_u32 s21, s21, 1973248
    s_add_u32 s22, s24, 89088
    s_mov_b32 m0, s22
    s_nop 0
    buffer_load_dwordx4 v1, s[4:7], s21 offen offset:0 lds
    buffer_load_dwordx4 v1, s[4:7], s21 offen offset:1024 lds
    buffer_load_dwordx4 v1, s[4:7], s21 offen offset:2048 lds
    buffer_load_dwordx4 v1, s[4:7], s21 offen offset:3072 lds
    s_add_u32 s21, s21, 4096
    s_add_u32 s22, s22, 4096
    s_mov_b32 m0, s22
    s_nop 0
    buffer_load_dwordx4 v1, s[4:7], s21 offen offset:0 lds
    buffer_load_dwordx4 v1, s[4:7], s21 offen offset:1024 lds
    buffer_load_dwordx4 v1, s[4:7], s21 offen offset:2048 lds
    buffer_load_dwordx4 v1, s[4:7], s21 offen offset:3072 lds
    s_mul_i32 s21, s17, 207872
    s_add_u32 s21, s21, s24
    s_add_u32 s21, s21, 2002944
    s_add_u32 s22, s24, 118784
    s_mov_b32 m0, s22
    s_nop 0
    buffer_load_dwordx4 v1, s[4:7], s21 offen offset:0 lds
    buffer_load_dwordx4 v1, s[4:7], s21 offen offset:1024 lds
    buffer_load_dwordx4 v1, s[4:7], s21 offen offset:2048 lds
    buffer_load_dwordx4 v1, s[4:7], s21 offen offset:3072 lds
    s_add_u32 s21, s21, 4096
    s_add_u32 s22, s22, 4096
    s_mov_b32 m0, s22
    s_nop 0
    buffer_load_dwordx4 v1, s[4:7], s21 offen offset:0 lds
    buffer_load_dwordx4 v1, s[4:7], s21 offen offset:1024 lds
    buffer_load_dwordx4 v1, s[4:7], s21 offen offset:2048 lds
    buffer_load_dwordx4 v1, s[4:7], s21 offen offset:3072 lds
    s_mul_i32 s21, s17, 207872
    s_add_u32 s21, s21, s24
    s_add_u32 s21, s21, 2032640
    buffer_load_dwordx4 a[0:3], v1, s[4:7], s21 offen offset:0
    buffer_load_dwordx4 a[4:7], v1, s[4:7], s21 offen offset:1024
    buffer_load_dwordx4 a[8:11], v1, s[4:7], s21 offen offset:2048
    buffer_load_dwordx4 a[12:15], v1, s[4:7], s21 offen offset:3072
    s_add_u32 s21, s21, 4096
    buffer_load_dwordx4 a[16:19], v1, s[4:7], s21 offen offset:0
    buffer_load_dwordx4 a[20:23], v1, s[4:7], s21 offen offset:1024
    buffer_load_dwordx4 a[24:27], v1, s[4:7], s21 offen offset:2048
    buffer_load_dwordx4 a[28:31], v1, s[4:7], s21 offen offset:3072
    s_waitcnt vmcnt(16)
    v_mov_b32 v125, 7
    ds_write_b32 v126, v125
    s_mul_i32 s21, s17, 207872
    s_add_u32 s21, s21, s24
    s_add_u32 s21, s21, 2062336
    buffer_load_dwordx4 v[76:79], v1, s[4:7], s21 offen offset:0
    buffer_load_dwordx4 v[80:83], v1, s[4:7], s21 offen offset:1024
    buffer_load_dwordx4 v[84:87], v1, s[4:7], s21 offen offset:2048
    buffer_load_dwordx4 v[88:91], v1, s[4:7], s21 offen offset:3072
    s_add_u32 s21, s21, 4096
    buffer_load_dwordx4 v[92:95], v1, s[4:7], s21 offen offset:0
    buffer_load_dwordx4 v[96:99], v1, s[4:7], s21 offen offset:1024
    buffer_load_dwordx4 v[100:103], v1, s[4:7], s21 offen offset:2048
    buffer_load_dwordx4 v[104:107], v1, s[4:7], s21 offen offset:3072
    s_waitcnt vmcnt(16)
    v_mov_b32 v125, 8
    ds_write_b32 v126, v125
    v_mov_b32 v116, 148992
    ds_read_b128 v[116:119], v116
    s_waitcnt lgkmcnt(0)
    v_min3_u32 v116, v116, v117, v118
    v_min_u32 v116, v116, v119
    v_cmp_gt_u32 vcc, 8, v116
    s_nop 1
    s_cbranch_vccz Lc150d
    s_nop 1
    s_mov_b32 s25, 2000000
Lc150:
    s_nop 0
    s_sleep 1
    v_mov_b32 v116, 148992
    ds_read_b128 v[116:119], v116
    s_waitcnt lgkmcnt(0)
    v_min3_u32 v116, v116, v117, v118
    v_min_u32 v116, v116, v119
    v_cmp_gt_u32 vcc, 8, v116
    s_nop 1
    s_cbranch_vccz Lc150d
    s_sub_u32 s25, s25, 1
    s_cmp_lg_u32 s25, 0
    s_cbranch_scc1 Lc150
    s_nop 0
Lc150d:
    s_waitcnt vmcnt(8)
    v_add_u32 v122, s24, v1
    ds_write_b128 v122, a[0:3] offset:0
    ds_write_b128 v122, a[4:7] offset:1024
    ds_write_b128 v122, a[8:11] offset:2048
    ds_write_b128 v122, a[12:15] offset:3072
    ds_write_b128 v122, a[16:19] offset:4096
    ds_write_b128 v122, a[20:23] offset:5120
    ds_write_b128 v122, a[24:27] offset:6144
    ds_write_b128 v122, a[28:31] offset:7168
    v_mov_b32 v125, 9
    ds_write_b32 v126, v125
    s_waitcnt vmcnt(0)
    v_add_u32 v122, s24, v1
    ds_write_b128 v122, v[76:79] offset:29696
    ds_write_b128 v122, v[80:83] offset:30720
    ds_write_b128 v122, v[84:87] offset:31744
    ds_write_b128 v122, v[88:91] offset:32768
    ds_write_b128 v122, v[92:95] offset:33792
    ds_write_b128 v122, v[96:99] offset:34816
    ds_write_b128 v122, v[100:103] offset:35840
    ds_write_b128 v122, v[104:107] offset:36864
    v_mov_b32 v125, 10
    ds_write_b32 v126, v125
    s_mul_i32 s21, s20, 401408
    s_add_u32 s21, s21, s24
    s_add_u32 s21, s21, 5210112
    s_add_u32 s22, s24, 59392
    s_mov_b32 m0, s22
    s_nop 0
    buffer_load_dwordx4 v1, s[4:7], s21 offen offset:0 lds
    buffer_load_dwordx4 v1, s[4:7], s21 offen offset:1024 lds
    buffer_load_dwordx4 v1, s[4:7], s21 offen offset:2048 lds
    buffer_load_dwordx4 v1, s[4:7], s21 offen offset:3072 lds
    s_add_u32 s21, s21, 4096
    s_add_u32 s22, s22, 4096
    s_mov_b32 m0, s22
    s_nop 0
    buffer_load_dwordx4 v1, s[4:7], s21 offen offset:0 lds
    buffer_load_dwordx4 v1, s[4:7], s21 offen offset:1024 lds
    buffer_load_dwordx4 v1, s[4:7], s21 offen offset:2048 lds
    s_mul_i32 s21, s20, 401408
    s_lshl_b32 s22, s30, 2
    s_add_u32 s22, s22, s29
    s_mul_i32 s22, s22, 3584
    s_add_u32 s21, s21, s22
    s_add_u32 s21, s21, 5353472
    s_mov_b64 exec, 0x1fffffff
    buffer_load_dword v124, v123, s[4:7], s21 offen
    s_mov_b64 exec, -1
    s_mul_i32 s21, s20, 401408
    s_add_u32 s21, s21, s24
    s_add_u32 s21, s21, 5468160
    buffer_load_dwordx4 a[56:59], v1, s[4:7], s21 offen offset:0
    buffer_load_dwordx4 a[60:63], v1, s[4:7], s21 offen offset:1024
    buffer_load_dwordx4 a[64:67], v1, s[4:7], s21 offen offset:2048
    buffer_load_dwordx4 a[68:71], v1, s[4:7], s21 offen offset:3072
    s_add_u32 s21, s21, 4096
    buffer_load_dwordx4 a[72:75], v1, s[4:7], s21 offen offset:0
    buffer_load_dwordx4 a[76:79], v1, s[4:7], s21 offen offset:1024
    buffer_load_dwordx4 a[80:83], v1, s[4:7], s21 offen offset:2048
    s_mul_i32 s21, s20, 401408
    s_add_u32 s21, s21, s24
    s_add_u32 s21, s21, 5496832
    buffer_load_dwordx4 a[84:87], v1, s[4:7], s21 offen offset:0
    buffer_load_dwordx4 a[88:91], v1, s[4:7], s21 offen offset:1024
    buffer_load_dwordx4 a[92:95], v1, s[4:7], s21 offen offset:2048
    buffer_load_dwordx4 a[96:99], v1, s[4:7], s21 offen offset:3072
    s_add_u32 s21, s21, 4096
    buffer_load_dwordx4 a[100:103], v1, s[4:7], s21 offen offset:0
    buffer_load_dwordx4 a[104:107], v1, s[4:7], s21 offen offset:1024
    buffer_load_dwordx4 a[108:111], v1, s[4:7], s21 offen offset:2048
    s_mul_i32 s21, s20, 401408
    s_add_u32 s21, s21, s24
    s_add_u32 s21, s21, 5525504
    buffer_load_dwordx4 a[112:115], v1, s[4:7], s21 offen offset:0
    buffer_load_dwordx4 a[116:119], v1, s[4:7], s21 offen offset:1024
    buffer_load_dwordx4 a[120:123], v1, s[4:7], s21 offen offset:2048
    buffer_load_dwordx4 a[124:127], v1, s[4:7], s21 offen offset:3072
    s_add_u32 s21, s21, 4096
    buffer_load_dwordx4 v[8:11], v1, s[4:7], s21 offen offset:0
    buffer_load_dwordx4 v[12:15], v1, s[4:7], s21 offen offset:1024
    buffer_load_dwordx4 v[16:19], v1, s[4:7], s21 offen offset:2048
    s_mul_i32 s21, s20, 401408
    s_add_u32 s21, s21, s24
    s_add_u32 s21, s21, 5554176
    buffer_load_dwordx4 v[20:23], v1, s[4:7], s21 offen offset:0
    buffer_load_dwordx4 v[24:27], v1, s[4:7], s21 offen offset:1024
    buffer_load_dwordx4 v[28:31], v1, s[4:7], s21 offen offset:2048
    buffer_load_dwordx4 v[32:35], v1, s[4:7], s21 offen offset:3072
    s_add_u32 s21, s21, 4096
    buffer_load_dwordx4 v[36:39], v1, s[4:7], s21 offen offset:0
    buffer_load_dwordx4 v[40:43], v1, s[4:7], s21 offen offset:1024
    buffer_load_dwordx4 v[44:47], v1, s[4:7], s21 offen offset:2048
    s_mul_i32 s21, s20, 401408
    s_add_u32 s21, s21, s24
    s_add_u32 s21, s21, 5582848
    buffer_load_dwordx4 v[48:51], v1, s[4:7], s21 offen offset:0
    buffer_load_dwordx4 v[52:55], v1, s[4:7], s21 offen offset:1024
    buffer_load_dwordx4 v[56:59], v1, s[4:7], s21 offen offset:2048
    buffer_load_dwordx4 v[60:63], v1, s[4:7], s21 offen offset:3072
    s_add_u32 s21, s21, 4096
    buffer_load_dwordx4 v[64:67], v1, s[4:7], s21 offen offset:0
    buffer_load_dwordx4 v[68:71], v1, s[4:7], s21 offen offset:1024
    buffer_load_dwordx4 v[72:75], v1, s[4:7], s21 offen offset:2048
    v_mov_b32 v116, 148992
    ds_read_b128 v[116:119], v116
    s_waitcnt lgkmcnt(0)
    v_min3_u32 v116, v116, v117, v118
    v_min_u32 v116, v116, v119
    v_cmp_gt_u32 vcc, 9, v116
    s_nop 1
    s_cbranch_vccz Lc151d
    s_nop 1
    s_mov_b32 s25, 2000000
Lc151:
    s_nop 0
    s_sleep 1
    v_mov_b32 v116, 148992
    ds_read_b128 v[116:119], v116
    s_waitcnt lgkmcnt(0)
    v_min3_u32 v116, v116, v117, v118
    v_min_u32 v116, v116, v119
    v_cmp_gt_u32 vcc, 9, v116
    s_nop 1
    s_cbranch_vccz Lc151d
    s_sub_u32 s25, s25, 1
    s_cmp_lg_u32 s25, 0
    s_cbranch_scc1 Lc151
    s_nop 0
Lc151d:
    s_mul_i32 s21, s20, 401408
    s_add_u32 s21, s21, s24
    s_add_u32 s21, s21, 5238784
    s_add_u32 s22, s24, 89088
    s_mov_b32 m0, s22
    s_nop 0
    buffer_load_dwordx4 v1, s[4:7], s21 offen offset:0 lds
    buffer_load_dwordx4 v1, s[4:7], s21 offen offset:1024 lds
    buffer_load_dwordx4 v1, s[4:7], s21 offen offset:2048 lds
    buffer_load_dwordx4 v1, s[4:7], s21 offen offset:3072 lds
    s_add_u32 s21, s21, 4096
    s_add_u32 s22, s22, 4096
    s_mov_b32 m0, s22
    s_nop 0
    buffer_load_dwordx4 v1, s[4:7], s21 offen offset:0 lds
    buffer_load_dwordx4 v1, s[4:7], s21 offen offset:1024 lds
    buffer_load_dwordx4 v1, s[4:7], s21 offen offset:2048 lds
    v_mov_b32 v116, 148992
    ds_read_b128 v[116:119], v116
    s_waitcnt lgkmcnt(0)
    v_min3_u32 v116, v116, v117, v118
    v_min_u32 v116, v116, v119
    v_cmp_gt_u32 vcc, 10, v116
    s_nop 1
    s_cbranch_vccz Lc152d
    s_nop 1
    s_mov_b32 s25, 2000000
Lc152:
    s_nop 0
    s_sleep 1
    v_mov_b32 v116, 148992
    ds_read_b128 v[116:119], v116
    s_waitcnt lgkmcnt(0)
    v_min3_u32 v116, v116, v117, v118
    v_min_u32 v116, v116, v119
    v_cmp_gt_u32 vcc, 10, v116
    s_nop 1
    s_cbranch_vccz Lc152d
    s_sub_u32 s25, s25, 1
    s_cmp_lg_u32 s25, 0
    s_cbranch_scc1 Lc152
    s_nop 0
Lc152d:
    s_mul_i32 s21, s20, 401408
    s_add_u32 s21, s21, s24
    s_add_u32 s21, s21, 5267456
    s_add_u32 s22, s24, 118784
    s_mov_b32 m0, s22
    s_nop 0
    buffer_load_dwordx4 v1, s[4:7], s21 offen offset:0 lds
    buffer_load_dwordx4 v1, s[4:7], s21 offen offset:1024 lds
    buffer_load_dwordx4 v1, s[4:7], s21 offen offset:2048 lds
    buffer_load_dwordx4 v1, s[4:7], s21 offen offset:3072 lds
    s_add_u32 s21, s21, 4096
    s_add_u32 s22, s22, 4096
    s_mov_b32 m0, s22
    s_nop 0
    buffer_load_dwordx4 v1, s[4:7], s21 offen offset:0 lds
    buffer_load_dwordx4 v1, s[4:7], s21 offen offset:1024 lds
    buffer_load_dwordx4 v1, s[4:7], s21 offen offset:2048 lds
    v_mov_b32 v116, 148992
    ds_read_b128 v[116:119], v116
    s_waitcnt lgkmcnt(0)
    v_min3_u32 v116, v116, v117, v118
    v_min_u32 v116, v116, v119
    v_cmp_gt_u32 vcc, 11, v116
    s_nop 1
    s_cbranch_vccz Lc153d
    s_nop 1
    s_mov_b32 s25, 2000000
Lc153:
    s_nop 0
    s_sleep 1
    v_mov_b32 v116, 148992
    ds_read_b128 v[116:119], v116
    s_waitcnt lgkmcnt(0)
    v_min3_u32 v116, v116, v117, v118
    v_min_u32 v116, v116, v119
    v_cmp_gt_u32 vcc, 11, v116
    s_nop 1
    s_cbranch_vccz Lc153d
    s_sub_u32 s25, s25, 1
    s_cmp_lg_u32 s25, 0
    s_cbranch_scc1 Lc153
    s_nop 0
Lc153d:
    s_mul_i32 s21, s20, 401408
    s_add_u32 s21, s21, s24
    s_add_u32 s21, s21, 5296128
    s_add_u32 s22, s24, 0
    s_mov_b32 m0, s22
    s_nop 0
    buffer_load_dwordx4 v1, s[4:7], s21 offen offset:0 lds
    buffer_load_dwordx4 v1, s[4:7], s21 offen offset:1024 lds
    buffer_load_dwordx4 v1, s[4:7], s21 offen offset:2048 lds
    buffer_load_dwordx4 v1, s[4:7], s21 offen offset:3072 lds
    s_add_u32 s21, s21, 4096
    s_add_u32 s22, s22, 4096
    s_mov_b32 m0, s22
    s_nop 0
    buffer_load_dwordx4 v1, s[4:7], s21 offen offset:0 lds
    buffer_load_dwordx4 v1, s[4:7], s21 offen offset:1024 lds
    buffer_load_dwordx4 v1, s[4:7], s21 offen offset:2048 lds
    v_mov_b32 v116, 148992
    ds_read_b128 v[116:119], v116
    s_waitcnt lgkmcnt(0)
    v_min3_u32 v116, v116, v117, v118
    v_min_u32 v116, v116, v119
    v_cmp_gt_u32 vcc, 12, v116
    s_nop 1
    s_cbranch_vccz Lc154d
    s_nop 1
    s_mov_b32 s25, 2000000
Lc154:
    s_nop 0
    s_sleep 1
    v_mov_b32 v116, 148992
    ds_read_b128 v[116:119], v116
    s_waitcnt lgkmcnt(0)
    v_min3_u32 v116, v116, v117, v118
    v_min_u32 v116, v116, v119
    v_cmp_gt_u32 vcc, 12, v116
    s_nop 1
    s_cbranch_vccz Lc154d
    s_sub_u32 s25, s25, 1
    s_cmp_lg_u32 s25, 0
    s_cbranch_scc1 Lc154
    s_nop 0
Lc154d:
    s_mul_i32 s21, s20, 401408
    s_add_u32 s21, s21, s24
    s_add_u32 s21, s21, 5324800
    s_add_u32 s22, s24, 29696
    s_mov_b32 m0, s22
    s_nop 0
    buffer_load_dwordx4 v1, s[4:7], s21 offen offset:0 lds
    buffer_load_dwordx4 v1, s[4:7], s21 offen offset:1024 lds
    buffer_load_dwordx4 v1, s[4:7], s21 offen offset:2048 lds
    buffer_load_dwordx4 v1, s[4:7], s21 offen offset:3072 lds
    s_add_u32 s21, s21, 4096
    s_add_u32 s22, s22, 4096
    s_mov_b32 m0, s22
    s_nop 0
    buffer_load_dwordx4 v1, s[4:7], s21 offen offset:0 lds
    buffer_load_dwordx4 v1, s[4:7], s21 offen offset:1024 lds
    buffer_load_dwordx4 v1, s[4:7], s21 offen offset:2048 lds
    s_waitcnt vmcnt(63)
    s_waitcnt vmcnt(21)
    s_waitcnt vmcnt(14)
    s_waitcnt vmcnt(7)
    s_waitcnt vmcnt(0)
    v_mov_b32 v125, 11
    ds_write_b32 v126, v125
    s_mul_i32 s23, s27, 112
    s_mul_i32 s22, s29, 28
    s_add_u32 s23, s23, s22
    s_lshl_b32 s23, s23, 10
    s_add_u32 s23, s23, 21334016
    v_mov_b32 v116, s44
    ds_read_b32 v116, v116
    s_waitcnt lgkmcnt(0)
    v_cmp_gt_u32 vcc, 13, v116
    s_nop 1
    s_cbranch_vccz Lc155d
    s_nop 1
    s_mov_b32 s25, 2000000
Lc155:
    s_nop 0
    s_sleep 1
    v_mov_b32 v116, s44
    ds_read_b32 v116, v116
    s_waitcnt lgkmcnt(0)
    v_cmp_gt_u32 vcc, 13, v116
    s_nop 1
    s_cbranch_vccz Lc155d
    s_sub_u32 s25, s25, 1
    s_cmp_lg_u32 s25, 0
    s_cbranch_scc1 Lc155
    s_nop 0
Lc155d:
    buffer_load_dwordx4 v[76:79], v120, s[4:7], s23 offen offset:0
    buffer_load_dwordx4 v[80:83], v120, s[4:7], s23 offen offset:256
    s_add_u32 s23, s23, 2048
    buffer_load_dwordx4 v[84:87], v120, s[4:7], s23 offen offset:0
    buffer_load_dwordx4 v[88:91], v120, s[4:7], s23 offen offset:256
    s_add_u32 s23, s23, 2048
    buffer_load_dwordx4 v[92:95], v120, s[4:7], s23 offen offset:0
    buffer_load_dwordx4 v[96:99], v120, s[4:7], s23 offen offset:256
    s_add_u32 s23, s23, 2048
    buffer_load_dwordx4 v[100:103], v120, s[4:7], s23 offen offset:0
    buffer_load_dwordx4 v[104:107], v120, s[4:7], s23 offen offset:256
    s_add_u32 s23, s23, 2048
    buffer_load_dwordx4 v[108:111], v120, s[4:7], s23 offen offset:0
    buffer_load_dwordx4 v[112:115], v120, s[4:7], s23 offen offset:256
    s_add_u32 s23, s23, 2048
    s_waitcnt vmcnt(8)
    v_mfma_f32_16x16x32_bf16 a[0:3], a[56:59], v[76:79], 0
    v_mfma_f32_16x16x32_bf16 a[28:31], a[56:59], v[80:83], 0
    v_mfma_f32_16x16x32_bf16 a[4:7], a[60:63], v[76:79], 0
    v_mfma_f32_16x16x32_bf16 a[32:35], a[60:63], v[80:83], 0
    v_mfma_f32_16x16x32_bf16 a[8:11], a[64:67], v[76:79], 0
    v_mfma_f32_16x16x32_bf16 a[36:39], a[64:67], v[80:83], 0
    v_mfma_f32_16x16x32_bf16 a[12:15], a[68:71], v[76:79], 0
    v_mfma_f32_16x16x32_bf16 a[40:43], a[68:71], v[80:83], 0
    v_mfma_f32_16x16x32_bf16 a[16:19], a[72:75], v[76:79], 0
    v_mfma_f32_16x16x32_bf16 a[44:47], a[72:75], v[80:83], 0
    v_mfma_f32_16x16x32_bf16 a[20:23], a[76:79], v[76:79], 0
    v_mfma_f32_16x16x32_bf16 a[48:51], a[76:79], v[80:83], 0
    v_mfma_f32_16x16x32_bf16 a[24:27], a[80:83], v[76:79], 0
    v_mfma_f32_16x16x32_bf16 a[52:55], a[80:83], v[80:83], 0
    s_waitcnt vmcnt(6)
    v_mfma_f32_16x16x32_bf16 a[0:3], a[84:87], v[84:87], a[0:3]
    v_mfma_f32_16x16x32_bf16 a[28:31], a[84:87], v[88:91], a[28:31]
    v_mfma_f32_16x16x32_bf16 a[4:7], a[88:91], v[84:87], a[4:7]
    v_mfma_f32_16x16x32_bf16 a[32:35], a[88:91], v[88:91], a[32:35]
    v_mfma_f32_16x16x32_bf16 a[8:11], a[92:95], v[84:87], a[8:11]
    v_mfma_f32_16x16x32_bf16 a[36:39], a[92:95], v[88:91], a[36:39]
    v_mfma_f32_16x16x32_bf16 a[12:15], a[96:99], v[84:87], a[12:15]
    v_mfma_f32_16x16x32_bf16 a[40:43], a[96:99], v[88:91], a[40:43]
    v_mfma_f32_16x16x32_bf16 a[16:19], a[100:103], v[84:87], a[16:19]
    v_mfma_f32_16x16x32_bf16 a[44:47], a[100:103], v[88:91], a[44:47]
    v_mfma_f32_16x16x32_bf16 a[20:23], a[104:107], v[84:87], a[20:23]
    v_mfma_f32_16x16x32_bf16 a[48:51], a[104:107], v[88:91], a[48:51]
    v_mfma_f32_16x16x32_bf16 a[24:27], a[108:111], v[84:87], a[24:27]
    v_mfma_f32_16x16x32_bf16 a[52:55], a[108:111], v[88:91], a[52:55]
    s_waitcnt vmcnt(4)
    v_mfma_f32_16x16x32_bf16 a[0:3], a[112:115], v[92:95], a[0:3]
    v_mfma_f32_16x16x32_bf16 a[28:31], a[112:115], v[96:99], a[28:31]
    v_mfma_f32_16x16x32_bf16 a[4:7], a[116:119], v[92:95], a[4:7]
    v_mfma_f32_16x16x32_bf16 a[32:35], a[116:119], v[96:99], a[32:35]
    v_mfma_f32_16x16x32_bf16 a[8:11], a[120:123], v[92:95], a[8:11]
    v_mfma_f32_16x16x32_bf16 a[36:39], a[120:123], v[96:99], a[36:39]
    v_mfma_f32_16x16x32_bf16 a[12:15], a[124:127], v[92:95], a[12:15]
    v_mfma_f32_16x16x32_bf16 a[40:43], a[124:127], v[96:99], a[40:43]
    v_mfma_f32_16x16x32_bf16 a[16:19], v[8:11], v[92:95], a[16:19]
    v_mfma_f32_16x16x32_bf16 a[44:47], v[8:11], v[96:99], a[44:47]
    v_mfma_f32_16x16x32_bf16 a[20:23], v[12:15], v[92:95], a[20:23]
    v_mfma_f32_16x16x32_bf16 a[48:51], v[12:15], v[96:99], a[48:51]
    v_mfma_f32_16x16x32_bf16 a[24:27], v[16:19], v[92:95], a[24:27]
    v_mfma_f32_16x16x32_bf16 a[52:55], v[16:19], v[96:99], a[52:55]
    s_waitcnt vmcnt(2)
    v_mfma_f32_16x16x32_bf16 a[0:3], v[20:23], v[100:103], a[0:3]
    v_mfma_f32_16x16x32_bf16 a[28:31], v[20:23], v[104:107], a[28:31]
    v_mfma_f32_16x16x32_bf16 a[4:7], v[24:27], v[100:103], a[4:7]
    v_mfma_f32_16x16x32_bf16 a[32:35], v[24:27], v[104:107], a[32:35]
    v_mfma_f32_16x16x32_bf16 a[8:11], v[28:31], v[100:103], a[8:11]
    v_mfma_f32_16x16x32_bf16 a[36:39], v[28:31], v[104:107], a[36:39]
    v_mfma_f32_16x16x32_bf16 a[12:15], v[32:35], v[100:103], a[12:15]
    v_mfma_f32_16x16x32_bf16 a[40:43], v[32:35], v[104:107], a[40:43]
    v_mfma_f32_16x16x32_bf16 a[16:19], v[36:39], v[100:103], a[16:19]
    v_mfma_f32_16x16x32_bf16 a[44:47], v[36:39], v[104:107], a[44:47]
    v_mfma_f32_16x16x32_bf16 a[20:23], v[40:43], v[100:103], a[20:23]
    v_mfma_f32_16x16x32_bf16 a[48:51], v[40:43], v[104:107], a[48:51]
    v_mfma_f32_16x16x32_bf16 a[24:27], v[44:47], v[100:103], a[24:27]
    v_mfma_f32_16x16x32_bf16 a[52:55], v[44:47], v[104:107], a[52:55]
    s_waitcnt vmcnt(0)
    v_mfma_f32_16x16x32_bf16 a[0:3], v[48:51], v[108:111], a[0:3]
    v_mfma_f32_16x16x32_bf16 a[28:31], v[48:51], v[112:115], a[28:31]
    v_mfma_f32_16x16x32_bf16 a[4:7], v[52:55], v[108:111], a[4:7]
    v_mfma_f32_16x16x32_bf16 a[32:35], v[52:55], v[112:115], a[32:35]
    v_mfma_f32_16x16x32_bf16 a[8:11], v[56:59], v[108:111], a[8:11]
    v_mfma_f32_16x16x32_bf16 a[36:39], v[56:59], v[112:115], a[36:39]
    v_mfma_f32_16x16x32_bf16 a[12:15], v[60:63], v[108:111], a[12:15]
    v_mfma_f32_16x16x32_bf16 a[40:43], v[60:63], v[112:115], a[40:43]
    v_mfma_f32_16x16x32_bf16 a[16:19], v[64:67], v[108:111], a[16:19]
    v_mfma_f32_16x16x32_bf16 a[44:47], v[64:67], v[112:115], a[44:47]
    v_mfma_f32_16x16x32_bf16 a[20:23], v[68:71], v[108:111], a[20:23]
    v_mfma_f32_16x16x32_bf16 a[48:51], v[68:71], v[112:115], a[48:51]
    v_mfma_f32_16x16x32_bf16 a[24:27], v[72:75], v[108:111], a[24:27]
    v_mfma_f32_16x16x32_bf16 a[52:55], v[72:75], v[112:115], a[52:55]
    s_mul_i32 s21, s17, 89088
    s_lshl_b32 s22, s42, 2
    s_add_u32 s22, s22, s29
    s_mul_i32 s22, s22, 7424
    s_add_u32 s21, s21, s22
    s_add_u32 s21, s21, 0
    s_mov_b64 exec, -1
    buffer_load_dword v124, v123, s[4:7], s21 offen
    s_mov_b64 exec, -1
    s_mul_i32 s21, s17, 89088
    s_lshl_b32 s22, s42, 2
    s_add_u32 s22, s22, s29
    s_mul_i32 s22, s22, 3712
    s_add_u32 s21, s21, s22
    s_add_u32 s21, s21, 59392
    s_mov_b64 exec, 0x3fffffff
    buffer_load_dword v124, v123, s[4:7], s21 offen
    s_mov_b64 exec, -1
    v_mov_b32 v116, 148992
    ds_read_b128 v[116:119], v116
    s_waitcnt lgkmcnt(0)
    v_min3_u32 v116, v116, v117, v118
    v_min_u32 v116, v116, v119
    v_cmp_gt_u32 vcc, 19, v116
    s_nop 1
    s_cbranch_vccz Lc156d
    s_nop 1
    s_mov_b32 s25, 2000000
Lc156:
    s_nop 0
    s_sleep 1
    v_mov_b32 v116, 148992
    ds_read_b128 v[116:119], v116
    s_waitcnt lgkmcnt(0)
    v_min3_u32 v116, v116, v117, v118
    v_min_u32 v116, v116, v119
    v_cmp_gt_u32 vcc, 19, v116
    s_nop 1
    s_cbranch_vccz Lc156d
    s_sub_u32 s25, s25, 1
    s_cmp_lg_u32 s25, 0
    s_cbranch_scc1 Lc156
    s_nop 0
Lc156d:
    ds_write_b128 v121, a[0:3] offset:0
    ds_write_b128 v121, a[4:7] offset:64
    ds_write_b128 v121, a[8:11] offset:128
    ds_write_b128 v121, a[12:15] offset:192
    ds_write_b128 v121, a[16:19] offset:256
    ds_write_b128 v121, a[20:23] offset:320
    ds_write_b128 v121, a[24:27] offset:384
    ds_write_b128 v121, a[28:31] offset:7424
    ds_write_b128 v121, a[32:35] offset:7488
    ds_write_b128 v121, a[36:39] offset:7552
    ds_write_b128 v121, a[40:43] offset:7616
    ds_write_b128 v121, a[44:47] offset:7680
    ds_write_b128 v121, a[48:51] offset:7744
    ds_write_b128 v121, a[52:55] offset:7808
    v_mov_b32 v125, 12
    ds_write_b32 v126, v125
    v_mov_b32 v116, 148992
    ds_read_b128 v[116:119], v116
    s_waitcnt lgkmcnt(0)
    v_min3_u32 v116, v116, v117, v118
    v_min_u32 v116, v116, v119
    v_cmp_gt_u32 vcc, 22, v116
    s_nop 1
    s_cbranch_vccz Lc157d
    s_nop 1
    s_mov_b32 s25, 2000000
Lc157:
    s_nop 0
    s_sleep 1
    v_mov_b32 v116, 148992
    ds_read_b128 v[116:119], v116
    s_waitcnt lgkmcnt(0)
    v_min3_u32 v116, v116, v117, v118
    v_min_u32 v116, v116, v119
    v_cmp_gt_u32 vcc, 22, v116
    s_nop 1
    s_cbranch_vccz Lc157d
    s_sub_u32 s25, s25, 1
    s_cmp_lg_u32 s25, 0
    s_cbranch_scc1 Lc157
    s_nop 0
Lc157d:
    s_mul_i32 s21, s17, 89088
    s_add_u32 s21, s21, s24
    s_add_u32 s21, s21, 29696
    s_add_u32 s22, s24, 0
    s_mov_b32 m0, s22
    s_nop 0
    buffer_load_dwordx4 v1, s[4:7], s21 offen offset:0 lds
    buffer_load_dwordx4 v1, s[4:7], s21 offen offset:1024 lds
    buffer_load_dwordx4 v1, s[4:7], s21 offen offset:2048 lds
    buffer_load_dwordx4 v1, s[4:7], s21 offen offset:3072 lds
    s_add_u32 s21, s21, 4096
    s_add_u32 s22, s22, 4096
    s_mov_b32 m0, s22
    s_nop 0
    buffer_load_dwordx4 v1, s[4:7], s21 offen offset:0 lds
    buffer_load_dwordx4 v1, s[4:7], s21 offen offset:1024 lds
    buffer_load_dwordx4 v1, s[4:7], s21 offen offset:2048 lds
    buffer_load_dwordx4 v1, s[4:7], s21 offen offset:3072 lds
    v_mov_b32 v116, 148992
    ds_read_b128 v[116:119], v116
    s_waitcnt lgkmcnt(0)
    v_min3_u32 v116, v116, v117, v118
    v_min_u32 v116, v116, v119
    v_cmp_gt_u32 vcc, 24, v116
    s_nop 1
    s_cbranch_vccz Lc158d
    s_nop 1
    s_mov_b32 s25, 2000000
Lc158:
    s_nop 0
    s_sleep 1
    v_mov_b32 v116, 148992
    ds_read_b128 v[116:119], v116
    s_waitcnt lgkmcnt(0)
    v_min3_u32 v116, v116, v117, v118
    v_min_u32 v116, v116, v119
    v_cmp_gt_u32 vcc, 24, v116
    s_nop 1
    s_cbranch_vccz Lc158d
    s_sub_u32 s25, s25, 1
    s_cmp_lg_u32 s25, 0
    s_cbranch_scc1 Lc158
    s_nop 0
Lc158d:
    s_mul_i32 s21, s17, 89088
    s_add_u32 s21, s21, s24
    s_add_u32 s21, s21, 59392
    s_add_u32 s22, s24, 29696
    s_mov_b32 m0, s22
    s_nop 0
    buffer_load_dwordx4 v1, s[4:7], s21 offen offset:0 lds
    buffer_load_dwordx4 v1, s[4:7], s21 offen offset:1024 lds
    buffer_load_dwordx4 v1, s[4:7], s21 offen offset:2048 lds
    buffer_load_dwordx4 v1, s[4:7], s21 offen offset:3072 lds
    s_add_u32 s21, s21, 4096
    s_add_u32 s22, s22, 4096
    s_mov_b32 m0, s22
    s_nop 0
    buffer_load_dwordx4 v1, s[4:7], s21 offen offset:0 lds
    buffer_load_dwordx4 v1, s[4:7], s21 offen offset:1024 lds
    buffer_load_dwordx4 v1, s[4:7], s21 offen offset:2048 lds
    buffer_load_dwordx4 v1, s[4:7], s21 offen offset:3072 lds
    s_mul_i32 s21, s17, 89088
    s_add_u32 s21, s21, s24
    s_add_u32 s21, s21, 0
    s_add_u32 s22, s24, 59392
    s_mov_b32 m0, s22
    s_nop 0
    buffer_load_dwordx4 v1, s[4:7], s21 offen offset:0 lds
    buffer_load_dwordx4 v1, s[4:7], s21 offen offset:1024 lds
    buffer_load_dwordx4 v1, s[4:7], s21 offen offset:2048 lds
    buffer_load_dwordx4 v1, s[4:7], s21 offen offset:3072 lds
    s_add_u32 s21, s21, 4096
    s_add_u32 s22, s22, 4096
    s_mov_b32 m0, s22
    s_nop 0
    buffer_load_dwordx4 v1, s[4:7], s21 offen offset:0 lds
    buffer_load_dwordx4 v1, s[4:7], s21 offen offset:1024 lds
    buffer_load_dwordx4 v1, s[4:7], s21 offen offset:2048 lds
    buffer_load_dwordx4 v1, s[4:7], s21 offen offset:3072 lds
    s_waitcnt vmcnt(16)
    s_waitcnt vmcnt(8)
    v_mov_b32 v125, 13
    ds_write_b32 v126, v125
    s_waitcnt vmcnt(0)
    v_mov_b32 v125, 14
    ds_write_b32 v126, v125
    v_mov_b32 v116, 148992
    ds_read_b128 v[116:119], v116
    s_waitcnt lgkmcnt(0)
    v_min3_u32 v116, v116, v117, v118
    v_min_u32 v116, v116, v119
    v_cmp_gt_u32 vcc, 26, v116
    s_nop 1
    s_cbranch_vccz Lc159d
    s_nop 1
    s_mov_b32 s25, 2000000
Lc159:
    s_nop 0
    s_sleep 1
    v_mov_b32 v116, 148992
    ds_read_b128 v[116:119], v116
    s_waitcnt lgkmcnt(0)
    v_min3_u32 v116, v116, v117, v118
    v_min_u32 v116, v116, v119
    v_cmp_gt_u32 vcc, 26, v116
    s_nop 1
    s_cbranch_vccz Lc159d
    s_sub_u32 s25, s25, 1
    s_cmp_lg_u32 s25, 0
    s_cbranch_scc1 Lc159
    s_nop 0
Lc159d:
    v_mov_b32 v116, 148992
    ds_read_b128 v[116:119], v116
    s_waitcnt lgkmcnt(0)
    v_min3_u32 v116, v116, v117, v118
    v_min_u32 v116, v116, v119
    v_cmp_gt_u32 vcc, 28, v116
    s_nop 1
    s_cbranch_vccz Lc160d
    s_nop 1
    s_mov_b32 s25, 2000000
Lc160:
    s_nop 0
    s_sleep 1
    v_mov_b32 v116, 148992
    ds_read_b128 v[116:119], v116
    s_waitcnt lgkmcnt(0)
    v_min3_u32 v116, v116, v117, v118
    v_min_u32 v116, v116, v119
    v_cmp_gt_u32 vcc, 28, v116
    s_nop 1
    s_cbranch_vccz Lc160d
    s_sub_u32 s25, s25, 1
    s_cmp_lg_u32 s25, 0
    s_cbranch_scc1 Lc160
    s_nop 0
Lc160d:
    s_mul_i32 s21, s17, 207872
    s_add_u32 s21, s21, s24
    s_add_u32 s21, s21, 1884160
    s_add_u32 s22, s24, 0
    s_mov_b32 m0, s22
    s_nop 0
    buffer_load_dwordx4 v1, s[4:7], s21 offen offset:0 lds
    buffer_load_dwordx4 v1, s[4:7], s21 offen offset:1024 lds
    buffer_load_dwordx4 v1, s[4:7], s21 offen offset:2048 lds
    buffer_load_dwordx4 v1, s[4:7], s21 offen offset:3072 lds
    s_add_u32 s21, s21, 4096
    s_add_u32 s22, s22, 4096
    s_mov_b32 m0, s22
    s_nop 0
    buffer_load_dwordx4 v1, s[4:7], s21 offen offset:0 lds
    buffer_load_dwordx4 v1, s[4:7], s21 offen offset:1024 lds
    buffer_load_dwordx4 v1, s[4:7], s21 offen offset:2048 lds
    buffer_load_dwordx4 v1, s[4:7], s21 offen offset:3072 lds
    s_mul_i32 s21, s17, 207872
    s_add_u32 s21, s21, s24
    s_add_u32 s21, s21, 1913856
    s_add_u32 s22, s24, 29696
    s_mov_b32 m0, s22
    s_nop 0
    buffer_load_dwordx4 v1, s[4:7], s21 offen offset:0 lds
    buffer_load_dwordx4 v1, s[4:7], s21 offen offset:1024 lds
    buffer_load_dwordx4 v1, s[4:7], s21 offen offset:2048 lds
    buffer_load_dwordx4 v1, s[4:7], s21 offen offset:3072 lds
    s_add_u32 s21, s21, 4096
    s_add_u32 s22, s22, 4096
    s_mov_b32 m0, s22
    s_nop 0
    buffer_load_dwordx4 v1, s[4:7], s21 offen offset:0 lds
    buffer_load_dwordx4 v1, s[4:7], s21 offen offset:1024 lds
    buffer_load_dwordx4 v1, s[4:7], s21 offen offset:2048 lds
    buffer_load_dwordx4 v1, s[4:7], s21 offen offset:3072 lds
    s_mul_i32 s21, s17, 207872
    s_add_u32 s21, s21, s24
    s_add_u32 s21, s21, 1943552
    s_add_u32 s22, s24, 59392
    s_mov_b32 m0, s22
    s_nop 0
    buffer_load_dwordx4 v1, s[4:7], s21 offen offset:0 lds
    buffer_load_dwordx4 v1, s[4:7], s21 offen offset:1024 lds
    buffer_load_dwordx4 v1, s[4:7], s21 offen offset:2048 lds
    buffer_load_dwordx4 v1, s[4:7], s21 offen offset:3072 lds
    s_add_u32 s21, s21, 4096
    s_add_u32 s22, s22, 4096
    s_mov_b32 m0, s22
    s_nop 0
    buffer_load_dwordx4 v1, s[4:7], s21 offen offset:0 lds
    buffer_load_dwordx4 v1, s[4:7], s21 offen offset:1024 lds
    buffer_load_dwordx4 v1, s[4:7], s21 offen offset:2048 lds
    buffer_load_dwordx4 v1, s[4:7], s21 offen offset:3072 lds
    s_waitcnt vmcnt(16)
    s_waitcnt vmcnt(8)
    s_waitcnt vmcnt(0)
    v_mov_b32 v125, 15
    ds_write_b32 v126, v125
    v_mov_b32 v116, 148992
    ds_read_b128 v[116:119], v116
    s_waitcnt lgkmcnt(0)
    v_min3_u32 v116, v116, v117, v118
    v_min_u32 v116, v116, v119
    v_cmp_gt_u32 vcc, 32, v116
    s_nop 1
    s_cbranch_vccz Lc161d
    s_nop 1
    s_mov_b32 s25, 2000000
Lc161:
    s_nop 0
    s_sleep 1
    v_mov_b32 v116, 148992
    ds_read_b128 v[116:119], v116
    s_waitcnt lgkmcnt(0)
    v_min3_u32 v116, v116, v117, v118
    v_min_u32 v116, v116, v119
    v_cmp_gt_u32 vcc, 32, v116
    s_nop 1
    s_cbranch_vccz Lc161d
    s_sub_u32 s25, s25, 1
    s_cmp_lg_u32 s25, 0
    s_cbranch_scc1 Lc161
    s_nop 0
Lc161d:
    s_mul_i32 s21, s17, 207872
    s_add_u32 s21, s21, s24
    s_add_u32 s21, s21, 1973248
    s_add_u32 s22, s24, 89088
    s_mov_b32 m0, s22
    s_nop 0
    buffer_load_dwordx4 v1, s[4:7], s21 offen offset:0 lds
    buffer_load_dwordx4 v1, s[4:7], s21 offen offset:1024 lds
    buffer_load_dwordx4 v1, s[4:7], s21 offen offset:2048 lds
    buffer_load_dwordx4 v1, s[4:7], s21 offen offset:3072 lds
    s_add_u32 s21, s21, 4096
    s_add_u32 s22, s22, 4096
    s_mov_b32 m0, s22
    s_nop 0
    buffer_load_dwordx4 v1, s[4:7], s21 offen offset:0 lds
    buffer_load_dwordx4 v1, s[4:7], s21 offen offset:1024 lds
    buffer_load_dwordx4 v1, s[4:7], s21 offen offset:2048 lds
    buffer_load_dwordx4 v1, s[4:7], s21 offen offset:3072 lds
    s_mul_i32 s21, s17, 207872
    s_add_u32 s21, s21, s24
    s_add_u32 s21, s21, 2002944
    s_add_u32 s22, s24, 118784
    s_mov_b32 m0, s22
    s_nop 0
    buffer_load_dwordx4 v1, s[4:7], s21 offen offset:0 lds
    buffer_load_dwordx4 v1, s[4:7], s21 offen offset:1024 lds
    buffer_load_dwordx4 v1, s[4:7], s21 offen offset:2048 lds
    buffer_load_dwordx4 v1, s[4:7], s21 offen offset:3072 lds
    s_add_u32 s21, s21, 4096
    s_add_u32 s22, s22, 4096
    s_mov_b32 m0, s22
    s_nop 0
    buffer_load_dwordx4 v1, s[4:7], s21 offen offset:0 lds
    buffer_load_dwordx4 v1, s[4:7], s21 offen offset:1024 lds
    buffer_load_dwordx4 v1, s[4:7], s21 offen offset:2048 lds
    buffer_load_dwordx4 v1, s[4:7], s21 offen offset:3072 lds
    s_mul_i32 s21, s17, 207872
    s_add_u32 s21, s21, s24
    s_add_u32 s21, s21, 2032640
    buffer_load_dwordx4 a[0:3], v1, s[4:7], s21 offen offset:0
    buffer_load_dwordx4 a[4:7], v1, s[4:7], s21 offen offset:1024
    buffer_load_dwordx4 a[8:11], v1, s[4:7], s21 offen offset:2048
    buffer_load_dwordx4 a[12:15], v1, s[4:7], s21 offen offset:3072
    s_add_u32 s21, s21, 4096
    buffer_load_dwordx4 a[16:19], v1, s[4:7], s21 offen offset:0
    buffer_load_dwordx4 a[20:23], v1, s[4:7], s21 offen offset:1024
    buffer_load_dwordx4 a[24:27], v1, s[4:7], s21 offen offset:2048
    buffer_load_dwordx4 a[28:31], v1, s[4:7], s21 offen offset:3072
    s_waitcnt vmcnt(16)
    v_mov_b32 v125, 16
    ds_write_b32 v126, v125
    s_mul_i32 s21, s17, 207872
    s_add_u32 s21, s21, s24
    s_add_u32 s21, s21, 2062336
    buffer_load_dwordx4 v[76:79], v1, s[4:7], s21 offen offset:0
    buffer_load_dwordx4 v[80:83], v1, s[4:7], s21 offen offset:1024
    buffer_load_dwordx4 v[84:87], v1, s[4:7], s21 offen offset:2048
    buffer_load_dwordx4 v[88:91], v1, s[4:7], s21 offen offset:3072
    s_add_u32 s21, s21, 4096
    buffer_load_dwordx4 v[92:95], v1, s[4:7], s21 offen offset:0
    buffer_load_dwordx4 v[96:99], v1, s[4:7], s21 offen offset:1024
    buffer_load_dwordx4 v[100:103], v1, s[4:7], s21 offen offset:2048
    buffer_load_dwordx4 v[104:107], v1, s[4:7], s21 offen offset:3072
    s_waitcnt vmcnt(16)
    v_mov_b32 v125, 17
    ds_write_b32 v126, v125
    v_mov_b32 v116, 148992
    ds_read_b128 v[116:119], v116
    s_waitcnt lgkmcnt(0)
    v_min3_u32 v116, v116, v117, v118
    v_min_u32 v116, v116, v119
    v_cmp_gt_u32 vcc, 33, v116
    s_nop 1
    s_cbranch_vccz Lc162d
    s_nop 1
    s_mov_b32 s25, 2000000
Lc162:
    s_nop 0
    s_sleep 1
    v_mov_b32 v116, 148992
    ds_read_b128 v[116:119], v116
    s_waitcnt lgkmcnt(0)
    v_min3_u32 v116, v116, v117, v118
    v_min_u32 v116, v116, v119
    v_cmp_gt_u32 vcc, 33, v116
    s_nop 1
    s_cbranch_vccz Lc162d
    s_sub_u32 s25, s25, 1
    s_cmp_lg_u32 s25, 0
    s_cbranch_scc1 Lc162
    s_nop 0
Lc162d:
    s_waitcnt vmcnt(8)
    v_add_u32 v122, s24, v1
    ds_write_b128 v122, a[0:3] offset:0
    ds_write_b128 v122, a[4:7] offset:1024
    ds_write_b128 v122, a[8:11] offset:2048
    ds_write_b128 v122, a[12:15] offset:3072
    ds_write_b128 v122, a[16:19] offset:4096
    ds_write_b128 v122, a[20:23] offset:5120
    ds_write_b128 v122, a[24:27] offset:6144
    ds_write_b128 v122, a[28:31] offset:7168
    v_mov_b32 v125, 18
    ds_write_b32 v126, v125
    s_waitcnt vmcnt(0)
    v_add_u32 v122, s24, v1
    ds_write_b128 v122, v[76:79] offset:29696
    ds_write_b128 v122, v[80:83] offset:30720
    ds_write_b128 v122, v[84:87] offset:31744
    ds_write_b128 v122, v[88:91] offset:32768
    ds_write_b128 v122, v[92:95] offset:33792
    ds_write_b128 v122, v[96:99] offset:34816
    ds_write_b128 v122, v[100:103] offset:35840
    ds_write_b128 v122, v[104:107] offset:36864
    v_mov_b32 v125, 19
    ds_write_b32 v126, v125
    s_mul_i32 s21, s20, 401408
    s_add_u32 s21, s21, s24
    s_add_u32 s21, s21, 5210112
    s_add_u32 s22, s24, 59392
    s_mov_b32 m0, s22
    s_nop 0
    buffer_load_dwordx4 v1, s[4:7], s21 offen offset:0 lds
    buffer_load_dwordx4 v1, s[4:7], s21 offen offset:1024 lds
    buffer_load_dwordx4 v1, s[4:7], s21 offen offset:2048 lds
    buffer_load_dwordx4 v1, s[4:7], s21 offen offset:3072 lds
    s_add_u32 s21, s21, 4096
    s_add_u32 s22, s22, 4096
    s_mov_b32 m0, s22
    s_nop 0
    buffer_load_dwordx4 v1, s[4:7], s21 offen offset:0 lds
    buffer_load_dwordx4 v1, s[4:7], s21 offen offset:1024 lds
    buffer_load_dwordx4 v1, s[4:7], s21 offen offset:2048 lds
    s_mul_i32 s21, s20, 401408
    s_lshl_b32 s22, s30, 2
    s_add_u32 s22, s22, s29
    s_mul_i32 s22, s22, 3584
    s_add_u32 s21, s21, s22
    s_add_u32 s21, s21, 5353472
    s_mov_b64 exec, 0x1fffffff
    buffer_load_dword v124, v123, s[4:7], s21 offen
    s_mov_b64 exec, -1
    v_mov_b32 v116, 148992
    ds_read_b128 v[116:119], v116
    s_waitcnt lgkmcnt(0)
    v_min3_u32 v116, v116, v117, v118
    v_min_u32 v116, v116, v119
    v_cmp_gt_u32 vcc, 34, v116
    s_nop 1
    s_cbranch_vccz Lc163d
    s_nop 1
    s_mov_b32 s25, 2000000
Lc163:
    s_nop 0
    s_sleep 1
    v_mov_b32 v116, 148992
    ds_read_b128 v[116:119], v116
    s_waitcnt lgkmcnt(0)
    v_min3_u32 v116, v116, v117, v118
    v_min_u32 v116, v116, v119
    v_cmp_gt_u32 vcc, 34, v116
    s_nop 1
    s_cbranch_vccz Lc163d
    s_sub_u32 s25, s25, 1
    s_cmp_lg_u32 s25, 0
    s_cbranch_scc1 Lc163
    s_nop 0
Lc163d:
    s_mul_i32 s21, s20, 401408
    s_add_u32 s21, s21, s24
    s_add_u32 s21, s21, 5238784
    s_add_u32 s22, s24, 89088
    s_mov_b32 m0, s22
    s_nop 0
    buffer_load_dwordx4 v1, s[4:7], s21 offen offset:0 lds
    buffer_load_dwordx4 v1, s[4:7], s21 offen offset:1024 lds
    buffer_load_dwordx4 v1, s[4:7], s21 offen offset:2048 lds
    buffer_load_dwordx4 v1, s[4:7], s21 offen offset:3072 lds
    s_add_u32 s21, s21, 4096
    s_add_u32 s22, s22, 4096
    s_mov_b32 m0, s22
    s_nop 0
    buffer_load_dwordx4 v1, s[4:7], s21 offen offset:0 lds
    buffer_load_dwordx4 v1, s[4:7], s21 offen offset:1024 lds
    buffer_load_dwordx4 v1, s[4:7], s21 offen offset:2048 lds
    v_mov_b32 v116, 148992
    ds_read_b128 v[116:119], v116
    s_waitcnt lgkmcnt(0)
    v_min3_u32 v116, v116, v117, v118
    v_min_u32 v116, v116, v119
    v_cmp_gt_u32 vcc, 35, v116
    s_nop 1
    s_cbranch_vccz Lc164d
    s_nop 1
    s_mov_b32 s25, 2000000
Lc164:
    s_nop 0
    s_sleep 1
    v_mov_b32 v116, 148992
    ds_read_b128 v[116:119], v116
    s_waitcnt lgkmcnt(0)
    v_min3_u32 v116, v116, v117, v118
    v_min_u32 v116, v116, v119
    v_cmp_gt_u32 vcc, 35, v116
    s_nop 1
    s_cbranch_vccz Lc164d
    s_sub_u32 s25, s25, 1
    s_cmp_lg_u32 s25, 0
    s_cbranch_scc1 Lc164
    s_nop 0
Lc164d:
    s_mul_i32 s21, s20, 401408
    s_add_u32 s21, s21, s24
    s_add_u32 s21, s21, 5267456
    s_add_u32 s22, s24, 118784
    s_mov_b32 m0, s22
    s_nop 0
    buffer_load_dwordx4 v1, s[4:7], s21 offen offset:0 lds
    buffer_load_dwordx4 v1, s[4:7], s21 offen offset:1024 lds
    buffer_load_dwordx4 v1, s[4:7], s21 offen offset:2048 lds
    buffer_load_dwordx4 v1, s[4:7], s21 offen offset:3072 lds
    s_add_u32 s21, s21, 4096
    s_add_u32 s22, s22, 4096
    s_mov_b32 m0, s22
    s_nop 0
    buffer_load_dwordx4 v1, s[4:7], s21 offen offset:0 lds
    buffer_load_dwordx4 v1, s[4:7], s21 offen offset:1024 lds
    buffer_load_dwordx4 v1, s[4:7], s21 offen offset:2048 lds
    v_mov_b32 v116, 148992
    ds_read_b128 v[116:119], v116
    s_waitcnt lgkmcnt(0)
    v_min3_u32 v116, v116, v117, v118
    v_min_u32 v116, v116, v119
    v_cmp_gt_u32 vcc, 36, v116
    s_nop 1
    s_cbranch_vccz Lc165d
    s_nop 1
    s_mov_b32 s25, 2000000
Lc165:
    s_nop 0
    s_sleep 1
    v_mov_b32 v116, 148992
    ds_read_b128 v[116:119], v116
    s_waitcnt lgkmcnt(0)
    v_min3_u32 v116, v116, v117, v118
    v_min_u32 v116, v116, v119
    v_cmp_gt_u32 vcc, 36, v116
    s_nop 1
    s_cbranch_vccz Lc165d
    s_sub_u32 s25, s25, 1
    s_cmp_lg_u32 s25, 0
    s_cbranch_scc1 Lc165
    s_nop 0
Lc165d:
    s_mul_i32 s21, s20, 401408
    s_add_u32 s21, s21, s24
    s_add_u32 s21, s21, 5296128
    s_add_u32 s22, s24, 0
    s_mov_b32 m0, s22
    s_nop 0
    buffer_load_dwordx4 v1, s[4:7], s21 offen offset:0 lds
    buffer_load_dwordx4 v1, s[4:7], s21 offen offset:1024 lds
    buffer_load_dwordx4 v1, s[4:7], s21 offen offset:2048 lds
    buffer_load_dwordx4 v1, s[4:7], s21 offen offset:3072 lds
    s_add_u32 s21, s21, 4096
    s_add_u32 s22, s22, 4096
    s_mov_b32 m0, s22
    s_nop 0
    buffer_load_dwordx4 v1, s[4:7], s21 offen offset:0 lds
    buffer_load_dwordx4 v1, s[4:7], s21 offen offset:1024 lds
    buffer_load_dwordx4 v1, s[4:7], s21 offen offset:2048 lds
    v_mov_b32 v116, 148992
    ds_read_b128 v[116:119], v116
    s_waitcnt lgkmcnt(0)
    v_min3_u32 v116, v116, v117, v118
    v_min_u32 v116, v116, v119
    v_cmp_gt_u32 vcc, 37, v116
    s_nop 1
    s_cbranch_vccz Lc166d
    s_nop 1
    s_mov_b32 s25, 2000000
Lc166:
    s_nop 0
    s_sleep 1
    v_mov_b32 v116, 148992
    ds_read_b128 v[116:119], v116
    s_waitcnt lgkmcnt(0)
    v_min3_u32 v116, v116, v117, v118
    v_min_u32 v116, v116, v119
    v_cmp_gt_u32 vcc, 37, v116
    s_nop 1
    s_cbranch_vccz Lc166d
    s_sub_u32 s25, s25, 1
    s_cmp_lg_u32 s25, 0
    s_cbranch_scc1 Lc166
    s_nop 0
Lc166d:
    s_mul_i32 s21, s20, 401408
    s_add_u32 s21, s21, s24
    s_add_u32 s21, s21, 5324800
    s_add_u32 s22, s24, 29696
    s_mov_b32 m0, s22
    s_nop 0
    buffer_load_dwordx4 v1, s[4:7], s21 offen offset:0 lds
    buffer_load_dwordx4 v1, s[4:7], s21 offen offset:1024 lds
    buffer_load_dwordx4 v1, s[4:7], s21 offen offset:2048 lds
    buffer_load_dwordx4 v1, s[4:7], s21 offen offset:3072 lds
    s_add_u32 s21, s21, 4096
    s_add_u32 s22, s22, 4096
    s_mov_b32 m0, s22
    s_nop 0
    buffer_load_dwordx4 v1, s[4:7], s21 offen offset:0 lds
    buffer_load_dwordx4 v1, s[4:7], s21 offen offset:1024 lds
    buffer_load_dwordx4 v1, s[4:7], s21 offen offset:2048 lds
    s_waitcnt vmcnt(29)
    s_waitcnt vmcnt(21)
    s_waitcnt vmcnt(14)
    s_waitcnt vmcnt(7)
    s_waitcnt vmcnt(0)
    v_mov_b32 v125, 20
    ds_write_b32 v126, v125
    s_mul_i32 s23, s27, 112
    s_mul_i32 s22, s29, 28
    s_add_u32 s23, s23, s22
    s_lshl_b32 s23, s23, 10
    s_add_u32 s23, s23, 28674048
    v_mov_b32 v116, s44
    ds_read_b32 v116, v116
    s_waitcnt lgkmcnt(0)
    v_cmp_gt_u32 vcc, 38, v116
    s_nop 1
    s_cbranch_vccz Lc167d
    s_nop 1
    s_mov_b32 s25, 2000000
Lc167:
    s_nop 0
    s_sleep 1
    v_mov_b32 v116, s44
    ds_read_b32 v116, v116
    s_waitcnt lgkmcnt(0)
    v_cmp_gt_u32 vcc, 38, v116
    s_nop 1
    s_cbranch_vccz Lc167d
    s_sub_u32 s25, s25, 1
    s_cmp_lg_u32 s25, 0
    s_cbranch_scc1 Lc167
    s_nop 0
Lc167d:
    buffer_load_dwordx4 v[76:79], v120, s[4:7], s23 offen offset:0
    buffer_load_dwordx4 v[80:83], v120, s[4:7], s23 offen offset:256
    s_add_u32 s23, s23, 2048
    buffer_load_dwordx4 v[84:87], v120, s[4:7], s23 offen offset:0
    buffer_load_dwordx4 v[88:91], v120, s[4:7], s23 offen offset:256
    s_add_u32 s23, s23, 2048
    buffer_load_dwordx4 v[92:95], v120, s[4:7], s23 offen offset:0
    buffer_load_dwordx4 v[96:99], v120, s[4:7], s23 offen offset:256
    s_add_u32 s23, s23, 2048
    buffer_load_dwordx4 v[100:103], v120, s[4:7], s23 offen offset:0
    buffer_load_dwordx4 v[104:107], v120, s[4:7], s23 offen offset:256
    s_add_u32 s23, s23, 2048
    buffer_load_dwordx4 v[108:111], v120, s[4:7], s23 offen offset:0
    buffer_load_dwordx4 v[112:115], v120, s[4:7], s23 offen offset:256
    s_add_u32 s23, s23, 2048
    s_waitcnt vmcnt(8)
    v_mfma_f32_16x16x32_bf16 a[0:3], a[56:59], v[76:79], 0
    v_mfma_f32_16x16x32_bf16 a[28:31], a[56:59], v[80:83], 0
    v_mfma_f32_16x16x32_bf16 a[4:7], a[60:63], v[76:79], 0
    v_mfma_f32_16x16x32_bf16 a[32:35], a[60:63], v[80:83], 0
    v_mfma_f32_16x16x32_bf16 a[8:11], a[64:67], v[76:79], 0
    v_mfma_f32_16x16x32_bf16 a[36:39], a[64:67], v[80:83], 0
    v_mfma_f32_16x16x32_bf16 a[12:15], a[68:71], v[76:79], 0
    v_mfma_f32_16x16x32_bf16 a[40:43], a[68:71], v[80:83], 0
    v_mfma_f32_16x16x32_bf16 a[16:19], a[72:75], v[76:79], 0
    v_mfma_f32_16x16x32_bf16 a[44:47], a[72:75], v[80:83], 0
    v_mfma_f32_16x16x32_bf16 a[20:23], a[76:79], v[76:79], 0
    v_mfma_f32_16x16x32_bf16 a[48:51], a[76:79], v[80:83], 0
    v_mfma_f32_16x16x32_bf16 a[24:27], a[80:83], v[76:79], 0
    v_mfma_f32_16x16x32_bf16 a[52:55], a[80:83], v[80:83], 0
    s_waitcnt vmcnt(6)
    v_mfma_f32_16x16x32_bf16 a[0:3], a[84:87], v[84:87], a[0:3]
    v_mfma_f32_16x16x32_bf16 a[28:31], a[84:87], v[88:91], a[28:31]
    v_mfma_f32_16x16x32_bf16 a[4:7], a[88:91], v[84:87], a[4:7]
    v_mfma_f32_16x16x32_bf16 a[32:35], a[88:91], v[88:91], a[32:35]
    v_mfma_f32_16x16x32_bf16 a[8:11], a[92:95], v[84:87], a[8:11]
    v_mfma_f32_16x16x32_bf16 a[36:39], a[92:95], v[88:91], a[36:39]
    v_mfma_f32_16x16x32_bf16 a[12:15], a[96:99], v[84:87], a[12:15]
    v_mfma_f32_16x16x32_bf16 a[40:43], a[96:99], v[88:91], a[40:43]
    v_mfma_f32_16x16x32_bf16 a[16:19], a[100:103], v[84:87], a[16:19]
    v_mfma_f32_16x16x32_bf16 a[44:47], a[100:103], v[88:91], a[44:47]
    v_mfma_f32_16x16x32_bf16 a[20:23], a[104:107], v[84:87], a[20:23]
    v_mfma_f32_16x16x32_bf16 a[48:51], a[104:107], v[88:91], a[48:51]
    v_mfma_f32_16x16x32_bf16 a[24:27], a[108:111], v[84:87], a[24:27]
    v_mfma_f32_16x16x32_bf16 a[52:55], a[108:111], v[88:91], a[52:55]
    s_waitcnt vmcnt(4)
    v_mfma_f32_16x16x32_bf16 a[0:3], a[112:115], v[92:95], a[0:3]
    v_mfma_f32_16x16x32_bf16 a[28:31], a[112:115], v[96:99], a[28:31]
    v_mfma_f32_16x16x32_bf16 a[4:7], a[116:119], v[92:95], a[4:7]
    v_mfma_f32_16x16x32_bf16 a[32:35], a[116:119], v[96:99], a[32:35]
    v_mfma_f32_16x16x32_bf16 a[8:11], a[120:123], v[92:95], a[8:11]
    v_mfma_f32_16x16x32_bf16 a[36:39], a[120:123], v[96:99], a[36:39]
    v_mfma_f32_16x16x32_bf16 a[12:15], a[124:127], v[92:95], a[12:15]
    v_mfma_f32_16x16x32_bf16 a[40:43], a[124:127], v[96:99], a[40:43]
    v_mfma_f32_16x16x32_bf16 a[16:19], v[8:11], v[92:95], a[16:19]
    v_mfma_f32_16x16x32_bf16 a[44:47], v[8:11], v[96:99], a[44:47]
    v_mfma_f32_16x16x32_bf16 a[20:23], v[12:15], v[92:95], a[20:23]
    v_mfma_f32_16x16x32_bf16 a[48:51], v[12:15], v[96:99], a[48:51]
    v_mfma_f32_16x16x32_bf16 a[24:27], v[16:19], v[92:95], a[24:27]
    v_mfma_f32_16x16x32_bf16 a[52:55], v[16:19], v[96:99], a[52:55]
    s_waitcnt vmcnt(2)
    v_mfma_f32_16x16x32_bf16 a[0:3], v[20:23], v[100:103], a[0:3]
    v_mfma_f32_16x16x32_bf16 a[28:31], v[20:23], v[104:107], a[28:31]
    v_mfma_f32_16x16x32_bf16 a[4:7], v[24:27], v[100:103], a[4:7]
    v_mfma_f32_16x16x32_bf16 a[32:35], v[24:27], v[104:107], a[32:35]
    v_mfma_f32_16x16x32_bf16 a[8:11], v[28:31], v[100:103], a[8:11]
    v_mfma_f32_16x16x32_bf16 a[36:39], v[28:31], v[104:107], a[36:39]
    v_mfma_f32_16x16x32_bf16 a[12:15], v[32:35], v[100:103], a[12:15]
    v_mfma_f32_16x16x32_bf16 a[40:43], v[32:35], v[104:107], a[40:43]
    v_mfma_f32_16x16x32_bf16 a[16:19], v[36:39], v[100:103], a[16:19]
    v_mfma_f32_16x16x32_bf16 a[44:47], v[36:39], v[104:107], a[44:47]
    v_mfma_f32_16x16x32_bf16 a[20:23], v[40:43], v[100:103], a[20:23]
    v_mfma_f32_16x16x32_bf16 a[48:51], v[40:43], v[104:107], a[48:51]
    v_mfma_f32_16x16x32_bf16 a[24:27], v[44:47], v[100:103], a[24:27]
    v_mfma_f32_16x16x32_bf16 a[52:55], v[44:47], v[104:107], a[52:55]
    s_waitcnt vmcnt(0)
    v_mfma_f32_16x16x32_bf16 a[0:3], v[48:51], v[108:111], a[0:3]
    v_mfma_f32_16x16x32_bf16 a[28:31], v[48:51], v[112:115], a[28:31]
    v_mfma_f32_16x16x32_bf16 a[4:7], v[52:55], v[108:111], a[4:7]
    v_mfma_f32_16x16x32_bf16 a[32:35], v[52:55], v[112:115], a[32:35]
    v_mfma_f32_16x16x32_bf16 a[8:11], v[56:59], v[108:111], a[8:11]
    v_mfma_f32_16x16x32_bf16 a[36:39], v[56:59], v[112:115], a[36:39]
    v_mfma_f32_16x16x32_bf16 a[12:15], v[60:63], v[108:111], a[12:15]
    v_mfma_f32_16x16x32_bf16 a[40:43], v[60:63], v[112:115], a[40:43]
    v_mfma_f32_16x16x32_bf16 a[16:19], v[64:67], v[108:111], a[16:19]
    v_mfma_f32_16x16x32_bf16 a[44:47], v[64:67], v[112:115], a[44:47]
    v_mfma_f32_16x16x32_bf16 a[20:23], v[68:71], v[108:111], a[20:23]
    v_mfma_f32_16x16x32_bf16 a[48:51], v[68:71], v[112:115], a[48:51]
    v_mfma_f32_16x16x32_bf16 a[24:27], v[72:75], v[108:111], a[24:27]
    v_mfma_f32_16x16x32_bf16 a[52:55], v[72:75], v[112:115], a[52:55]
    v_mov_b32 v116, 148992
    ds_read_b128 v[116:119], v116
    s_waitcnt lgkmcnt(0)
    v_min3_u32 v116, v116, v117, v118
    v_min_u32 v116, v116, v119
    v_cmp_gt_u32 vcc, 44, v116
    s_nop 1
    s_cbranch_vccz Lc168d
    s_nop 1
    s_mov_b32 s25, 2000000
Lc168:
    s_nop 0
    s_sleep 1
    v_mov_b32 v116, 148992
    ds_read_b128 v[116:119], v116
    s_waitcnt lgkmcnt(0)
    v_min3_u32 v116, v116, v117, v118
    v_min_u32 v116, v116, v119
    v_cmp_gt_u32 vcc, 44, v116
    s_nop 1
    s_cbranch_vccz Lc168d
    s_sub_u32 s25, s25, 1
    s_cmp_lg_u32 s25, 0
    s_cbranch_scc1 Lc168
    s_nop 0
Lc168d:
    ds_write_b128 v121, a[0:3] offset:0
    ds_write_b128 v121, a[4:7] offset:64
    ds_write_b128 v121, a[8:11] offset:128
    ds_write_b128 v121, a[12:15] offset:192
    ds_write_b128 v121, a[16:19] offset:256
    ds_write_b128 v121, a[20:23] offset:320
    ds_write_b128 v121, a[24:27] offset:384
    ds_write_b128 v121, a[28:31] offset:7424
    ds_write_b128 v121, a[32:35] offset:7488
    ds_write_b128 v121, a[36:39] offset:7552
    ds_write_b128 v121, a[40:43] offset:7616
    ds_write_b128 v121, a[44:47] offset:7680
    ds_write_b128 v121, a[48:51] offset:7744
    ds_write_b128 v121, a[52:55] offset:7808
    v_mov_b32 v125, 21
    ds_write_b32 v126, v125
Lmain_end:
    s_nop 3
    s_endpgm
.section .rodata,"a"
.p2align 6
.amdhsa_kernel main_kernel
  .amdhsa_next_free_vgpr 256
  .amdhsa_next_free_sgpr 102
  .amdhsa_accum_offset 128
  .amdhsa_group_segment_fixed_size 0
  .amdhsa_kernarg_size 80
  .amdhsa_user_sgpr_count 2
  .amdhsa_user_sgpr_kernarg_segment_ptr 1
  .amdhsa_system_sgpr_workgroup_id_x 1
.end_amdhsa_kernel
.text
```
